```python
import torch

def _softmax(x, axis=-1):
    return torch.softmax(x, dim=axis)
def _gelu(x):
    return torch.nn.functional.gelu(x, approximate="tanh")
def _silu(x):
    return torch.nn.functional.silu(x)
def _sigmoid(x):
    return torch.sigmoid(x)
def _layernorm(x, axis=-1, eps=1e-5):
    m = x.mean(dim=axis, keepdim=True)
    v = x.var(dim=axis, keepdim=True, unbiased=False)
    return (x - m) / torch.sqrt(v + eps)
def _scatter_add(tgt, idx, src, axis=0):
    return tgt.clone().index_add_(axis, idx, src)
def _segment_sum(src, seg, n):
    out = torch.zeros((n,) + src.shape[1:], dtype=src.dtype)
    return out.index_add_(0, seg, src)
def _pad(x, pw):
    flat = tuple(v for pair in reversed(pw) for v in pair)
    return torch.nn.functional.pad(x, flat)

kernel_name = 'gated_mix__softmax_full_mha__mixer_s_mlp__prompt'

def setup_inputs():

    _w = (lambda a: (lambda t: t.to(torch.bfloat16) if t.is_floating_point() else t)(torch.as_tensor(a)))
    def _A_setup():
        B, S, D = 1, 2048, 1024
        return {
            "x": _w((lambda *s: torch.randn(*s, dtype=torch.bfloat16) * 0.1)(B, S, D)),
            "wqkv": _w((lambda *s: torch.randn(*s, dtype=torch.bfloat16) * 0.4)(D, 3 * D)),
            "wo": _w((lambda *s: torch.randn(*s, dtype=torch.bfloat16) * 0.4)(D, D)),
        }
    _A_in = _A_setup()

    def _B_setup():
        B, S, D, F = 1, 2048, 1024, 3584
        return {
            "x":  _w((lambda *s: torch.randn(*s, dtype=torch.bfloat16) * 0.1)(B, S, D)),
            "w1": _w((lambda *s: torch.randn(*s, dtype=torch.bfloat16) * 3.2)(D, D) * (D ** -0.5)),
            "w2": _w((lambda *s: torch.randn(*s, dtype=torch.bfloat16) * 3.2)(D, D) * (D ** -0.5)),
            "w3": _w((lambda *s: torch.randn(*s, dtype=torch.bfloat16) * 3.2)(D, F) * (D ** -0.5)),
            "w4": _w((lambda *s: torch.randn(*s, dtype=torch.bfloat16) * 3.2)(F, D) * (F ** -0.5)),
        }
    _B_in = _B_setup()

    return {
        "A_x": _A_in["x"],
        "A_wqkv": _A_in["wqkv"],
        "A_wo": _A_in["wo"],
        "B_x": _B_in["x"],
        "B_w1": _B_in["w1"],
        "B_w2": _B_in["w2"],
        "B_w3": _B_in["w3"],
        "B_w4": _B_in["w4"],
        "gate_w": _w((lambda *s: torch.randn(*s, dtype=torch.bfloat16) * 0.4)(1024) * 16.0),
    }

def reference(A_x, A_wqkv, A_wo, B_x, B_w1, B_w2, B_w3, B_w4, gate_w):
    def _A_ref(x, wqkv, wo):
        B, S, D = x.shape
        H = 32; Dh = D // H
        qkv = (lambda x, *d: x.permute(*d))((x @ wqkv).reshape(B, S, 3, H, Dh), 2, 0, 3, 1, 4)
        q, k, v = qkv[0], qkv[1], qkv[2]
        scale = Dh ** -0.5
        scores = torch.einsum("bhqd,bhkd->bhqk", q, k) * scale
        p = _softmax(scores, axis=-1)
        o = torch.einsum("bhqk,bhkd->bhqd", p, v)
        return (lambda x, *d: x.permute(*d))(o, 0, 2, 1, 3).reshape(B, S, D) @ wo

    def _B_ref(x, w1, w2, w3, w4):
        B, S, D = x.shape
        h = _gelu(_layernorm(x, axis=-1) @ w1)
        c = D // 4
        g0 = _pad(h[:, :, 0*c:1*c], ((0, 0), (1, 0), (0, 0)))[:, :S, :]
        g1 = _pad(h[:, :, 1*c:2*c], ((0, 0), (0, 1), (0, 0)))[:, 1:, :]
        g2 = _pad(h[:, :, 2*c:3*c], ((0, 0), (2, 0), (0, 0)))[:, :S, :]
        g3 = _pad(h[:, :, 3*c:   ], ((0, 0), (0, 2), (0, 0)))[:, 2:, :]
        hs = torch.concatenate([g0, g1, g2, g3], axis=-1) @ w2
        x1 = x + hs
        h2 = _gelu(_layernorm(x1, axis=-1) @ w3) @ w4
        return x1 + h2

    x = A_x
    g = _sigmoid((x * gate_w).sum(-1, keepdims=True))
    a = _A_ref(x, A_wqkv, A_wo)
    b = _B_ref(x, B_w1, B_w2, B_w3, B_w4)
    return g * a + (1 - g) * b
```

```asm
; @launch grid=(256,1,1) block=(512,1,1) lds=163840
.amdgcn_target "amdgcn-amd-amdhsa--gfx950"
.text
.p2align 8
.globl gated_mix__softmax_full_mha__mixer_s_mlp__prompt_kernel
.type gated_mix__softmax_full_mha__mixer_s_mlp__prompt_kernel,@function
gated_mix__softmax_full_mha__mixer_s_mlp__prompt_kernel:
    s_cmp_ge_u32 s2, 256
    s_cbranch_scc1 L_end_1
    s_load_dwordx16 s[64:79], s[0:1], 0
    s_load_dwordx8 s[80:87], s[0:1], 64
    v_lshrrev_b32 v1, 6, v0
    v_and_b32 v2, 63, v0
    s_and_b32 s14, s2, 7
    v_readfirstlane_b32 s18, v1
    s_lshr_b32 s15, s2, 3
    s_and_b32 s16, s14, 1
    s_lshl_b32 s16, s16, 3
    s_and_b32 s3, s15, 7
    s_add_u32 s16, s16, s3
    s_lshr_b32 s17, s14, 1
    s_lshl_b32 s17, s17, 2
    s_lshr_b32 s3, s15, 3
    s_add_u32 s17, s17, s3
    s_add_u32 s13, s17, 2
    s_and_b32 s13, s13, 15
    s_cmp_lt_u32 s18, 4
    s_cbranch_scc1 L_comp_2
H_begin:
    s_sub_u32 s18, s18, 4
    v_lshrrev_b32 v3, 3, v2
    v_and_b32 v4, 7, v2
    v_lshrrev_b32 v5, 1, v3
    v_xor_b32 v5, v5, v4
    s_lshl_b32 s3, s16, 7
    s_lshl_b32 s36, s18, 5
    s_add_u32 s3, s3, s36
    v_add_u32 v6, s3, v3
    v_lshlrev_b32 v6, 11, v6
    v_lshl_add_u32 v10, v5, 4, v6
    v_xor_b32 v11, 64, v10
    v_add_u32 v11, 15360, v11
    v_add_u32 v12, 30720, v10
    v_add_u32 v13, 30720, v11
    s_mov_b32 s31, 0x20000
    s_lshl_b32 s37, s18, 12
    s_and_b32 s3, s17, 7
    s_cmp_eq_u32 s3, 3
    s_cselect_b32 s3, 4, 4
    s_mul_i32 s52, s16, s3
    s_mul_i32 s3, s17, 0
    s_add_u32 s52, s52, s3
    s_and_b32 s52, s52, 15
    s_mov_b32 s55, s18
    s_mov_b32 s53, 0
    s_lshl_b32 s3, s55, 11
    s_mov_b32 s30, 6291456
    s_mov_b32 s32, 6144
    s_cmp_eq_u32 s55, 3
    s_cselect_b32 s30, 2097152, s30
    s_cselect_b32 s32, 2048, s32
    s_cselect_b32 s33, 0, s3
    s_cselect_b32 s3, s13, s17
    s_lshl_b32 s3, s3, 7
    s_add_u32 s33, s33, s3
    s_lshl_b32 s34, s32, 4
    s_lshl_b32 s35, s32, 6
    s_lshl_b32 s38, s55, 13
    s_add_u32 s38, s38, 16384
    v_and_b32 v14, 2, v3
    v_and_b32 v15, 7, v2
    v_xor_b32 v14, v14, v15
    v_mul_lo_u32 v15, v3, s32
    v_lshl_add_u32 v14, v14, 4, v15
    s_lshl_b32 s3, s32, 3
    s_sub_u32 s3, s3, 1024
    v_xor_b32 v15, 64, v14
    v_add_u32 v15, s3, v15
    s_waitcnt lgkmcnt(0)
    s_cmp_eq_u32 s55, 3
    s_cselect_b32 s28, s72, s66
    s_cselect_b32 s29, s73, s67
    s_and_b32 s29, s29, 0xffff
    s_mov_b32 s24, s64
    s_and_b32 s25, s65, 0xffff
    s_mov_b32 s26, 4194304
    s_mov_b32 s27, 0x20000
    s_add_u32 m0, s37, 0
    s_lshl_b32 s39, s52, 7
    buffer_load_dwordx4 v10, s[24:27], s39 offen offset:0 lds
    buffer_load_dwordx4 v11, s[24:27], s39 offen offset:1024 lds
    buffer_load_dwordx4 v12, s[24:27], s39 offen offset:2048 lds
    buffer_load_dwordx4 v13, s[24:27], s39 offen offset:3072 lds
    s_add_u32 s45, s38, 0
    s_mul_i32 s41, s52, s35
    s_add_u32 s41, s41, s33
    s_add_u32 m0, s45, 0
    s_add_u32 s52, s52, 1
    buffer_load_dwordx4 v14, s[28:31], s41 offen lds
    buffer_load_dwordx4 v15, s[28:31], s41 offen offset:1024 lds
    s_add_u32 m0, s45, 2048
    s_add_u32 s41, s41, s34
    buffer_load_dwordx4 v14, s[28:31], s41 offen lds
    buffer_load_dwordx4 v15, s[28:31], s41 offen offset:1024 lds
    s_add_u32 m0, s45, 4096
    s_add_u32 s41, s41, s34
    buffer_load_dwordx4 v14, s[28:31], s41 offen lds
    buffer_load_dwordx4 v15, s[28:31], s41 offen offset:1024 lds
    s_add_u32 m0, s45, 6144
    s_add_u32 s41, s41, s34
    buffer_load_dwordx4 v14, s[28:31], s41 offen lds
    buffer_load_dwordx4 v15, s[28:31], s41 offen offset:1024 lds
    s_and_b32 s52, s52, 15
    s_add_u32 m0, s37, 49152
    s_lshl_b32 s39, s52, 7
    buffer_load_dwordx4 v10, s[24:27], s39 offen offset:0 lds
    buffer_load_dwordx4 v11, s[24:27], s39 offen offset:1024 lds
    buffer_load_dwordx4 v12, s[24:27], s39 offen offset:2048 lds
    buffer_load_dwordx4 v13, s[24:27], s39 offen offset:3072 lds
    s_waitcnt vmcnt(4)
    s_barrier
    s_add_u32 s45, s38, 49152
    s_mul_i32 s41, s52, s35
    s_add_u32 s41, s41, s33
    s_add_u32 m0, s45, 0
    s_add_u32 s52, s52, 1
    buffer_load_dwordx4 v14, s[28:31], s41 offen lds
    buffer_load_dwordx4 v15, s[28:31], s41 offen offset:1024 lds
    s_add_u32 m0, s45, 2048
    s_add_u32 s41, s41, s34
    buffer_load_dwordx4 v14, s[28:31], s41 offen lds
    buffer_load_dwordx4 v15, s[28:31], s41 offen offset:1024 lds
    s_add_u32 m0, s45, 4096
    s_add_u32 s41, s41, s34
    buffer_load_dwordx4 v14, s[28:31], s41 offen lds
    buffer_load_dwordx4 v15, s[28:31], s41 offen offset:1024 lds
    s_add_u32 m0, s45, 6144
    s_add_u32 s41, s41, s34
    buffer_load_dwordx4 v14, s[28:31], s41 offen lds
    buffer_load_dwordx4 v15, s[28:31], s41 offen offset:1024 lds
    s_and_b32 s52, s52, 15
    s_add_u32 m0, s37, 98304
    s_lshl_b32 s39, s52, 7
    buffer_load_dwordx4 v10, s[24:27], s39 offen offset:0 lds
    buffer_load_dwordx4 v11, s[24:27], s39 offen offset:1024 lds
    buffer_load_dwordx4 v12, s[24:27], s39 offen offset:2048 lds
    buffer_load_dwordx4 v13, s[24:27], s39 offen offset:3072 lds
    s_add_u32 s45, s38, 98304
    s_mul_i32 s41, s52, s35
    s_add_u32 s41, s41, s33
    s_add_u32 m0, s45, 0
    s_add_u32 s52, s52, 1
    buffer_load_dwordx4 v14, s[28:31], s41 offen lds
    buffer_load_dwordx4 v15, s[28:31], s41 offen offset:1024 lds
    s_lshl_b32 s46, s16, 7
    s_lshl_b32 s3, s17, 3
    s_add_u32 s46, s46, s3
    s_lshl_b32 s3, s18, 1
    s_add_u32 s46, s46, s3
    s_lshl_b32 s46, s46, 11
    v_lshlrev_b32 v8, 4, v2
    v_lshlrev_b32 v5, 11, v3
    v_lshl_add_u32 v31, v4, 4, v5
    s_lshl_b32 s47, s16, 17
    s_lshl_b32 s3, s17, 7
    s_add_u32 s47, s47, s3
    s_lshl_b32 s3, s18, 15
    s_add_u32 s47, s47, s3
    s_add_u32 s42, s47, 16384
    v_mov_b32 v9, 0xffff0000
    v_lshrrev_b32 v4, 4, v2
    s_mov_b32 s56, s72
    s_and_b32 s57, s73, 0xffff
    s_mov_b32 s58, 2097152
    s_mov_b32 s59, 0x20000
    s_mov_b32 s8, s84
    s_and_b32 s9, s85, 0xffff
    s_mov_b32 s10, 256
    s_mov_b32 s11, 0x20000
    s_waitcnt vmcnt(6)
    s_barrier
    s_add_u32 m0, s45, 2048
    s_add_u32 s41, s41, s34
    buffer_load_dwordx4 v14, s[28:31], s41 offen lds
    buffer_load_dwordx4 v15, s[28:31], s41 offen offset:1024 lds
    s_add_u32 m0, s45, 4096
    s_add_u32 s41, s41, s34
    buffer_load_dwordx4 v14, s[28:31], s41 offen lds
    buffer_load_dwordx4 v15, s[28:31], s41 offen offset:1024 lds
    s_add_u32 m0, s45, 6144
    s_add_u32 s41, s41, s34
    buffer_load_dwordx4 v14, s[28:31], s41 offen lds
    buffer_load_dwordx4 v15, s[28:31], s41 offen offset:1024 lds
    s_and_b32 s52, s52, 15
    buffer_load_dwordx4 v[64:67], v8, s[24:27], s46 offen offset:0
    buffer_load_dwordx4 v[68:71], v8, s[24:27], s46 offen offset:1024
    buffer_load_dwordx4 v[72:75], v8, s[24:27], s46 offen offset:2048
    buffer_load_dwordx4 v[76:79], v8, s[24:27], s46 offen offset:3072
    s_add_u32 m0, s37, 0
    s_lshl_b32 s39, s52, 7
    buffer_load_dwordx4 v10, s[24:27], s39 offen offset:0 lds
    buffer_load_dwordx4 v11, s[24:27], s39 offen offset:1024 lds
    s_waitcnt vmcnt(6)
    s_barrier
    buffer_load_dwordx4 v12, s[24:27], s39 offen offset:2048 lds
    buffer_load_dwordx4 v13, s[24:27], s39 offen offset:3072 lds
    s_add_u32 s45, s38, 0
    s_mul_i32 s41, s52, s35
    s_add_u32 s41, s41, s33
    s_add_u32 m0, s45, 0
    s_add_u32 s52, s52, 1
    buffer_load_dwordx4 v14, s[28:31], s41 offen lds
    buffer_load_dwordx4 v15, s[28:31], s41 offen offset:1024 lds
    s_add_u32 m0, s45, 2048
    s_add_u32 s41, s41, s34
    buffer_load_dwordx4 v14, s[28:31], s41 offen lds
    buffer_load_dwordx4 v15, s[28:31], s41 offen offset:1024 lds
    s_add_u32 m0, s45, 4096
    s_add_u32 s41, s41, s34
    buffer_load_dwordx4 v14, s[28:31], s41 offen lds
    buffer_load_dwordx4 v15, s[28:31], s41 offen offset:1024 lds
    s_add_u32 m0, s45, 6144
    s_add_u32 s41, s41, s34
    buffer_load_dwordx4 v14, s[28:31], s41 offen lds
    buffer_load_dwordx4 v15, s[28:31], s41 offen offset:1024 lds
    s_and_b32 s52, s52, 15
    buffer_load_dword v19, off, s[8:11], 0 sc1
    s_add_u32 m0, s37, 49152
    s_lshl_b32 s39, s52, 7
    buffer_load_dwordx4 v10, s[24:27], s39 offen offset:0 lds
    buffer_load_dwordx4 v11, s[24:27], s39 offen offset:1024 lds
    buffer_load_dwordx4 v12, s[24:27], s39 offen offset:2048 lds
    buffer_load_dwordx4 v13, s[24:27], s39 offen offset:3072 lds
    s_add_u32 s45, s38, 49152
    s_mul_i32 s41, s52, s35
    s_add_u32 s41, s41, s33
    s_add_u32 m0, s45, 0
    s_add_u32 s52, s52, 1
    buffer_load_dwordx4 v14, s[28:31], s41 offen lds
    buffer_load_dwordx4 v15, s[28:31], s41 offen offset:1024 lds
    s_mov_b32 s4, s86
    s_and_b32 s5, s87, 0xffff
    s_mov_b32 s6, 88080384
    s_mov_b32 s7, 0x20000
    s_lshl_b32 s19, s16, 4
    s_add_u32 s19, s19, s17
    s_lshl_b32 s21, s19, 7
    s_add_u32 s21, s21, 40239104
    s_mov_b32 s22, 8
    s_mov_b32 s23, 159296
    s_lshl_b32 s3, s19, 9
    s_add_u32 s3, s3, 40501248
    s_cmp_eq_u32 s18, 1
    s_cselect_b32 s21, s3, s21
    s_cselect_b32 s22, 32, s22
    s_cselect_b32 s23, 159552, s23
    s_cselect_b32 s54, -1, 0
    s_cmp_ge_u32 s18, 2
    s_cselect_b32 s22, 0, s22
    v_and_b32 v5, 31, v2
    v_lshl_add_u32 v17, v5, 3, s23
    v_cmp_gt_u32 vcc, s22, v2
    v_mov_b32 v5, 2147483632
    s_nop 0
    v_cndmask_b32 v16, v5, v8, vcc
    s_waitcnt vmcnt(6)
    s_barrier
    s_add_u32 m0, s45, 2048
    s_add_u32 s41, s41, s34
    buffer_load_dwordx4 v14, s[28:31], s41 offen lds
    buffer_load_dwordx4 v15, s[28:31], s41 offen offset:1024 lds
    s_add_u32 m0, s45, 4096
    s_add_u32 s41, s41, s34
    buffer_load_dwordx4 v14, s[28:31], s41 offen lds
    buffer_load_dwordx4 v15, s[28:31], s41 offen offset:1024 lds
    s_add_u32 m0, s45, 6144
    s_add_u32 s41, s41, s34
    buffer_load_dwordx4 v14, s[28:31], s41 offen lds
    buffer_load_dwordx4 v15, s[28:31], s41 offen offset:1024 lds
    s_and_b32 s52, s52, 15
    s_mov_b32 s62, 0x8000
L_noncesp_4:
    v_cmp_eq_u32 vcc, 0, v19
    s_cbranch_vccz L_nonceok_3
    s_sub_u32 s62, s62, 1
    s_cmp_eq_u32 s62, 0
    s_cbranch_scc1 L_nonceok_3
    s_sleep 2
    buffer_load_dword v19, off, s[8:11], 0 sc1
    s_waitcnt vmcnt(0)
    s_branch L_noncesp_4
L_nonceok_3:
    v_readfirstlane_b32 s12, v19
    s_mov_b32 s8, s80
    s_and_b32 s9, s81, 0xffff
    s_mov_b32 s10, 2048
    s_mov_b32 s11, 0x20000
    buffer_load_dwordx4 v[88:91], v31, s[56:59], s47 offen
    buffer_load_dwordx4 v[92:95], v31, s[56:59], s42 offen
    s_add_u32 m0, s37, 98304
    s_lshl_b32 s39, s52, 7
    buffer_load_dwordx4 v10, s[24:27], s39 offen offset:0 lds
    v_lshlrev_b32 v34, 16, v64
    v_and_b32 v35, v9, v64
    v_add_f32 v24, v34, v35
    v_mul_f32 v26, v34, v34
    buffer_load_dwordx4 v11, s[24:27], s39 offen offset:1024 lds
    v_fmac_f32 v26, v35, v35
    v_lshlrev_b32 v34, 16, v65
    v_and_b32 v35, v9, v65
    v_add_f32 v24, v24, v34
    v_fmac_f32 v26, v34, v34
    buffer_load_dwordx4 v12, s[24:27], s39 offen offset:2048 lds
    v_add_f32 v24, v24, v35
    v_fmac_f32 v26, v35, v35
    v_lshlrev_b32 v34, 16, v66
    v_and_b32 v35, v9, v66
    buffer_load_dwordx4 v13, s[24:27], s39 offen offset:3072 lds
    v_add_f32 v24, v24, v34
    v_fmac_f32 v26, v34, v34
    v_add_f32 v24, v24, v35
    v_fmac_f32 v26, v35, v35
    v_lshlrev_b32 v34, 16, v67
    s_add_u32 s45, s38, 98304
    s_mul_i32 s41, s52, s35
    s_add_u32 s41, s41, s33
    s_add_u32 m0, s45, 0
    s_add_u32 s52, s52, 1
    buffer_load_dwordx4 v14, s[28:31], s41 offen lds
    v_and_b32 v35, v9, v67
    v_add_f32 v24, v24, v34
    v_fmac_f32 v26, v34, v34
    v_add_f32 v24, v24, v35
    buffer_load_dwordx4 v15, s[28:31], s41 offen offset:1024 lds
    v_fmac_f32 v26, v35, v35
    v_lshlrev_b32 v34, 16, v68
    v_and_b32 v35, v9, v68
    v_add_f32 v24, v24, v34
    v_fmac_f32 v26, v34, v34
    s_add_u32 m0, s45, 2048
    s_add_u32 s41, s41, s34
    buffer_load_dwordx4 v14, s[28:31], s41 offen lds
    v_add_f32 v24, v24, v35
    v_fmac_f32 v26, v35, v35
    v_lshlrev_b32 v34, 16, v69
    v_and_b32 v35, v9, v69
    v_add_f32 v24, v24, v34
    buffer_load_dwordx4 v15, s[28:31], s41 offen offset:1024 lds
    v_fmac_f32 v26, v34, v34
    v_add_f32 v24, v24, v35
    v_fmac_f32 v26, v35, v35
    v_lshlrev_b32 v34, 16, v70
    s_add_u32 m0, s45, 4096
    s_add_u32 s41, s41, s34
    buffer_load_dwordx4 v14, s[28:31], s41 offen lds
    v_and_b32 v35, v9, v70
    v_add_f32 v24, v24, v34
    v_fmac_f32 v26, v34, v34
    v_add_f32 v24, v24, v35
    v_fmac_f32 v26, v35, v35
    buffer_load_dwordx4 v15, s[28:31], s41 offen offset:1024 lds
    v_lshlrev_b32 v34, 16, v71
    v_and_b32 v35, v9, v71
    v_add_f32 v24, v24, v34
    v_fmac_f32 v26, v34, v34
    s_add_u32 m0, s45, 6144
    s_add_u32 s41, s41, s34
    buffer_load_dwordx4 v14, s[28:31], s41 offen lds
    v_add_f32 v24, v24, v35
    v_fmac_f32 v26, v35, v35
    v_lshlrev_b32 v34, 16, v72
    v_and_b32 v35, v9, v72
    v_add_f32 v25, v34, v35
    buffer_load_dwordx4 v15, s[28:31], s41 offen offset:1024 lds
    v_mul_f32 v27, v34, v34
    v_fmac_f32 v27, v35, v35
    v_lshlrev_b32 v34, 16, v73
    v_and_b32 v35, v9, v73
    v_add_f32 v25, v25, v34
    s_and_b32 s52, s52, 15
    s_waitcnt vmcnt(12)
    s_barrier
    s_add_u32 m0, s37, 0
    s_lshl_b32 s39, s52, 7
    buffer_load_dwordx4 v10, s[24:27], s39 offen offset:0 lds
    v_fmac_f32 v27, v34, v34
    v_add_f32 v25, v25, v35
    v_fmac_f32 v27, v35, v35
    v_lshlrev_b32 v34, 16, v74
    buffer_load_dwordx4 v11, s[24:27], s39 offen offset:1024 lds
    v_and_b32 v35, v9, v74
    v_add_f32 v25, v25, v34
    v_fmac_f32 v27, v34, v34
    v_add_f32 v25, v25, v35
    v_fmac_f32 v27, v35, v35
    buffer_load_dwordx4 v12, s[24:27], s39 offen offset:2048 lds
    v_lshlrev_b32 v34, 16, v75
    v_and_b32 v35, v9, v75
    v_add_f32 v25, v25, v34
    v_fmac_f32 v27, v34, v34
    buffer_load_dwordx4 v13, s[24:27], s39 offen offset:3072 lds
    v_add_f32 v25, v25, v35
    v_fmac_f32 v27, v35, v35
    v_lshlrev_b32 v34, 16, v76
    v_and_b32 v35, v9, v76
    v_add_f32 v25, v25, v34
    s_add_u32 s45, s38, 0
    s_mul_i32 s41, s52, s35
    s_add_u32 s41, s41, s33
    s_add_u32 m0, s45, 0
    s_add_u32 s52, s52, 1
    buffer_load_dwordx4 v14, s[28:31], s41 offen lds
    v_fmac_f32 v27, v34, v34
    v_add_f32 v25, v25, v35
    v_fmac_f32 v27, v35, v35
    v_lshlrev_b32 v34, 16, v77
    buffer_load_dwordx4 v15, s[28:31], s41 offen offset:1024 lds
    v_and_b32 v35, v9, v77
    v_add_f32 v25, v25, v34
    v_fmac_f32 v27, v34, v34
    v_add_f32 v25, v25, v35
    v_fmac_f32 v27, v35, v35
    s_add_u32 m0, s45, 2048
    s_add_u32 s41, s41, s34
    buffer_load_dwordx4 v14, s[28:31], s41 offen lds
    v_lshlrev_b32 v34, 16, v78
    v_and_b32 v35, v9, v78
    v_add_f32 v25, v25, v34
    v_fmac_f32 v27, v34, v34
    v_add_f32 v25, v25, v35
    buffer_load_dwordx4 v15, s[28:31], s41 offen offset:1024 lds
    v_fmac_f32 v27, v35, v35
    v_lshlrev_b32 v34, 16, v79
    v_and_b32 v35, v9, v79
    v_add_f32 v25, v25, v34
    s_add_u32 m0, s45, 4096
    s_add_u32 s41, s41, s34
    buffer_load_dwordx4 v14, s[28:31], s41 offen lds
    v_fmac_f32 v27, v34, v34
    v_add_f32 v25, v25, v35
    v_fmac_f32 v27, v35, v35
    v_lshlrev_b32 v40, 16, v88
    v_and_b32 v41, v9, v88
    buffer_load_dwordx4 v15, s[28:31], s41 offen offset:1024 lds
    v_lshlrev_b32 v32, 16, v92
    v_and_b32 v33, v9, v92
    v_add_f32 v40, v40, v32
    v_add_f32 v41, v41, v33
    s_add_u32 m0, s45, 6144
    s_add_u32 s41, s41, s34
    buffer_load_dwordx4 v14, s[28:31], s41 offen lds
    v_lshlrev_b32 v42, 16, v89
    v_and_b32 v43, v9, v89
    v_lshlrev_b32 v32, 16, v93
    v_and_b32 v33, v9, v93
    v_add_f32 v42, v42, v32
    buffer_load_dwordx4 v15, s[28:31], s41 offen offset:1024 lds
    v_add_f32 v43, v43, v33
    v_lshlrev_b32 v44, 16, v90
    v_and_b32 v45, v9, v90
    v_lshlrev_b32 v32, 16, v94
    v_and_b32 v33, v9, v94
    s_and_b32 s52, s52, 15
    s_waitcnt vmcnt(12)
    s_barrier
    buffer_load_dwordx4 v[80:83], v8, s[8:11], 0 offen
    buffer_load_dwordx4 v[84:87], v8, s[8:11], 0 offen offset:1024
    s_add_u32 m0, s37, 49152
    s_lshl_b32 s39, s52, 7
    buffer_load_dwordx4 v10, s[24:27], s39 offen offset:0 lds
    v_add_f32 v44, v44, v32
    v_add_f32 v45, v45, v33
    v_lshlrev_b32 v46, 16, v91
    v_and_b32 v47, v9, v91
    buffer_load_dwordx4 v11, s[24:27], s39 offen offset:1024 lds
    v_lshlrev_b32 v32, 16, v95
    v_and_b32 v33, v9, v95
    v_add_f32 v46, v46, v32
    v_add_f32 v47, v47, v33
    v_permlane32_swap_b32 v24, v25
    buffer_load_dwordx4 v12, s[24:27], s39 offen offset:2048 lds
    v_permlane32_swap_b32 v26, v27
    v_permlane32_swap_b32 v40, v44
    v_permlane32_swap_b32 v41, v45
    v_permlane32_swap_b32 v42, v46
    v_permlane32_swap_b32 v43, v47
    buffer_load_dwordx4 v13, s[24:27], s39 offen offset:3072 lds
    v_add_f32 v24, v24, v25
    v_add_f32 v26, v26, v27
    v_add_f32 v40, v40, v44
    v_add_f32 v41, v41, v45
    s_add_u32 s45, s38, 49152
    s_mul_i32 s41, s52, s35
    s_add_u32 s41, s41, s33
    s_add_u32 m0, s45, 0
    s_add_u32 s52, s52, 1
    buffer_load_dwordx4 v14, s[28:31], s41 offen lds
    v_add_f32 v42, v42, v46
    v_add_f32 v43, v43, v47
    v_mov_b32 v25, v24
    v_mov_b32 v27, v26
    v_permlane16_swap_b32 v40, v42
    buffer_load_dwordx4 v15, s[28:31], s41 offen offset:1024 lds
    v_permlane16_swap_b32 v41, v43
    v_permlane16_swap_b32 v24, v25
    v_permlane16_swap_b32 v26, v27
    v_add_f32 v40, v40, v42
    v_add_f32 v41, v41, v43
    s_add_u32 m0, s45, 2048
    s_add_u32 s41, s41, s34
    buffer_load_dwordx4 v14, s[28:31], s41 offen lds
    v_add_f32 v24, v24, v25
    v_add_f32 v25, v26, v27
    v_add_f32_dpp v40, v40, v40 row_ror:8 row_mask:0xf bank_mask:0xf
    v_add_f32_dpp v41, v41, v41 row_ror:8 row_mask:0xf bank_mask:0xf
    buffer_load_dwordx4 v15, s[28:31], s41 offen offset:1024 lds
    v_add_f32_dpp v24, v24, v24 row_ror:8 row_mask:0xf bank_mask:0xf
    v_add_f32_dpp v25, v25, v25 row_ror:8 row_mask:0xf bank_mask:0xf
    v_and_b32 v5, 7, v2
    v_add_f32_dpp v24, v24, v24 row_ror:4 row_mask:0xf bank_mask:0xf
    v_add_f32_dpp v25, v25, v25 row_ror:4 row_mask:0xf bank_mask:0xf
    s_add_u32 m0, s45, 4096
    s_add_u32 s41, s41, s34
    buffer_load_dwordx4 v14, s[28:31], s41 offen lds
    v_lshlrev_b32 v5, 5, v5
    v_add_f32_dpp v24, v24, v24 row_ror:2 row_mask:0xf bank_mask:0xf
    v_add_f32_dpp v25, v25, v25 row_ror:2 row_mask:0xf bank_mask:0xf
    v_lshrrev_b32 v6, 5, v2
    v_add_f32_dpp v24, v24, v24 row_ror:1 row_mask:0xf bank_mask:0xf
    buffer_load_dwordx4 v15, s[28:31], s41 offen offset:1024 lds
    v_add_f32_dpp v25, v25, v25 row_ror:1 row_mask:0xf bank_mask:0xf
    v_lshl_add_u32 v5, v6, 4, v5
    v_and_b32 v7, 1, v4
    v_lshl_add_u32 v5, v7, 3, v5
    s_add_u32 m0, s45, 6144
    s_add_u32 s41, s41, s34
    buffer_load_dwordx4 v14, s[28:31], s41 offen lds
    s_lshl_b32 s3, s18, 8
    s_add_u32 s3, s3, 159552
    v_add_u32 v5, s3, v5
    ds_write_b64 v5, v[40:41]
    v_mul_f32 v24, 0x3a800000, v24
    buffer_load_dwordx4 v15, s[28:31], s41 offen offset:1024 lds
    v_mul_f32 v25, 0x3a800000, v25
    s_lshl_b32 s3, s18, 4
    s_add_u32 s3, s3, 159296
    v_lshl_add_u32 v5, v6, 3, s3
    ds_write_b64 v5, v[24:25]
    s_and_b32 s52, s52, 15
    s_waitcnt vmcnt(12) lgkmcnt(0)
    s_barrier
    ds_read_b64 v[24:25], v17 offset:0
    ds_read_b64 v[26:27], v17 offset:256
    ds_read_b64 v[28:29], v17 offset:512
    ds_read_b64 v[30:31], v17 offset:768
    s_add_u32 m0, s37, 98304
    s_lshl_b32 s39, s52, 7
    buffer_load_dwordx4 v10, s[24:27], s39 offen offset:0 lds
    buffer_load_dwordx4 v11, s[24:27], s39 offen offset:1024 lds
    s_waitcnt lgkmcnt(0)
    buffer_load_dwordx4 v12, s[24:27], s39 offen offset:2048 lds
    v_add_f32 v26, v26, v28
    buffer_load_dwordx4 v13, s[24:27], s39 offen offset:3072 lds
    v_add_f32 v26, v26, v30
    s_add_u32 s45, s38, 98304
    s_mul_i32 s41, s52, s35
    s_add_u32 s41, s41, s33
    s_add_u32 m0, s45, 0
    s_add_u32 s52, s52, 1
    buffer_load_dwordx4 v14, s[28:31], s41 offen lds
    v_and_b32 v26, s54, v26
    buffer_load_dwordx4 v15, s[28:31], s41 offen offset:1024 lds
    v_add_f32 v20, v24, v26
    s_add_u32 m0, s45, 2048
    s_add_u32 s41, s41, s34
    buffer_load_dwordx4 v14, s[28:31], s41 offen lds
    v_mov_b32 v21, s12
    buffer_load_dwordx4 v15, s[28:31], s41 offen offset:1024 lds
    v_add_f32 v27, v27, v29
    s_add_u32 m0, s45, 4096
    s_add_u32 s41, s41, s34
    buffer_load_dwordx4 v14, s[28:31], s41 offen lds
    v_add_f32 v27, v27, v31
    buffer_load_dwordx4 v15, s[28:31], s41 offen offset:1024 lds
    v_and_b32 v27, s54, v27
    s_add_u32 m0, s45, 6144
    s_add_u32 s41, s41, s34
    buffer_load_dwordx4 v14, s[28:31], s41 offen lds
    v_add_f32 v22, v25, v27
    buffer_load_dwordx4 v15, s[28:31], s41 offen offset:1024 lds
    v_mov_b32 v23, s12
    s_and_b32 s52, s52, 15
    buffer_store_dwordx4 v[20:23], v16, s[4:7], s21 offen sc1
    s_waitcnt vmcnt(13)
    s_barrier
    s_mov_b32 s8, s74
    s_and_b32 s9, s75, 0xffff
    s_mov_b32 s10, 2097152
    s_mov_b32 s11, 0x20000
    s_add_u32 m0, s37, 0
    s_lshl_b32 s39, s52, 7
    buffer_load_dwordx4 v10, s[24:27], s39 offen offset:0 lds
    v_mov_b32 v28, 0
    v_mov_b32 v29, 0
    buffer_load_dwordx4 v11, s[24:27], s39 offen offset:1024 lds
    v_lshlrev_b32 v32, 16, v80
    v_and_b32 v33, v9, v80
    v_lshlrev_b32 v34, 16, v64
    buffer_load_dwordx4 v12, s[24:27], s39 offen offset:2048 lds
    v_and_b32 v35, v9, v64
    v_mul_f32 v34, v34, v32
    v_mul_f32 v35, v35, v33
    buffer_load_dwordx4 v13, s[24:27], s39 offen offset:3072 lds
    v_cvt_pk_bf16_f32 v34, v34, v35
    v_lshlrev_b32 v35, 16, v34
    v_and_b32 v34, v9, v34
    s_add_u32 s45, s38, 0
    s_mul_i32 s41, s52, s35
    s_add_u32 s41, s41, s33
    s_add_u32 m0, s45, 0
    s_add_u32 s52, s52, 1
    buffer_load_dwordx4 v14, s[28:31], s41 offen lds
    v_add_f32 v28, v28, v35
    v_add_f32 v28, v28, v34
    v_lshlrev_b32 v34, 16, v72
    buffer_load_dwordx4 v15, s[28:31], s41 offen offset:1024 lds
    v_and_b32 v35, v9, v72
    v_mul_f32 v34, v34, v32
    v_mul_f32 v35, v35, v33
    s_add_u32 m0, s45, 2048
    s_add_u32 s41, s41, s34
    buffer_load_dwordx4 v14, s[28:31], s41 offen lds
    v_cvt_pk_bf16_f32 v34, v34, v35
    v_lshlrev_b32 v35, 16, v34
    buffer_load_dwordx4 v15, s[28:31], s41 offen offset:1024 lds
    v_and_b32 v34, v9, v34
    v_add_f32 v29, v29, v35
    v_add_f32 v29, v29, v34
    s_add_u32 m0, s45, 4096
    s_add_u32 s41, s41, s34
    buffer_load_dwordx4 v14, s[28:31], s41 offen lds
    v_lshlrev_b32 v32, 16, v81
    v_and_b32 v33, v9, v81
    v_lshlrev_b32 v34, 16, v65
    buffer_load_dwordx4 v15, s[28:31], s41 offen offset:1024 lds
    v_and_b32 v35, v9, v65
    v_mul_f32 v34, v34, v32
    v_mul_f32 v35, v35, v33
    s_add_u32 m0, s45, 6144
    s_add_u32 s41, s41, s34
    buffer_load_dwordx4 v14, s[28:31], s41 offen lds
    v_cvt_pk_bf16_f32 v34, v34, v35
    v_lshlrev_b32 v35, 16, v34
    v_and_b32 v34, v9, v34
    buffer_load_dwordx4 v15, s[28:31], s41 offen offset:1024 lds
    v_add_f32 v28, v28, v35
    v_add_f32 v28, v28, v34
    v_lshlrev_b32 v34, 16, v73
    s_and_b32 s52, s52, 15
    s_waitcnt vmcnt(12)
    s_barrier
    s_add_u32 m0, s37, 49152
    s_lshl_b32 s39, s52, 7
    buffer_load_dwordx4 v10, s[24:27], s39 offen offset:0 lds
    v_and_b32 v35, v9, v73
    v_mul_f32 v34, v34, v32
    buffer_load_dwordx4 v11, s[24:27], s39 offen offset:1024 lds
    v_mul_f32 v35, v35, v33
    v_cvt_pk_bf16_f32 v34, v34, v35
    v_lshlrev_b32 v35, 16, v34
    buffer_load_dwordx4 v12, s[24:27], s39 offen offset:2048 lds
    v_and_b32 v34, v9, v34
    v_add_f32 v29, v29, v35
    v_add_f32 v29, v29, v34
    buffer_load_dwordx4 v13, s[24:27], s39 offen offset:3072 lds
    v_lshlrev_b32 v32, 16, v82
    v_and_b32 v33, v9, v82
    v_lshlrev_b32 v34, 16, v66
    s_add_u32 s45, s38, 49152
    s_mul_i32 s41, s52, s35
    s_add_u32 s41, s41, s33
    s_add_u32 m0, s45, 0
    s_add_u32 s52, s52, 1
    buffer_load_dwordx4 v14, s[28:31], s41 offen lds
    v_and_b32 v35, v9, v66
    v_mul_f32 v34, v34, v32
    v_mul_f32 v35, v35, v33
    buffer_load_dwordx4 v15, s[28:31], s41 offen offset:1024 lds
    v_cvt_pk_bf16_f32 v34, v34, v35
    v_lshlrev_b32 v35, 16, v34
    v_and_b32 v34, v9, v34
    s_add_u32 m0, s45, 2048
    s_add_u32 s41, s41, s34
    buffer_load_dwordx4 v14, s[28:31], s41 offen lds
    v_add_f32 v28, v28, v35
    v_add_f32 v28, v28, v34
    v_lshlrev_b32 v34, 16, v74
    buffer_load_dwordx4 v15, s[28:31], s41 offen offset:1024 lds
    v_and_b32 v35, v9, v74
    v_mul_f32 v34, v34, v32
    v_mul_f32 v35, v35, v33
    s_add_u32 m0, s45, 4096
    s_add_u32 s41, s41, s34
    buffer_load_dwordx4 v14, s[28:31], s41 offen lds
    v_cvt_pk_bf16_f32 v34, v34, v35
    v_lshlrev_b32 v35, 16, v34
    v_and_b32 v34, v9, v34
    buffer_load_dwordx4 v15, s[28:31], s41 offen offset:1024 lds
    v_add_f32 v29, v29, v35
    v_add_f32 v29, v29, v34
    v_lshlrev_b32 v32, 16, v83
    s_add_u32 m0, s45, 6144
    s_add_u32 s41, s41, s34
    buffer_load_dwordx4 v14, s[28:31], s41 offen lds
    v_and_b32 v33, v9, v83
    v_lshlrev_b32 v34, 16, v67
    v_and_b32 v35, v9, v67
    buffer_load_dwordx4 v15, s[28:31], s41 offen offset:1024 lds
    v_mul_f32 v34, v34, v32
    v_mul_f32 v35, v35, v33
    v_cvt_pk_bf16_f32 v34, v34, v35
    s_and_b32 s52, s52, 15
    s_waitcnt vmcnt(12)
    s_barrier
    s_add_u32 m0, s37, 98304
    s_lshl_b32 s39, s52, 7
    buffer_load_dwordx4 v10, s[24:27], s39 offen offset:0 lds
    v_lshlrev_b32 v35, 16, v34
    v_and_b32 v34, v9, v34
    buffer_load_dwordx4 v11, s[24:27], s39 offen offset:1024 lds
    v_add_f32 v28, v28, v35
    v_add_f32 v28, v28, v34
    v_lshlrev_b32 v34, 16, v75
    buffer_load_dwordx4 v12, s[24:27], s39 offen offset:2048 lds
    v_and_b32 v35, v9, v75
    v_mul_f32 v34, v34, v32
    v_mul_f32 v35, v35, v33
    buffer_load_dwordx4 v13, s[24:27], s39 offen offset:3072 lds
    v_cvt_pk_bf16_f32 v34, v34, v35
    v_lshlrev_b32 v35, 16, v34
    v_and_b32 v34, v9, v34
    s_add_u32 s45, s38, 98304
    s_mul_i32 s41, s52, s35
    s_add_u32 s41, s41, s33
    s_add_u32 m0, s45, 0
    s_add_u32 s52, s52, 1
    buffer_load_dwordx4 v14, s[28:31], s41 offen lds
    v_add_f32 v29, v29, v35
    v_add_f32 v29, v29, v34
    v_lshlrev_b32 v32, 16, v84
    buffer_load_dwordx4 v15, s[28:31], s41 offen offset:1024 lds
    v_and_b32 v33, v9, v84
    v_lshlrev_b32 v34, 16, v68
    v_and_b32 v35, v9, v68
    s_add_u32 m0, s45, 2048
    s_add_u32 s41, s41, s34
    buffer_load_dwordx4 v14, s[28:31], s41 offen lds
    v_mul_f32 v34, v34, v32
    v_mul_f32 v35, v35, v33
    v_cvt_pk_bf16_f32 v34, v34, v35
    buffer_load_dwordx4 v15, s[28:31], s41 offen offset:1024 lds
    v_lshlrev_b32 v35, 16, v34
    v_and_b32 v34, v9, v34
    v_add_f32 v28, v28, v35
    s_add_u32 m0, s45, 4096
    s_add_u32 s41, s41, s34
    buffer_load_dwordx4 v14, s[28:31], s41 offen lds
    v_add_f32 v28, v28, v34
    v_lshlrev_b32 v34, 16, v76
    v_and_b32 v35, v9, v76
    buffer_load_dwordx4 v15, s[28:31], s41 offen offset:1024 lds
    v_mul_f32 v34, v34, v32
    v_mul_f32 v35, v35, v33
    v_cvt_pk_bf16_f32 v34, v34, v35
    s_add_u32 m0, s45, 6144
    s_add_u32 s41, s41, s34
    buffer_load_dwordx4 v14, s[28:31], s41 offen lds
    v_lshlrev_b32 v35, 16, v34
    v_and_b32 v34, v9, v34
    v_add_f32 v29, v29, v35
    buffer_load_dwordx4 v15, s[28:31], s41 offen offset:1024 lds
    v_add_f32 v29, v29, v34
    v_lshlrev_b32 v32, 16, v85
    v_and_b32 v33, v9, v85
    s_and_b32 s52, s52, 15
    s_waitcnt vmcnt(12)
    s_barrier
    s_add_u32 m0, s37, 0
    s_lshl_b32 s39, s52, 7
    buffer_load_dwordx4 v10, s[24:27], s39 offen offset:0 lds
    v_lshlrev_b32 v34, 16, v69
    v_and_b32 v35, v9, v69
    buffer_load_dwordx4 v11, s[24:27], s39 offen offset:1024 lds
    v_mul_f32 v34, v34, v32
    v_mul_f32 v35, v35, v33
    v_cvt_pk_bf16_f32 v34, v34, v35
    buffer_load_dwordx4 v12, s[24:27], s39 offen offset:2048 lds
    v_lshlrev_b32 v35, 16, v34
    v_and_b32 v34, v9, v34
    v_add_f32 v28, v28, v35
    buffer_load_dwordx4 v13, s[24:27], s39 offen offset:3072 lds
    v_add_f32 v28, v28, v34
    v_lshlrev_b32 v34, 16, v77
    v_and_b32 v35, v9, v77
    s_add_u32 s45, s38, 0
    s_mul_i32 s41, s52, s35
    s_add_u32 s41, s41, s33
    s_add_u32 m0, s45, 0
    s_add_u32 s52, s52, 1
    buffer_load_dwordx4 v14, s[28:31], s41 offen lds
    v_mul_f32 v34, v34, v32
    v_mul_f32 v35, v35, v33
    v_cvt_pk_bf16_f32 v34, v34, v35
    buffer_load_dwordx4 v15, s[28:31], s41 offen offset:1024 lds
    v_lshlrev_b32 v35, 16, v34
    v_and_b32 v34, v9, v34
    v_add_f32 v29, v29, v35
    s_add_u32 m0, s45, 2048
    s_add_u32 s41, s41, s34
    buffer_load_dwordx4 v14, s[28:31], s41 offen lds
    v_add_f32 v29, v29, v34
    v_lshlrev_b32 v32, 16, v86
    buffer_load_dwordx4 v15, s[28:31], s41 offen offset:1024 lds
    v_and_b32 v33, v9, v86
    v_lshlrev_b32 v34, 16, v70
    v_and_b32 v35, v9, v70
    s_add_u32 m0, s45, 4096
    s_add_u32 s41, s41, s34
    buffer_load_dwordx4 v14, s[28:31], s41 offen lds
    v_mul_f32 v34, v34, v32
    v_mul_f32 v35, v35, v33
    v_cvt_pk_bf16_f32 v34, v34, v35
    buffer_load_dwordx4 v15, s[28:31], s41 offen offset:1024 lds
    v_lshlrev_b32 v35, 16, v34
    v_and_b32 v34, v9, v34
    v_add_f32 v28, v28, v35
    s_add_u32 m0, s45, 6144
    s_add_u32 s41, s41, s34
    buffer_load_dwordx4 v14, s[28:31], s41 offen lds
    v_add_f32 v28, v28, v34
    v_lshlrev_b32 v34, 16, v78
    v_and_b32 v35, v9, v78
    buffer_load_dwordx4 v15, s[28:31], s41 offen offset:1024 lds
    v_mul_f32 v34, v34, v32
    v_mul_f32 v35, v35, v33
    v_cvt_pk_bf16_f32 v34, v34, v35
    s_and_b32 s52, s52, 15
    s_waitcnt vmcnt(12)
    s_barrier
    s_add_u32 m0, s37, 49152
    s_lshl_b32 s39, s52, 7
    buffer_load_dwordx4 v10, s[24:27], s39 offen offset:0 lds
    v_lshlrev_b32 v35, 16, v34
    v_and_b32 v34, v9, v34
    buffer_load_dwordx4 v11, s[24:27], s39 offen offset:1024 lds
    v_add_f32 v29, v29, v35
    v_add_f32 v29, v29, v34
    v_lshlrev_b32 v32, 16, v87
    buffer_load_dwordx4 v12, s[24:27], s39 offen offset:2048 lds
    v_and_b32 v33, v9, v87
    v_lshlrev_b32 v34, 16, v71
    v_and_b32 v35, v9, v71
    buffer_load_dwordx4 v13, s[24:27], s39 offen offset:3072 lds
    v_mul_f32 v34, v34, v32
    v_mul_f32 v35, v35, v33
    v_cvt_pk_bf16_f32 v34, v34, v35
    s_add_u32 s45, s38, 49152
    s_mul_i32 s41, s52, s35
    s_add_u32 s41, s41, s33
    s_add_u32 m0, s45, 0
    s_add_u32 s52, s52, 1
    buffer_load_dwordx4 v14, s[28:31], s41 offen lds
    v_lshlrev_b32 v35, 16, v34
    v_and_b32 v34, v9, v34
    v_add_f32 v28, v28, v35
    buffer_load_dwordx4 v15, s[28:31], s41 offen offset:1024 lds
    v_add_f32 v28, v28, v34
    v_lshlrev_b32 v34, 16, v79
    v_and_b32 v35, v9, v79
    s_add_u32 m0, s45, 2048
    s_add_u32 s41, s41, s34
    buffer_load_dwordx4 v14, s[28:31], s41 offen lds
    v_mul_f32 v34, v34, v32
    v_mul_f32 v35, v35, v33
    v_cvt_pk_bf16_f32 v34, v34, v35
    buffer_load_dwordx4 v15, s[28:31], s41 offen offset:1024 lds
    v_lshlrev_b32 v35, 16, v34
    v_and_b32 v34, v9, v34
    v_add_f32 v29, v29, v35
    s_add_u32 m0, s45, 4096
    s_add_u32 s41, s41, s34
    buffer_load_dwordx4 v14, s[28:31], s41 offen lds
    v_add_f32 v29, v29, v34
    s_nop 1
    v_permlane32_swap_b32 v28, v29
    buffer_load_dwordx4 v15, s[28:31], s41 offen offset:1024 lds
    v_add_f32 v28, v28, v29
    v_mov_b32 v29, v28
    s_nop 1
    s_add_u32 m0, s45, 6144
    s_add_u32 s41, s41, s34
    buffer_load_dwordx4 v14, s[28:31], s41 offen lds
    v_permlane16_swap_b32 v28, v29
    v_add_f32 v28, v28, v29
    s_nop 1
    buffer_load_dwordx4 v15, s[28:31], s41 offen offset:1024 lds
    v_add_f32_dpp v28, v28, v28 row_ror:8 row_mask:0xf bank_mask:0xf
    s_nop 1
    v_add_f32_dpp v28, v28, v28 row_ror:4 row_mask:0xf bank_mask:0xf
    s_and_b32 s52, s52, 15
    s_waitcnt vmcnt(12)
    s_barrier
    s_add_u32 m0, s37, 98304
    s_lshl_b32 s39, s52, 7
    buffer_load_dwordx4 v10, s[24:27], s39 offen offset:0 lds
    s_nop 1
    v_add_f32_dpp v28, v28, v28 row_ror:2 row_mask:0xf bank_mask:0xf
    buffer_load_dwordx4 v11, s[24:27], s39 offen offset:1024 lds
    s_nop 1
    v_add_f32_dpp v28, v28, v28 row_ror:1 row_mask:0xf bank_mask:0xf
    v_cvt_pk_bf16_f32 v28, v28, v28
    buffer_load_dwordx4 v12, s[24:27], s39 offen offset:2048 lds
    v_and_b32 v28, v9, v28
    v_mul_f32 v28, 0xbfb8aa3b, v28
    v_exp_f32 v28, v28
    buffer_load_dwordx4 v13, s[24:27], s39 offen offset:3072 lds
    s_nop 0
    v_add_f32 v28, 1.0, v28
    v_rcp_f32 v28, v28
    s_add_u32 s45, s38, 98304
    s_mul_i32 s41, s52, s35
    s_add_u32 s41, s41, s33
    s_add_u32 m0, s45, 0
    s_add_u32 s52, s52, 1
    buffer_load_dwordx4 v14, s[28:31], s41 offen lds
    s_nop 0
    v_cvt_pk_bf16_f32 v28, v28, v28
    v_and_b32 v28, v9, v28
    buffer_load_dwordx4 v15, s[28:31], s41 offen offset:1024 lds
    s_lshr_b32 s46, s46, 9
    s_add_u32 s46, s46, 39845888
    v_and_b32 v5, 31, v2
    s_add_u32 m0, s45, 2048
    s_add_u32 s41, s41, s34
    buffer_load_dwordx4 v14, s[28:31], s41 offen lds
    v_cmp_eq_u32 vcc, 0, v5
    v_lshrrev_b32 v30, 3, v2
    v_mov_b32 v6, 2147483632
    buffer_load_dwordx4 v15, s[28:31], s41 offen offset:1024 lds
    v_cndmask_b32 v30, v6, v30, vcc
    v_lshlrev_b32 v16, 4, v5
    s_lshl_b32 s21, s16, 11
    s_add_u32 m0, s45, 4096
    s_add_u32 s41, s41, s34
    buffer_load_dwordx4 v14, s[28:31], s41 offen lds
    s_lshl_b32 s3, s18, 9
    s_add_u32 s21, s21, s3
    s_add_u32 s21, s21, 40239104
    buffer_load_dwordx4 v15, s[28:31], s41 offen offset:1024 lds
    v_lshrrev_b32 v7, 3, v2
    v_lshlrev_b32 v7, 14, v7
    v_and_b32 v6, 7, v2
    s_add_u32 m0, s45, 6144
    s_add_u32 s41, s41, s34
    buffer_load_dwordx4 v14, s[28:31], s41 offen lds
    v_lshl_add_u32 v17, v6, 4, v7
    s_lshl_b32 s22, s13, 9
    s_lshl_b32 s3, s18, 7
    buffer_load_dwordx4 v15, s[28:31], s41 offen offset:1024 lds
    s_add_u32 s22, s22, s3
    s_add_u32 s22, s22, 40501248
    s_add_u32 s23, s22, 8192
    s_and_b32 s52, s52, 15
    buffer_store_dword v28, v30, s[4:7], s46 offen sc1
    s_waitcnt vmcnt(13)
    s_barrier
    buffer_load_dwordx4 v[20:23], v16, s[4:7], s21 offen sc1
    buffer_load_dwordx4 v[32:35], v17, s[4:7], s22 offen sc1
    buffer_load_dwordx4 v[36:39], v17, s[4:7], s23 offen sc1
    s_add_u32 m0, s37, 0
    s_lshl_b32 s39, s52, 7
    buffer_load_dwordx4 v10, s[24:27], s39 offen offset:0 lds
    buffer_load_dwordx4 v11, s[24:27], s39 offen offset:1024 lds
    buffer_load_dwordx4 v12, s[24:27], s39 offen offset:2048 lds
    buffer_load_dwordx4 v13, s[24:27], s39 offen offset:3072 lds
    s_add_u32 s45, s38, 0
    s_mul_i32 s41, s52, s35
    s_add_u32 s41, s41, s33
    s_add_u32 m0, s45, 0
    s_add_u32 s52, s52, 1
    buffer_load_dwordx4 v14, s[28:31], s41 offen lds
    buffer_load_dwordx4 v15, s[28:31], s41 offen offset:1024 lds
    s_add_u32 m0, s45, 2048
    s_add_u32 s41, s41, s34
    buffer_load_dwordx4 v14, s[28:31], s41 offen lds
    buffer_load_dwordx4 v15, s[28:31], s41 offen offset:1024 lds
    s_add_u32 m0, s45, 4096
    s_add_u32 s41, s41, s34
    buffer_load_dwordx4 v14, s[28:31], s41 offen lds
    buffer_load_dwordx4 v15, s[28:31], s41 offen offset:1024 lds
    s_add_u32 m0, s45, 6144
    s_add_u32 s41, s41, s34
    buffer_load_dwordx4 v14, s[28:31], s41 offen lds
    buffer_load_dwordx4 v15, s[28:31], s41 offen offset:1024 lds
    s_and_b32 s52, s52, 15
    v_and_b32 v58, 15, v2
    v_lshlrev_b32 v58, 7, v58
    s_lshl_b32 s3, s2, 2
    s_add_u32 s3, s3, s18
    s_lshl_b32 s3, s3, 11
    buffer_load_dword v60, v58, s[8:11], s3 offen
    s_waitcnt vmcnt(13)
    s_barrier
H_p1j14:
    s_mov_b32 s62, 0x8000
L_paysp_6:
    v_xor_b32 v24, s12, v21
    v_xor_b32 v25, s12, v23
    v_xor_b32 v26, s12, v33
    v_xor_b32 v27, s12, v35
    v_or3_b32 v24, v24, v25, v26
    v_xor_b32 v25, s12, v37
    v_xor_b32 v26, s12, v39
    v_or3_b32 v24, v24, v25, v26
    v_or_b32 v24, v24, v27
    v_cmp_ne_u32 vcc, 0, v24
    s_cbranch_vccz L_payok_5
    s_sub_u32 s62, s62, 1
    s_cmp_eq_u32 s62, 0
    s_cbranch_scc1 L_payok_5
    s_sleep 2
    buffer_load_dwordx4 v[20:23], v16, s[4:7], s21 offen sc1
    buffer_load_dwordx4 v[32:35], v17, s[4:7], s22 offen sc1
    buffer_load_dwordx4 v[36:39], v17, s[4:7], s23 offen sc1
    s_waitcnt vmcnt(0)
    s_branch L_paysp_6
L_payok_5:
    v_add_f32 v32, v32, v36
    v_add_f32 v33, v34, v38
    v_mov_b32 v21, v22
    s_lshl_b32 s3, s18, 9
    s_add_u32 s3, s3, 155648
    v_permlane32_swap_b32 v32, v33
    v_add_u32 v16, s3, v16
    v_add_f32 v32, v32, v33
    v_mov_b32 v33, v32
    v_fma_f32 v21, -v20, v20, v21
    v_max_f32 v21, 0, v21
    v_add_f32 v21, 0x3727c5ac, v21
    v_rsq_f32 v24, v21
    v_sqrt_f32 v23, v21
    v_mul_f32 v22, v24, v24
    v_mul_f32 v21, 0xc0135761, v24
    v_mul_f32 v22, v22, v24
    v_mul_f32 v22, 0xbdd2d3e8, v22
    v_permlane16_swap_b32 v32, v33
    ds_write_b128 v16, v[20:23]
    v_add_f32 v32, v32, v33
    s_lshl_b32 s3, s18, 6
    s_add_u32 s3, s3, 157696
    v_add_f32_dpp v32, v32, v32 row_ror:8 row_mask:0xf bank_mask:0xf
    v_lshl_add_u32 v6, v6, 3, s3
    v_lshrrev_b32 v7, 5, v2
    v_lshl_add_u32 v6, v7, 2, v6
    ds_write_b32 v6, v32
    v_mov_b32 v5, 159232
    ds_write_b32 v5, v19
    s_waitcnt vmcnt(1) lgkmcnt(0)
    s_barrier
    s_lshl_b32 s33, s17, 19
    s_lshl_b32 s37, s18, 13
    s_add_u32 s33, s33, s37
    s_add_u32 s33, s33, 4194304
    s_lshl_b32 s34, s17, 14
    s_lshl_b32 s3, s18, 7
    s_add_u32 s34, s34, s3
    s_add_u32 s34, s34, 46137344
    s_lshr_b32 s21, s18, 1
    s_and_b32 s22, s18, 1
    v_and_b32 v3, 15, v2
    s_mul_i32 s14, s16, 0
    v_lshrrev_b32 v5, 1, v2
    v_add_u32 v5, s14, v5
    v_and_b32 v5, 15, v5
    v_lshlrev_b32 v17, 10, v5
    s_sub_u32 s3, s16, s14
    s_and_b32 s3, s3, 15
    s_lshl_b32 s3, s3, 1
    s_lshl_b32 s35, 3, s3
    s_mov_b32 s36, 0
    buffer_load_dword v20, v17, s[4:7], s34 offen sc1
    v_add_u32 v5, 0, v2
    v_mul_u32_u24 v6, 2341, v5
    v_lshrrev_b32 v6, 16, v6
    v_mul_u32_u24 v7, 28, v6
    v_sub_u32 v7, v5, v7
    v_bfe_u32 v5, v6, 2, 1
    v_lshlrev_b32 v5, 1, v5
    v_xor_b32 v7, v7, v5
    v_mul_u32_u24 v6, 7168, v6
    v_lshl_add_u32 v96, v7, 4, v6
    v_add_u32 v5, 64, v2
    v_mul_u32_u24 v6, 2341, v5
    v_lshrrev_b32 v6, 16, v6
    v_mul_u32_u24 v7, 28, v6
    v_sub_u32 v7, v5, v7
    v_bfe_u32 v5, v6, 2, 1
    v_lshlrev_b32 v5, 1, v5
    v_xor_b32 v7, v7, v5
    v_mul_u32_u24 v6, 7168, v6
    v_lshl_add_u32 v97, v7, 4, v6
    v_subrev_u32 v97, 1024, v97
    v_add_u32 v5, 128, v2
    v_mul_u32_u24 v6, 2341, v5
    v_lshrrev_b32 v6, 16, v6
    v_mul_u32_u24 v7, 28, v6
    v_sub_u32 v7, v5, v7
    v_bfe_u32 v5, v6, 2, 1
    v_lshlrev_b32 v5, 1, v5
    v_xor_b32 v7, v7, v5
    v_mul_u32_u24 v6, 7168, v6
    v_lshl_add_u32 v98, v7, 4, v6
    v_subrev_u32 v98, 2048, v98
    v_add_u32 v5, 192, v2
    v_mul_u32_u24 v6, 2341, v5
    v_lshrrev_b32 v6, 16, v6
    v_mul_u32_u24 v7, 28, v6
    v_sub_u32 v7, v5, v7
    v_bfe_u32 v5, v6, 2, 1
    v_lshlrev_b32 v5, 1, v5
    v_xor_b32 v7, v7, v5
    v_mul_u32_u24 v6, 7168, v6
    v_lshl_add_u32 v99, v7, 4, v6
    v_subrev_u32 v99, 3072, v99
    v_add_u32 v5, 256, v2
    v_mul_u32_u24 v6, 2341, v5
    v_lshrrev_b32 v6, 16, v6
    v_mul_u32_u24 v7, 28, v6
    v_sub_u32 v7, v5, v7
    v_bfe_u32 v5, v6, 2, 1
    v_lshlrev_b32 v5, 1, v5
    v_xor_b32 v7, v7, v5
    v_mul_u32_u24 v6, 7168, v6
    v_lshl_add_u32 v100, v7, 4, v6
    v_add_u32 v5, 320, v2
    v_mul_u32_u24 v6, 2341, v5
    v_lshrrev_b32 v6, 16, v6
    v_mul_u32_u24 v7, 28, v6
    v_sub_u32 v7, v5, v7
    v_bfe_u32 v5, v6, 2, 1
    v_lshlrev_b32 v5, 1, v5
    v_xor_b32 v7, v7, v5
    v_mul_u32_u24 v6, 7168, v6
    v_lshl_add_u32 v101, v7, 4, v6
    v_subrev_u32 v101, 1024, v101
    v_add_u32 v5, 384, v2
    v_mul_u32_u24 v6, 2341, v5
    v_lshrrev_b32 v6, 16, v6
    v_mul_u32_u24 v7, 28, v6
    v_sub_u32 v7, v5, v7
    v_bfe_u32 v5, v6, 2, 1
    v_lshlrev_b32 v5, 1, v5
    v_xor_b32 v7, v7, v5
    v_mul_u32_u24 v6, 7168, v6
    v_lshl_add_u32 v102, v7, 4, v6
    v_subrev_u32 v102, 2048, v102
    s_barrier
    s_barrier
    v_lshrrev_b32 v5, 3, v2
    v_and_b32 v6, 7, v2
    v_mul_u32_u24 v7, 7168, v5
    v_cmp_eq_u32 vcc, 7, v6
    v_lshl_add_u32 v30, v6, 4, v7
    v_mov_b32 v7, 2147483632
    s_mul_i32 s47, s16, 458752
    v_cndmask_b32 v30, v30, v7, vcc
    s_mul_i32 s3, s17, 448
    s_add_u32 s47, s47, s3
    s_mul_i32 s3, s18, 112
    s_add_u32 s47, s47, s3
    v_and_b32 v7, 6, v5
    v_xor_b32 v7, v7, v6
    v_lshlrev_b32 v5, 11, v5
    v_lshl_add_u32 v55, v6, 4, v5
    v_lshl_add_u32 v24, v7, 4, v5
    s_lshl_b32 s3, s17, 7
    v_add_u32 v24, s3, v24
    v_add_u32 v25, 15360, v24
    v_add_u32 v26, 30720, v24
    v_add_u32 v27, 46080, v24
    v_lshrrev_b32 v5, 2, v3
    v_and_b32 v6, 3, v3
    v_lshl_add_u32 v7, v4, 2, v5
    v_bfe_u32 v5, v7, 1, 2
    v_lshlrev_b32 v7, 7, v7
    v_lshl_add_u32 v7, v6, 3, v7
    v_lshl_add_u32 v7, v5, 5, v7
    s_lshl_b32 s46, s18, 12
    s_add_u32 s38, s46, 98304
    v_add_u32 v32, 98304, v7
    v_xor_b32 v33, 32, v32
    v_xor_b32 v34, 64, v32
    v_xor_b32 v35, 96, v32
    s_lshl_b32 s43, s16, 18
    s_lshl_b32 s3, s18, 11
    s_add_u32 s43, s43, s3
    s_add_u32 s43, s43, 12582912
    s_lshl_b32 s44, s18, 16
    s_add_u32 m0, s46, 131072
    s_lshl_b32 s41, s17, 7
    buffer_load_dwordx4 v10, s[24:27], s41 offen offset:0 lds
    buffer_load_dwordx4 v11, s[24:27], s41 offen offset:1024 lds
    buffer_load_dwordx4 v12, s[24:27], s41 offen offset:2048 lds
    buffer_load_dwordx4 v13, s[24:27], s41 offen offset:3072 lds
    v_lshlrev_b32 v21, 2, v2
    s_add_u32 s3, s16, 15
    s_and_b32 s3, s3, 15
    s_lshl_b32 s48, s3, 8
    s_add_u32 s48, s48, 46530560
    v_lshlrev_b32 v61, 2, v2
    s_lshl_b32 s49, s16, 8
    s_add_u32 s49, s49, 46530560
    s_add_u32 s3, s16, 1
    s_and_b32 s3, s3, 15
    s_lshl_b32 s50, s3, 8
    s_add_u32 s50, s50, 46530560
    v_and_b32 v5, 31, v2
    v_lshlrev_b32 v23, 2, v5
    v_and_b32 v5, 7, v2
    v_lshlrev_b32 v54, 7, v5
    s_lshl_b32 s3, s2, 2
    s_add_u32 s3, s3, s18
    s_lshl_b32 s63, s3, 10
    s_mov_b32 s28, s74
    s_and_b32 s29, s75, 0xffff
    s_mov_b32 s30, 2097152
    s_mov_b32 s31, 0x20000
    s_mov_b32 s8, s76
    s_and_b32 s9, s77, 0xffff
    s_mov_b32 s10, 7340032
    s_mov_b32 s11, 0x20000
    s_mov_b32 s52, s78
    s_and_b32 s53, s79, 0xffff
    s_mov_b32 s54, 7340032
    s_mov_b32 s55, 0x20000
    s_mov_b32 s56, s68
    s_and_b32 s57, s69, 0xffff
    s_mov_b32 s58, 2097152
    s_mov_b32 s59, 0x20000
    v_and_b32 v5, 1, v3
    v_lshlrev_b32 v5, 4, v5
    v_mov_b32 v6, 0x3f80
    v_lshlrev_b32 v6, v5, v6
    v_lshrrev_b32 v5, 1, v3
    v_cmp_eq_u32 vcc, 0, v5
    v_mov_b32 v108, 0x3f803f80
    s_nop 0
    v_cndmask_b32 v104, 0, v6, vcc
    v_cmp_eq_u32 vcc, 1, v5
    v_mov_b32 v109, 0x3f803f80
    s_nop 0
    v_cndmask_b32 v105, 0, v6, vcc
    v_cmp_eq_u32 vcc, 2, v5
    v_mov_b32 v110, 0x3f803f80
    s_nop 0
    v_cndmask_b32 v106, 0, v6, vcc
    v_cmp_eq_u32 vcc, 3, v5
    v_mov_b32 v111, 0x3f803f80
    s_nop 0
    v_cndmask_b32 v107, 0, v6, vcc
    s_lshl_b32 s42, s18, 5
    v_add_u32 v5, s42, v3
    v_lshlrev_b32 v5, 7, v5
    v_lshrrev_b32 v6, 1, v3
    v_lshrrev_b32 v7, 1, v4
    v_xor_b32 v6, v6, v7
    v_lshl_add_u32 v5, v6, 4, v5
    v_and_b32 v7, 1, v4
    v_lshl_add_u32 v5, v7, 3, v5
    v_add_u32 v10, 131072, v5
    v_xor_b32 v11, 32, v10
    v_xor_b32 v12, 64, v10
    v_xor_b32 v13, 96, v10
    s_setprio 2
    s_andn2_b32 s39, s36, s35
    s_bcnt1_i32_b32 s3, s39
    s_cmp_ge_u32 s3, 2
    s_cbranch_scc1 L_kvok_8
    s_mov_b32 s62, 0x8000
L_kvr_7:
    buffer_load_dword v20, v17, s[4:7], s34 offen sc1
    s_waitcnt vmcnt(0)
    v_cmp_eq_u32 vcc, s12, v20
    s_mov_b32 s36, vcc_lo
    s_andn2_b32 s39, s36, s35
    s_bcnt1_i32_b32 s3, s39
    s_cmp_ge_u32 s3, 2
    s_cbranch_scc1 L_kvok_8
    s_sleep 2
    s_sub_u32 s62, s62, 1
    s_cmp_lg_u32 s62, 0
    s_cbranch_scc1 L_kvr_7
    s_not_b32 s39, s35
L_kvok_8:
    s_ff1_i32_b32 s3, s39
    s_bitset1_b32 s35, s3
    s_bitset0_b32 s39, s3
    s_and_b32 s41, s3, 1
    s_lshl_b32 s41, s41, 12
    s_add_u32 s41, s41, s33
    s_lshr_b32 s3, s3, 1
    s_add_u32 s3, s3, s14
    s_and_b32 s3, s3, 15
    s_add_u32 m0, s37, 65536
    s_lshl_b32 s3, s3, 15
    s_add_u32 s41, s41, s3
    buffer_load_dwordx4 v8, s[4:7], s41 offen offset:0 sc1 lds
    buffer_load_dwordx4 v8, s[4:7], s41 offen offset:1024 sc1 lds
    buffer_load_dwordx4 v8, s[4:7], s41 offen offset:2048 sc1 lds
    buffer_load_dwordx4 v8, s[4:7], s41 offen offset:3072 sc1 lds
    s_ff1_i32_b32 s3, s39
    s_bitset1_b32 s35, s3
    s_bitset0_b32 s39, s3
    s_and_b32 s41, s3, 1
    s_lshl_b32 s41, s41, 12
    s_add_u32 s41, s41, s33
    s_lshr_b32 s3, s3, 1
    s_add_u32 s3, s3, s14
    s_and_b32 s3, s3, 15
    s_add_u32 m0, s37, 69632
    s_lshl_b32 s3, s3, 15
    s_add_u32 s41, s41, s3
    buffer_load_dwordx4 v8, s[4:7], s41 offen offset:0 sc1 lds
    buffer_load_dwordx4 v8, s[4:7], s41 offen offset:1024 sc1 lds
    buffer_load_dwordx4 v8, s[4:7], s41 offen offset:2048 sc1 lds
    buffer_load_dwordx4 v8, s[4:7], s41 offen offset:3072 sc1 lds
    s_andn2_b32 s39, s36, s35
    s_bcnt1_i32_b32 s3, s39
    s_cmp_ge_u32 s3, 2
    s_cbranch_scc1 L_kvok_10
    s_mov_b32 s62, 0x8000
L_kvr_9:
    buffer_load_dword v20, v17, s[4:7], s34 offen sc1
    s_waitcnt vmcnt(0)
    v_cmp_eq_u32 vcc, s12, v20
    s_mov_b32 s36, vcc_lo
    s_andn2_b32 s39, s36, s35
    s_bcnt1_i32_b32 s3, s39
    s_cmp_ge_u32 s3, 2
    s_cbranch_scc1 L_kvok_10
    s_sleep 2
    s_sub_u32 s62, s62, 1
    s_cmp_lg_u32 s62, 0
    s_cbranch_scc1 L_kvr_9
    s_not_b32 s39, s35
L_kvok_10:
    s_ff1_i32_b32 s3, s39
    s_bitset1_b32 s35, s3
    s_bitset0_b32 s39, s3
    s_and_b32 s41, s3, 1
    s_lshl_b32 s41, s41, 12
    s_add_u32 s41, s41, s33
    s_lshr_b32 s3, s3, 1
    s_add_u32 s3, s3, s14
    s_and_b32 s3, s3, 15
    s_add_u32 m0, s37, 0
    s_lshl_b32 s3, s3, 15
    s_add_u32 s41, s41, s3
    buffer_load_dwordx4 v8, s[4:7], s41 offen offset:0 sc1 lds
    buffer_load_dwordx4 v8, s[4:7], s41 offen offset:1024 sc1 lds
    buffer_load_dwordx4 v8, s[4:7], s41 offen offset:2048 sc1 lds
    buffer_load_dwordx4 v8, s[4:7], s41 offen offset:3072 sc1 lds
    s_ff1_i32_b32 s3, s39
    s_bitset1_b32 s35, s3
    s_bitset0_b32 s39, s3
    s_and_b32 s41, s3, 1
    s_lshl_b32 s41, s41, 12
    s_add_u32 s41, s41, s33
    s_lshr_b32 s3, s3, 1
    s_add_u32 s3, s3, s14
    s_and_b32 s3, s3, 15
    s_add_u32 m0, s37, 4096
    s_lshl_b32 s3, s3, 15
    s_add_u32 s41, s41, s3
    buffer_load_dwordx4 v8, s[4:7], s41 offen offset:0 sc1 lds
    buffer_load_dwordx4 v8, s[4:7], s41 offen offset:1024 sc1 lds
    buffer_load_dwordx4 v8, s[4:7], s41 offen offset:2048 sc1 lds
    buffer_load_dwordx4 v8, s[4:7], s41 offen offset:3072 sc1 lds
    buffer_load_dword v20, v17, s[4:7], s34 offen sc1
    ds_read_b64 v[128:129], v10 offset:0
    ds_read_b64 v[130:131], v11 offset:0
    ds_read_b64 v[132:133], v12 offset:0
    ds_read_b64 v[134:135], v13 offset:0
    ds_read_b64 v[136:137], v10 offset:2048
    ds_read_b64 v[138:139], v11 offset:2048
    ds_read_b64 v[140:141], v12 offset:2048
    ds_read_b64 v[142:143], v13 offset:2048
    s_waitcnt lgkmcnt(0)
    v_lshlrev_b32 v64, 16, v128
    v_and_b32 v65, v9, v128
    v_lshlrev_b32 v66, 16, v129
    v_and_b32 v67, v9, v129
    v_lshlrev_b32 v68, 16, v130
    v_and_b32 v69, v9, v130
    v_lshlrev_b32 v70, 16, v131
    v_and_b32 v71, v9, v131
    v_lshlrev_b32 v72, 16, v132
    v_and_b32 v73, v9, v132
    v_lshlrev_b32 v74, 16, v133
    v_and_b32 v75, v9, v133
    v_lshlrev_b32 v76, 16, v134
    v_and_b32 v77, v9, v134
    v_lshlrev_b32 v78, 16, v135
    v_and_b32 v79, v9, v135
    v_lshlrev_b32 v80, 16, v136
    v_and_b32 v81, v9, v136
    v_lshlrev_b32 v82, 16, v137
    v_and_b32 v83, v9, v137
    v_lshlrev_b32 v84, 16, v138
    v_and_b32 v85, v9, v138
    v_lshlrev_b32 v86, 16, v139
    v_and_b32 v87, v9, v139
    v_lshlrev_b32 v88, 16, v140
    v_and_b32 v89, v9, v140
    v_lshlrev_b32 v90, 16, v141
    v_and_b32 v91, v9, v141
    v_lshlrev_b32 v92, 16, v142
    v_and_b32 v93, v9, v142
    v_lshlrev_b32 v94, 16, v143
    v_and_b32 v95, v9, v143
    s_waitcnt vmcnt(9)
    s_barrier
    s_waitcnt vmcnt(0)
    v_cmp_eq_u32 vcc, s12, v20
    s_mov_b32 s36, vcc_lo
    s_andn2_b32 s39, s36, s35
    s_bcnt1_i32_b32 s3, s39
    s_cmp_ge_u32 s3, 2
    s_cbranch_scc1 L_kvok_12
    s_mov_b32 s62, 0x8000
L_kvr_11:
    buffer_load_dword v20, v17, s[4:7], s34 offen sc1
    s_waitcnt vmcnt(0)
    v_cmp_eq_u32 vcc, s12, v20
    s_mov_b32 s36, vcc_lo
    s_andn2_b32 s39, s36, s35
    s_bcnt1_i32_b32 s3, s39
    s_cmp_ge_u32 s3, 2
    s_cbranch_scc1 L_kvok_12
    s_sleep 2
    s_sub_u32 s62, s62, 1
    s_cmp_lg_u32 s62, 0
    s_cbranch_scc1 L_kvr_11
    s_not_b32 s39, s35
L_kvok_12:
    s_ff1_i32_b32 s3, s39
    s_bitset1_b32 s35, s3
    s_bitset0_b32 s39, s3
    s_and_b32 s41, s3, 1
    s_lshl_b32 s41, s41, 12
    s_add_u32 s41, s41, s33
    s_lshr_b32 s3, s3, 1
    s_add_u32 s3, s3, s14
    s_and_b32 s3, s3, 15
    s_add_u32 m0, s37, 32768
    s_lshl_b32 s3, s3, 15
    s_add_u32 s41, s41, s3
    buffer_load_dwordx4 v8, s[4:7], s41 offen offset:0 sc1 lds
    buffer_load_dwordx4 v8, s[4:7], s41 offen offset:1024 sc1 lds
    buffer_load_dwordx4 v8, s[4:7], s41 offen offset:2048 sc1 lds
    buffer_load_dwordx4 v8, s[4:7], s41 offen offset:3072 sc1 lds
    s_ff1_i32_b32 s3, s39
    s_bitset1_b32 s35, s3
    s_bitset0_b32 s39, s3
    s_and_b32 s41, s3, 1
    s_lshl_b32 s41, s41, 12
    s_add_u32 s41, s41, s33
    s_lshr_b32 s3, s3, 1
    s_add_u32 s3, s3, s14
    s_and_b32 s3, s3, 15
    s_add_u32 m0, s37, 36864
    s_lshl_b32 s3, s3, 15
    s_add_u32 s41, s41, s3
    buffer_load_dwordx4 v8, s[4:7], s41 offen offset:0 sc1 lds
    buffer_load_dwordx4 v8, s[4:7], s41 offen offset:1024 sc1 lds
    buffer_load_dwordx4 v8, s[4:7], s41 offen offset:2048 sc1 lds
    buffer_load_dwordx4 v8, s[4:7], s41 offen offset:3072 sc1 lds
    buffer_load_dword v20, v17, s[4:7], s34 offen sc1
    buffer_load_dwordx4 v[224:227], v30, s[8:11], s47 offen
    s_add_u32 s47, s47, 57344
    buffer_load_dwordx4 v[228:231], v30, s[8:11], s47 offen
    s_add_u32 s47, s47, 57344
    buffer_load_dwordx4 v[232:235], v30, s[8:11], s47 offen
    s_add_u32 s47, s47, 57344
    buffer_load_dwordx4 v[236:239], v30, s[8:11], s47 offen
    s_add_u32 s47, s47, 57344
    s_barrier
    s_waitcnt vmcnt(4)
    v_cmp_eq_u32 vcc, s12, v20
    s_mov_b32 s36, vcc_lo
    s_andn2_b32 s39, s36, s35
    s_bcnt1_i32_b32 s3, s39
    s_cmp_ge_u32 s3, 2
    s_cbranch_scc1 L_kvok_14
    s_mov_b32 s62, 0x8000
L_kvr_13:
    buffer_load_dword v20, v17, s[4:7], s34 offen sc1
    s_waitcnt vmcnt(0)
    v_cmp_eq_u32 vcc, s12, v20
    s_mov_b32 s36, vcc_lo
    s_andn2_b32 s39, s36, s35
    s_bcnt1_i32_b32 s3, s39
    s_cmp_ge_u32 s3, 2
    s_cbranch_scc1 L_kvok_14
    s_sleep 2
    s_sub_u32 s62, s62, 1
    s_cmp_lg_u32 s62, 0
    s_cbranch_scc1 L_kvr_13
    s_not_b32 s39, s35
L_kvok_14:
    s_ff1_i32_b32 s3, s39
    s_bitset1_b32 s35, s3
    s_bitset0_b32 s39, s3
    s_and_b32 s41, s3, 1
    s_lshl_b32 s41, s41, 12
    s_add_u32 s41, s41, s33
    s_lshr_b32 s3, s3, 1
    s_add_u32 s3, s3, s14
    s_and_b32 s3, s3, 15
    s_add_u32 m0, s37, 65536
    s_lshl_b32 s3, s3, 15
    s_add_u32 s41, s41, s3
    buffer_load_dwordx4 v8, s[4:7], s41 offen offset:0 sc1 lds
    buffer_load_dwordx4 v8, s[4:7], s41 offen offset:1024 sc1 lds
    buffer_load_dwordx4 v8, s[4:7], s41 offen offset:2048 sc1 lds
    buffer_load_dwordx4 v8, s[4:7], s41 offen offset:3072 sc1 lds
    s_ff1_i32_b32 s3, s39
    s_bitset1_b32 s35, s3
    s_bitset0_b32 s39, s3
    s_and_b32 s41, s3, 1
    s_lshl_b32 s41, s41, 12
    s_add_u32 s41, s41, s33
    s_lshr_b32 s3, s3, 1
    s_add_u32 s3, s3, s14
    s_and_b32 s3, s3, 15
    s_add_u32 m0, s37, 69632
    s_lshl_b32 s3, s3, 15
    s_add_u32 s41, s41, s3
    buffer_load_dwordx4 v8, s[4:7], s41 offen offset:0 sc1 lds
    buffer_load_dwordx4 v8, s[4:7], s41 offen offset:1024 sc1 lds
    buffer_load_dwordx4 v8, s[4:7], s41 offen offset:2048 sc1 lds
    buffer_load_dwordx4 v8, s[4:7], s41 offen offset:3072 sc1 lds
    buffer_load_dword v20, v17, s[4:7], s34 offen sc1
    buffer_load_dwordx4 v[240:243], v30, s[8:11], s47 offen
    s_add_u32 s47, s47, 57344
    buffer_load_dwordx4 v[244:247], v30, s[8:11], s47 offen
    s_add_u32 s47, s47, 57344
    buffer_load_dwordx4 v[248:251], v30, s[8:11], s47 offen
    s_add_u32 s47, s47, 57344
    buffer_load_dwordx4 v[252:255], v30, s[8:11], s47 offen
    s_add_u32 s47, s47, 57344
    s_barrier
    s_waitcnt vmcnt(4)
    v_cmp_eq_u32 vcc, s12, v20
    s_mov_b32 s36, vcc_lo
H_j3:
    s_add_u32 m0, s38, 0
    s_nop 0
    buffer_load_dwordx4 v24, s[28:31], s44 offen offset:0 lds
    buffer_load_dwordx4 v25, s[28:31], s44 offen offset:1024 lds
    buffer_load_dwordx4 v26, s[28:31], s44 offen offset:2048 lds
    buffer_load_dwordx4 v27, s[28:31], s44 offen offset:3072 lds
    s_add_u32 s44, s44, 262144
    s_andn2_b32 s39, s36, s35
    s_bcnt1_i32_b32 s3, s39
    s_cmp_ge_u32 s3, 2
    s_cbranch_scc1 L_kvok_16
    s_mov_b32 s62, 0x8000
L_kvr_15:
    buffer_load_dword v20, v17, s[4:7], s34 offen sc1
    s_waitcnt vmcnt(0)
    v_cmp_eq_u32 vcc, s12, v20
    s_mov_b32 s36, vcc_lo
    s_andn2_b32 s39, s36, s35
    s_bcnt1_i32_b32 s3, s39
    s_cmp_ge_u32 s3, 2
    s_cbranch_scc1 L_kvok_16
    s_sleep 2
    s_sub_u32 s62, s62, 1
    s_cmp_lg_u32 s62, 0
    s_cbranch_scc1 L_kvr_15
    s_not_b32 s39, s35
L_kvok_16:
    s_ff1_i32_b32 s3, s39
    s_bitset1_b32 s35, s3
    s_bitset0_b32 s39, s3
    s_and_b32 s41, s3, 1
    s_lshl_b32 s41, s41, 12
    s_add_u32 s41, s41, s33
    s_lshr_b32 s3, s3, 1
    s_add_u32 s3, s3, s14
    s_and_b32 s3, s3, 15
    s_add_u32 m0, s37, 0
    s_lshl_b32 s3, s3, 15
    s_add_u32 s41, s41, s3
    buffer_load_dwordx4 v8, s[4:7], s41 offen offset:0 sc1 lds
    buffer_load_dwordx4 v8, s[4:7], s41 offen offset:1024 sc1 lds
    buffer_load_dwordx4 v8, s[4:7], s41 offen offset:2048 sc1 lds
    buffer_load_dwordx4 v8, s[4:7], s41 offen offset:3072 sc1 lds
    s_ff1_i32_b32 s3, s39
    s_bitset1_b32 s35, s3
    s_bitset0_b32 s39, s3
    s_and_b32 s41, s3, 1
    s_lshl_b32 s41, s41, 12
    s_add_u32 s41, s41, s33
    s_lshr_b32 s3, s3, 1
    s_add_u32 s3, s3, s14
    s_and_b32 s3, s3, 15
    s_add_u32 m0, s37, 4096
    s_lshl_b32 s3, s3, 15
    s_add_u32 s41, s41, s3
    buffer_load_dwordx4 v8, s[4:7], s41 offen offset:0 sc1 lds
    buffer_load_dwordx4 v8, s[4:7], s41 offen offset:1024 sc1 lds
    buffer_load_dwordx4 v8, s[4:7], s41 offen offset:2048 sc1 lds
    buffer_load_dwordx4 v8, s[4:7], s41 offen offset:3072 sc1 lds
    buffer_load_dword v18, v61, s[4:7], s48 offen sc1
    buffer_load_dword v19, v61, s[4:7], s49 offen sc1
    buffer_load_dword v20, v61, s[4:7], s50 offen sc1
    s_waitcnt vmcnt(0)
    s_mov_b32 s62, 0x8000
L_h1sp_18:
    v_xor_b32 v18, s12, v18
    v_xor_b32 v19, s12, v19
    v_xor_b32 v20, s12, v20
    v_or3_b32 v18, v18, v19, v20
    v_cmp_ne_u32 vcc, 0, v18
    s_cbranch_vccz L_h1ok_17
    s_sub_u32 s62, s62, 1
    s_cmp_eq_u32 s62, 0
    s_cbranch_scc1 L_h1ok_17
    s_sleep 2
    buffer_load_dword v18, v61, s[4:7], s48 offen sc1
    buffer_load_dword v19, v61, s[4:7], s49 offen sc1
    buffer_load_dword v20, v61, s[4:7], s50 offen sc1
    s_waitcnt vmcnt(0)
    s_branch L_h1sp_18
L_h1ok_17:
    s_lshl_b32 s41, s16, 9
    s_lshl_b32 s3, s18, 7
    s_add_u32 s41, s41, s3
    s_add_u32 s41, s41, 39845888
    buffer_load_dword v36, v23, s[4:7], s41 offen sc1
    buffer_load_dwordx4 v[128:131], v8, s[4:7], s43 offen offset:0 sc1
    buffer_load_dwordx4 v[132:135], v8, s[4:7], s43 offen offset:1024 sc1
    s_add_u32 s43, s43, 8192
    buffer_load_dwordx4 v[136:139], v8, s[4:7], s43 offen offset:0 sc1
    buffer_load_dwordx4 v[140:143], v8, s[4:7], s43 offen offset:1024 sc1
    s_add_u32 s43, s43, 8192
    buffer_load_dwordx4 v[144:147], v8, s[4:7], s43 offen offset:0 sc1
    buffer_load_dwordx4 v[148:151], v8, s[4:7], s43 offen offset:1024 sc1
    s_add_u32 s43, s43, 8192
    buffer_load_dwordx4 v[152:155], v8, s[4:7], s43 offen offset:0 sc1
    buffer_load_dwordx4 v[156:159], v8, s[4:7], s43 offen offset:1024 sc1
    s_add_u32 s43, s43, 8192
    s_waitcnt vmcnt(20)
    s_barrier
    s_setprio 0
    ds_read_b64_tr_b16 v[192:193], v32 offset:0
    ds_read_b64_tr_b16 v[194:195], v32 offset:2048
    ds_read_b64_tr_b16 v[196:197], v33 offset:0
    ds_read_b64_tr_b16 v[198:199], v33 offset:2048
    ds_read_b64_tr_b16 v[200:201], v34 offset:0
    ds_read_b64_tr_b16 v[202:203], v34 offset:2048
    ds_read_b64_tr_b16 v[204:205], v35 offset:0
    ds_read_b64_tr_b16 v[206:207], v35 offset:2048
    v_mfma_f32_16x16x32_bf16 v[44:47], v[104:107], v[224:227], 0
    v_mfma_f32_16x16x32_bf16 v[44:47], v[104:107], v[228:231], v[44:47]
    v_mfma_f32_16x16x32_bf16 v[44:47], v[104:107], v[232:235], v[44:47]
    v_mfma_f32_16x16x32_bf16 v[44:47], v[104:107], v[236:239], v[44:47]
    s_add_u32 m0, s38, 16384
    s_nop 0
    buffer_load_dwordx4 v24, s[28:31], s44 offen offset:0 lds
    buffer_load_dwordx4 v25, s[28:31], s44 offen offset:1024 lds
    buffer_load_dwordx4 v26, s[28:31], s44 offen offset:2048 lds
    v_mfma_f32_16x16x32_bf16 v[44:47], v[104:107], v[240:243], v[44:47]
    v_mfma_f32_16x16x32_bf16 v[44:47], v[104:107], v[244:247], v[44:47]
    v_mfma_f32_16x16x32_bf16 v[44:47], v[104:107], v[248:251], v[44:47]
    v_mfma_f32_16x16x32_bf16 v[44:47], v[104:107], v[252:255], v[44:47]
    buffer_load_dwordx4 v27, s[28:31], s44 offen offset:3072 lds
    s_add_u32 s44, s44, 262144
    buffer_load_dwordx4 v[160:163], v8, s[4:7], s43 offen offset:0 sc1
    buffer_load_dwordx4 v[164:167], v8, s[4:7], s43 offen offset:1024 sc1
    ds_read_b64_tr_b16 v[208:209], v32 offset:4096
    ds_read_b64_tr_b16 v[210:211], v32 offset:6144
    ds_read_b64_tr_b16 v[212:213], v33 offset:4096
    ds_read_b64_tr_b16 v[214:215], v33 offset:6144
    ds_read_b64_tr_b16 v[216:217], v34 offset:4096
    ds_read_b64_tr_b16 v[218:219], v34 offset:6144
    ds_read_b64_tr_b16 v[220:221], v35 offset:4096
    ds_read_b64_tr_b16 v[222:223], v35 offset:6144
    s_waitcnt lgkmcnt(8) vmcnt(6)
    v_mfma_f32_16x16x32_bf16 v[64:67], v[192:195], v[128:131], v[64:67]
    v_mfma_f32_16x16x32_bf16 v[80:83], v[192:195], v[132:135], v[80:83]
    v_mfma_f32_16x16x32_bf16 v[84:87], v[196:199], v[132:135], v[84:87]
    v_mfma_f32_16x16x32_bf16 v[68:71], v[196:199], v[128:131], v[68:71]
    s_add_u32 s43, s43, 8192
    buffer_load_dwordx4 v[168:171], v8, s[4:7], s43 offen offset:0 sc1
    buffer_load_dwordx4 v[172:175], v8, s[4:7], s43 offen offset:1024 sc1
    s_add_u32 s43, s43, 8192
    buffer_load_dwordx4 v[176:179], v8, s[4:7], s43 offen offset:0 sc1
    v_mfma_f32_16x16x32_bf16 v[72:75], v[200:203], v[128:131], v[72:75]
    v_mfma_f32_16x16x32_bf16 v[88:91], v[200:203], v[132:135], v[88:91]
    v_mfma_f32_16x16x32_bf16 v[92:95], v[204:207], v[132:135], v[92:95]
    v_mfma_f32_16x16x32_bf16 v[76:79], v[204:207], v[128:131], v[76:79]
    buffer_load_dwordx4 v[180:183], v8, s[4:7], s43 offen offset:1024 sc1
    s_add_u32 s43, s43, 8192
    buffer_load_dwordx4 v[184:187], v8, s[4:7], s43 offen offset:0 sc1
    buffer_load_dwordx4 v[188:191], v8, s[4:7], s43 offen offset:1024 sc1
    ds_read_b64_tr_b16 v[192:193], v32 offset:8192
    ds_read_b64_tr_b16 v[194:195], v32 offset:10240
    ds_read_b64_tr_b16 v[196:197], v33 offset:8192
    ds_read_b64_tr_b16 v[198:199], v33 offset:10240
    ds_read_b64_tr_b16 v[200:201], v34 offset:8192
    ds_read_b64_tr_b16 v[202:203], v34 offset:10240
    ds_read_b64_tr_b16 v[204:205], v35 offset:8192
    ds_read_b64_tr_b16 v[206:207], v35 offset:10240
    s_waitcnt lgkmcnt(8)
    v_mfma_f32_16x16x32_bf16 v[64:67], v[208:211], v[136:139], v[64:67]
    v_mfma_f32_16x16x32_bf16 v[80:83], v[208:211], v[140:143], v[80:83]
    v_mfma_f32_16x16x32_bf16 v[84:87], v[212:215], v[140:143], v[84:87]
    v_mfma_f32_16x16x32_bf16 v[68:71], v[212:215], v[136:139], v[68:71]
    s_add_u32 s43, s43, 8192
    s_andn2_b32 s39, s36, s35
    s_bcnt1_i32_b32 s3, s39
    s_cmp_ge_u32 s3, 2
    s_cbranch_scc1 L_kvok_20
    s_mov_b32 s62, 0x8000
L_kvr_19:
    buffer_load_dword v20, v17, s[4:7], s34 offen sc1
    s_waitcnt vmcnt(0)
    v_cmp_eq_u32 vcc, s12, v20
    s_mov_b32 s36, vcc_lo
    s_andn2_b32 s39, s36, s35
    s_bcnt1_i32_b32 s3, s39
    s_cmp_ge_u32 s3, 2
    s_cbranch_scc1 L_kvok_20
    s_sleep 2
    s_sub_u32 s62, s62, 1
    s_cmp_lg_u32 s62, 0
    s_cbranch_scc1 L_kvr_19
    s_not_b32 s39, s35
L_kvok_20:
    s_ff1_i32_b32 s3, s39
    s_bitset1_b32 s35, s3
    s_bitset0_b32 s39, s3
    s_and_b32 s41, s3, 1
    s_lshl_b32 s41, s41, 12
    s_add_u32 s41, s41, s33
    s_lshr_b32 s3, s3, 1
    s_add_u32 s3, s3, s14
    s_and_b32 s3, s3, 15
    s_add_u32 m0, s37, 32768
    s_lshl_b32 s3, s3, 15
    s_add_u32 s41, s41, s3
    buffer_load_dwordx4 v8, s[4:7], s41 offen offset:0 sc1 lds
    buffer_load_dwordx4 v8, s[4:7], s41 offen offset:1024 sc1 lds
    buffer_load_dwordx4 v8, s[4:7], s41 offen offset:2048 sc1 lds
    v_mfma_f32_16x16x32_bf16 v[72:75], v[216:219], v[136:139], v[72:75]
    v_mfma_f32_16x16x32_bf16 v[88:91], v[216:219], v[140:143], v[88:91]
    v_mfma_f32_16x16x32_bf16 v[92:95], v[220:223], v[140:143], v[92:95]
    v_mfma_f32_16x16x32_bf16 v[76:79], v[220:223], v[136:139], v[76:79]
    buffer_load_dwordx4 v8, s[4:7], s41 offen offset:3072 sc1 lds
    s_ff1_i32_b32 s3, s39
    s_bitset1_b32 s35, s3
    s_bitset0_b32 s39, s3
    s_and_b32 s41, s3, 1
    s_lshl_b32 s41, s41, 12
    s_add_u32 s41, s41, s33
    s_lshr_b32 s3, s3, 1
    s_add_u32 s3, s3, s14
    s_and_b32 s3, s3, 15
    s_add_u32 m0, s37, 36864
    s_lshl_b32 s3, s3, 15
    s_add_u32 s41, s41, s3
    buffer_load_dwordx4 v8, s[4:7], s41 offen offset:0 sc1 lds
    buffer_load_dwordx4 v8, s[4:7], s41 offen offset:1024 sc1 lds
    ds_read_b64_tr_b16 v[208:209], v32 offset:12288
    ds_read_b64_tr_b16 v[210:211], v32 offset:14336
    ds_read_b64_tr_b16 v[212:213], v33 offset:12288
    ds_read_b64_tr_b16 v[214:215], v33 offset:14336
    ds_read_b64_tr_b16 v[216:217], v34 offset:12288
    ds_read_b64_tr_b16 v[218:219], v34 offset:14336
    ds_read_b64_tr_b16 v[220:221], v35 offset:12288
    ds_read_b64_tr_b16 v[222:223], v35 offset:14336
    s_waitcnt lgkmcnt(8)
    v_mfma_f32_16x16x32_bf16 v[64:67], v[192:195], v[144:147], v[64:67]
    v_mfma_f32_16x16x32_bf16 v[80:83], v[192:195], v[148:151], v[80:83]
    v_mfma_f32_16x16x32_bf16 v[84:87], v[196:199], v[148:151], v[84:87]
    v_mfma_f32_16x16x32_bf16 v[68:71], v[196:199], v[144:147], v[68:71]
    buffer_load_dwordx4 v8, s[4:7], s41 offen offset:2048 sc1 lds
    buffer_load_dwordx4 v8, s[4:7], s41 offen offset:3072 sc1 lds
    v_mfma_f32_16x16x32_bf16 v[72:75], v[200:203], v[144:147], v[72:75]
    v_mfma_f32_16x16x32_bf16 v[88:91], v[200:203], v[148:151], v[88:91]
    v_mfma_f32_16x16x32_bf16 v[92:95], v[204:207], v[148:151], v[92:95]
    v_mfma_f32_16x16x32_bf16 v[76:79], v[204:207], v[144:147], v[76:79]
    s_waitcnt vmcnt(16) lgkmcnt(0)
    s_barrier
    ds_read_b64_tr_b16 v[192:193], v32 offset:16384
    ds_read_b64_tr_b16 v[194:195], v32 offset:18432
    ds_read_b64_tr_b16 v[196:197], v33 offset:16384
    ds_read_b64_tr_b16 v[198:199], v33 offset:18432
    ds_read_b64_tr_b16 v[200:201], v34 offset:16384
    ds_read_b64_tr_b16 v[202:203], v34 offset:18432
    ds_read_b64_tr_b16 v[204:205], v35 offset:16384
    ds_read_b64_tr_b16 v[206:207], v35 offset:18432
    v_mfma_f32_16x16x32_bf16 v[64:67], v[208:211], v[152:155], v[64:67]
    v_mfma_f32_16x16x32_bf16 v[80:83], v[208:211], v[156:159], v[80:83]
    v_mfma_f32_16x16x32_bf16 v[84:87], v[212:215], v[156:159], v[84:87]
    v_mfma_f32_16x16x32_bf16 v[68:71], v[212:215], v[152:155], v[68:71]
    s_add_u32 m0, s38, 0
    s_nop 0
    buffer_load_dwordx4 v24, s[28:31], s44 offen offset:0 lds
    buffer_load_dwordx4 v25, s[28:31], s44 offen offset:1024 lds
    buffer_load_dwordx4 v26, s[28:31], s44 offen offset:2048 lds
    v_mfma_f32_16x16x32_bf16 v[72:75], v[216:219], v[152:155], v[72:75]
    v_mfma_f32_16x16x32_bf16 v[88:91], v[216:219], v[156:159], v[88:91]
    v_mfma_f32_16x16x32_bf16 v[92:95], v[220:223], v[156:159], v[92:95]
    v_mfma_f32_16x16x32_bf16 v[76:79], v[220:223], v[152:155], v[76:79]
    buffer_load_dwordx4 v27, s[28:31], s44 offen offset:3072 lds
    s_add_u32 s44, s44, 262144
    buffer_load_dwordx4 v[128:131], v8, s[4:7], s43 offen offset:0 sc1
    buffer_load_dwordx4 v[132:135], v8, s[4:7], s43 offen offset:1024 sc1
    ds_read_b64_tr_b16 v[208:209], v32 offset:20480
    ds_read_b64_tr_b16 v[210:211], v32 offset:22528
    ds_read_b64_tr_b16 v[212:213], v33 offset:20480
    ds_read_b64_tr_b16 v[214:215], v33 offset:22528
    ds_read_b64_tr_b16 v[216:217], v34 offset:20480
    ds_read_b64_tr_b16 v[218:219], v34 offset:22528
    ds_read_b64_tr_b16 v[220:221], v35 offset:20480
    ds_read_b64_tr_b16 v[222:223], v35 offset:22528
    s_waitcnt lgkmcnt(8) vmcnt(14)
    v_mfma_f32_16x16x32_bf16 v[64:67], v[192:195], v[160:163], v[64:67]
    v_mfma_f32_16x16x32_bf16 v[80:83], v[192:195], v[164:167], v[80:83]
    v_mfma_f32_16x16x32_bf16 v[84:87], v[196:199], v[164:167], v[84:87]
    v_mfma_f32_16x16x32_bf16 v[68:71], v[196:199], v[160:163], v[68:71]
    s_add_u32 s43, s43, 8192
    buffer_load_dwordx4 v[136:139], v8, s[4:7], s43 offen offset:0 sc1
    buffer_load_dwordx4 v[140:143], v8, s[4:7], s43 offen offset:1024 sc1
    s_add_u32 s43, s43, 8192
    buffer_load_dwordx4 v[144:147], v8, s[4:7], s43 offen offset:0 sc1
    v_mfma_f32_16x16x32_bf16 v[72:75], v[200:203], v[160:163], v[72:75]
    v_mfma_f32_16x16x32_bf16 v[88:91], v[200:203], v[164:167], v[88:91]
    v_mfma_f32_16x16x32_bf16 v[92:95], v[204:207], v[164:167], v[92:95]
    v_mfma_f32_16x16x32_bf16 v[76:79], v[204:207], v[160:163], v[76:79]
    buffer_load_dwordx4 v[148:151], v8, s[4:7], s43 offen offset:1024 sc1
    s_add_u32 s43, s43, 8192
    buffer_load_dwordx4 v[152:155], v8, s[4:7], s43 offen offset:0 sc1
    buffer_load_dwordx4 v[156:159], v8, s[4:7], s43 offen offset:1024 sc1
    ds_read_b64_tr_b16 v[192:193], v32 offset:24576
    ds_read_b64_tr_b16 v[194:195], v32 offset:26624
    ds_read_b64_tr_b16 v[196:197], v33 offset:24576
    ds_read_b64_tr_b16 v[198:199], v33 offset:26624
    ds_read_b64_tr_b16 v[200:201], v34 offset:24576
    ds_read_b64_tr_b16 v[202:203], v34 offset:26624
    ds_read_b64_tr_b16 v[204:205], v35 offset:24576
    ds_read_b64_tr_b16 v[206:207], v35 offset:26624
    s_waitcnt lgkmcnt(8)
    v_mfma_f32_16x16x32_bf16 v[64:67], v[208:211], v[168:171], v[64:67]
    v_mfma_f32_16x16x32_bf16 v[80:83], v[208:211], v[172:175], v[80:83]
    v_mfma_f32_16x16x32_bf16 v[84:87], v[212:215], v[172:175], v[84:87]
    v_mfma_f32_16x16x32_bf16 v[68:71], v[212:215], v[168:171], v[68:71]
    s_add_u32 s43, s43, 8192
    s_andn2_b32 s39, s36, s35
    s_bcnt1_i32_b32 s3, s39
    s_cmp_ge_u32 s3, 2
    s_cbranch_scc1 L_kvok_22
    s_mov_b32 s62, 0x8000
L_kvr_21:
    buffer_load_dword v20, v17, s[4:7], s34 offen sc1
    s_waitcnt vmcnt(0)
    v_cmp_eq_u32 vcc, s12, v20
    s_mov_b32 s36, vcc_lo
    s_andn2_b32 s39, s36, s35
    s_bcnt1_i32_b32 s3, s39
    s_cmp_ge_u32 s3, 2
    s_cbranch_scc1 L_kvok_22
    s_sleep 2
    s_sub_u32 s62, s62, 1
    s_cmp_lg_u32 s62, 0
    s_cbranch_scc1 L_kvr_21
    s_not_b32 s39, s35
L_kvok_22:
    s_ff1_i32_b32 s3, s39
    s_bitset1_b32 s35, s3
    s_bitset0_b32 s39, s3
    s_and_b32 s41, s3, 1
    s_lshl_b32 s41, s41, 12
    s_add_u32 s41, s41, s33
    s_lshr_b32 s3, s3, 1
    s_add_u32 s3, s3, s14
    s_and_b32 s3, s3, 15
    s_add_u32 m0, s37, 65536
    s_lshl_b32 s3, s3, 15
    s_add_u32 s41, s41, s3
    buffer_load_dwordx4 v8, s[4:7], s41 offen offset:0 sc1 lds
    buffer_load_dwordx4 v8, s[4:7], s41 offen offset:1024 sc1 lds
    buffer_load_dwordx4 v8, s[4:7], s41 offen offset:2048 sc1 lds
    v_mfma_f32_16x16x32_bf16 v[72:75], v[216:219], v[168:171], v[72:75]
    v_mfma_f32_16x16x32_bf16 v[88:91], v[216:219], v[172:175], v[88:91]
    v_mfma_f32_16x16x32_bf16 v[92:95], v[220:223], v[172:175], v[92:95]
    v_mfma_f32_16x16x32_bf16 v[76:79], v[220:223], v[168:171], v[76:79]
    buffer_load_dwordx4 v8, s[4:7], s41 offen offset:3072 sc1 lds
    s_ff1_i32_b32 s3, s39
    s_bitset1_b32 s35, s3
    s_bitset0_b32 s39, s3
    s_and_b32 s41, s3, 1
    s_lshl_b32 s41, s41, 12
    s_add_u32 s41, s41, s33
    s_lshr_b32 s3, s3, 1
    s_add_u32 s3, s3, s14
    s_and_b32 s3, s3, 15
    s_add_u32 m0, s37, 69632
    s_lshl_b32 s3, s3, 15
    s_add_u32 s41, s41, s3
    buffer_load_dwordx4 v8, s[4:7], s41 offen offset:0 sc1 lds
    buffer_load_dwordx4 v8, s[4:7], s41 offen offset:1024 sc1 lds
    ds_read_b64_tr_b16 v[208:209], v32 offset:28672
    ds_read_b64_tr_b16 v[210:211], v32 offset:30720
    ds_read_b64_tr_b16 v[212:213], v33 offset:28672
    ds_read_b64_tr_b16 v[214:215], v33 offset:30720
    ds_read_b64_tr_b16 v[216:217], v34 offset:28672
    ds_read_b64_tr_b16 v[218:219], v34 offset:30720
    ds_read_b64_tr_b16 v[220:221], v35 offset:28672
    ds_read_b64_tr_b16 v[222:223], v35 offset:30720
    s_waitcnt lgkmcnt(8)
    v_mfma_f32_16x16x32_bf16 v[64:67], v[192:195], v[176:179], v[64:67]
    v_mfma_f32_16x16x32_bf16 v[80:83], v[192:195], v[180:183], v[80:83]
    v_mfma_f32_16x16x32_bf16 v[84:87], v[196:199], v[180:183], v[84:87]
    v_mfma_f32_16x16x32_bf16 v[68:71], v[196:199], v[176:179], v[68:71]
    buffer_load_dwordx4 v8, s[4:7], s41 offen offset:2048 sc1 lds
    buffer_load_dwordx4 v8, s[4:7], s41 offen offset:3072 sc1 lds
    v_mfma_f32_16x16x32_bf16 v[72:75], v[200:203], v[176:179], v[72:75]
    v_mfma_f32_16x16x32_bf16 v[88:91], v[200:203], v[180:183], v[88:91]
    v_mfma_f32_16x16x32_bf16 v[92:95], v[204:207], v[180:183], v[92:95]
    v_mfma_f32_16x16x32_bf16 v[76:79], v[204:207], v[176:179], v[76:79]
    s_waitcnt vmcnt(16) lgkmcnt(0)
    s_barrier
    ds_read_b64_tr_b16 v[192:193], v32 offset:0
    ds_read_b64_tr_b16 v[194:195], v32 offset:2048
    ds_read_b64_tr_b16 v[196:197], v33 offset:0
    ds_read_b64_tr_b16 v[198:199], v33 offset:2048
    ds_read_b64_tr_b16 v[200:201], v34 offset:0
    ds_read_b64_tr_b16 v[202:203], v34 offset:2048
    ds_read_b64_tr_b16 v[204:205], v35 offset:0
    ds_read_b64_tr_b16 v[206:207], v35 offset:2048
    v_mfma_f32_16x16x32_bf16 v[64:67], v[208:211], v[184:187], v[64:67]
    v_mfma_f32_16x16x32_bf16 v[80:83], v[208:211], v[188:191], v[80:83]
    v_mfma_f32_16x16x32_bf16 v[84:87], v[212:215], v[188:191], v[84:87]
    v_mfma_f32_16x16x32_bf16 v[68:71], v[212:215], v[184:187], v[68:71]
    s_add_u32 m0, s38, 16384
    s_nop 0
    buffer_load_dwordx4 v24, s[28:31], s44 offen offset:0 lds
    buffer_load_dwordx4 v25, s[28:31], s44 offen offset:1024 lds
    buffer_load_dwordx4 v26, s[28:31], s44 offen offset:2048 lds
    v_mfma_f32_16x16x32_bf16 v[72:75], v[216:219], v[184:187], v[72:75]
    v_mfma_f32_16x16x32_bf16 v[88:91], v[216:219], v[188:191], v[88:91]
    v_mfma_f32_16x16x32_bf16 v[92:95], v[220:223], v[188:191], v[92:95]
    v_mfma_f32_16x16x32_bf16 v[76:79], v[220:223], v[184:187], v[76:79]
    buffer_load_dwordx4 v27, s[28:31], s44 offen offset:3072 lds
    s_add_u32 s44, s44, 262144
    buffer_load_dwordx4 v[160:163], v8, s[4:7], s43 offen offset:0 sc1
    buffer_load_dwordx4 v[164:167], v8, s[4:7], s43 offen offset:1024 sc1
    ds_read_b64_tr_b16 v[208:209], v32 offset:4096
    ds_read_b64_tr_b16 v[210:211], v32 offset:6144
    ds_read_b64_tr_b16 v[212:213], v33 offset:4096
    ds_read_b64_tr_b16 v[214:215], v33 offset:6144
    ds_read_b64_tr_b16 v[216:217], v34 offset:4096
    ds_read_b64_tr_b16 v[218:219], v34 offset:6144
    ds_read_b64_tr_b16 v[220:221], v35 offset:4096
    ds_read_b64_tr_b16 v[222:223], v35 offset:6144
    s_waitcnt lgkmcnt(8) vmcnt(14)
    v_mfma_f32_16x16x32_bf16 v[64:67], v[192:195], v[128:131], v[64:67]
    v_mfma_f32_16x16x32_bf16 v[80:83], v[192:195], v[132:135], v[80:83]
    v_mfma_f32_16x16x32_bf16 v[84:87], v[196:199], v[132:135], v[84:87]
    v_mfma_f32_16x16x32_bf16 v[68:71], v[196:199], v[128:131], v[68:71]
    s_add_u32 s43, s43, 8192
    buffer_load_dwordx4 v[168:171], v8, s[4:7], s43 offen offset:0 sc1
    buffer_load_dwordx4 v[172:175], v8, s[4:7], s43 offen offset:1024 sc1
    s_add_u32 s43, s43, 8192
    buffer_load_dwordx4 v[176:179], v8, s[4:7], s43 offen offset:0 sc1
    v_mfma_f32_16x16x32_bf16 v[72:75], v[200:203], v[128:131], v[72:75]
    v_mfma_f32_16x16x32_bf16 v[88:91], v[200:203], v[132:135], v[88:91]
    v_mfma_f32_16x16x32_bf16 v[92:95], v[204:207], v[132:135], v[92:95]
    v_mfma_f32_16x16x32_bf16 v[76:79], v[204:207], v[128:131], v[76:79]
    buffer_load_dwordx4 v[180:183], v8, s[4:7], s43 offen offset:1024 sc1
    s_add_u32 s43, s43, 8192
    buffer_load_dwordx4 v[184:187], v8, s[4:7], s43 offen offset:0 sc1
    buffer_load_dwordx4 v[188:191], v8, s[4:7], s43 offen offset:1024 sc1
    ds_read_b64_tr_b16 v[192:193], v32 offset:8192
    ds_read_b64_tr_b16 v[194:195], v32 offset:10240
    ds_read_b64_tr_b16 v[196:197], v33 offset:8192
    ds_read_b64_tr_b16 v[198:199], v33 offset:10240
    ds_read_b64_tr_b16 v[200:201], v34 offset:8192
    ds_read_b64_tr_b16 v[202:203], v34 offset:10240
    ds_read_b64_tr_b16 v[204:205], v35 offset:8192
    ds_read_b64_tr_b16 v[206:207], v35 offset:10240
    s_waitcnt lgkmcnt(8)
    v_mfma_f32_16x16x32_bf16 v[64:67], v[208:211], v[136:139], v[64:67]
    v_mfma_f32_16x16x32_bf16 v[80:83], v[208:211], v[140:143], v[80:83]
    v_mfma_f32_16x16x32_bf16 v[84:87], v[212:215], v[140:143], v[84:87]
    v_mfma_f32_16x16x32_bf16 v[68:71], v[212:215], v[136:139], v[68:71]
    s_add_u32 s43, s43, 8192
    s_andn2_b32 s39, s36, s35
    s_bcnt1_i32_b32 s3, s39
    s_cmp_ge_u32 s3, 2
    s_cbranch_scc1 L_kvok_24
    s_mov_b32 s62, 0x8000
L_kvr_23:
    buffer_load_dword v20, v17, s[4:7], s34 offen sc1
    s_waitcnt vmcnt(0)
    v_cmp_eq_u32 vcc, s12, v20
    s_mov_b32 s36, vcc_lo
    s_andn2_b32 s39, s36, s35
    s_bcnt1_i32_b32 s3, s39
    s_cmp_ge_u32 s3, 2
    s_cbranch_scc1 L_kvok_24
    s_sleep 2
    s_sub_u32 s62, s62, 1
    s_cmp_lg_u32 s62, 0
    s_cbranch_scc1 L_kvr_23
    s_not_b32 s39, s35
L_kvok_24:
    s_ff1_i32_b32 s3, s39
    s_bitset1_b32 s35, s3
    s_bitset0_b32 s39, s3
    s_and_b32 s41, s3, 1
    s_lshl_b32 s41, s41, 12
    s_add_u32 s41, s41, s33
    s_lshr_b32 s3, s3, 1
    s_add_u32 s3, s3, s14
    s_and_b32 s3, s3, 15
    s_add_u32 m0, s37, 0
    s_lshl_b32 s3, s3, 15
    s_add_u32 s41, s41, s3
    buffer_load_dwordx4 v8, s[4:7], s41 offen offset:0 sc1 lds
    buffer_load_dwordx4 v8, s[4:7], s41 offen offset:1024 sc1 lds
    buffer_load_dwordx4 v8, s[4:7], s41 offen offset:2048 sc1 lds
    v_mfma_f32_16x16x32_bf16 v[72:75], v[216:219], v[136:139], v[72:75]
    v_mfma_f32_16x16x32_bf16 v[88:91], v[216:219], v[140:143], v[88:91]
    v_mfma_f32_16x16x32_bf16 v[92:95], v[220:223], v[140:143], v[92:95]
    v_mfma_f32_16x16x32_bf16 v[76:79], v[220:223], v[136:139], v[76:79]
    buffer_load_dwordx4 v8, s[4:7], s41 offen offset:3072 sc1 lds
    s_ff1_i32_b32 s3, s39
    s_bitset1_b32 s35, s3
    s_bitset0_b32 s39, s3
    s_and_b32 s41, s3, 1
    s_lshl_b32 s41, s41, 12
    s_add_u32 s41, s41, s33
    s_lshr_b32 s3, s3, 1
    s_add_u32 s3, s3, s14
    s_and_b32 s3, s3, 15
    s_add_u32 m0, s37, 4096
    s_lshl_b32 s3, s3, 15
    s_add_u32 s41, s41, s3
    buffer_load_dwordx4 v8, s[4:7], s41 offen offset:0 sc1 lds
    buffer_load_dwordx4 v8, s[4:7], s41 offen offset:1024 sc1 lds
    ds_read_b64_tr_b16 v[208:209], v32 offset:12288
    ds_read_b64_tr_b16 v[210:211], v32 offset:14336
    ds_read_b64_tr_b16 v[212:213], v33 offset:12288
    ds_read_b64_tr_b16 v[214:215], v33 offset:14336
    ds_read_b64_tr_b16 v[216:217], v34 offset:12288
    ds_read_b64_tr_b16 v[218:219], v34 offset:14336
    ds_read_b64_tr_b16 v[220:221], v35 offset:12288
    ds_read_b64_tr_b16 v[222:223], v35 offset:14336
    s_waitcnt lgkmcnt(8)
    v_mfma_f32_16x16x32_bf16 v[64:67], v[192:195], v[144:147], v[64:67]
    v_mfma_f32_16x16x32_bf16 v[80:83], v[192:195], v[148:151], v[80:83]
    v_mfma_f32_16x16x32_bf16 v[84:87], v[196:199], v[148:151], v[84:87]
    v_mfma_f32_16x16x32_bf16 v[68:71], v[196:199], v[144:147], v[68:71]
    buffer_load_dwordx4 v8, s[4:7], s41 offen offset:2048 sc1 lds
    buffer_load_dwordx4 v8, s[4:7], s41 offen offset:3072 sc1 lds
    v_mfma_f32_16x16x32_bf16 v[72:75], v[200:203], v[144:147], v[72:75]
    v_mfma_f32_16x16x32_bf16 v[88:91], v[200:203], v[148:151], v[88:91]
    v_mfma_f32_16x16x32_bf16 v[92:95], v[204:207], v[148:151], v[92:95]
    v_mfma_f32_16x16x32_bf16 v[76:79], v[204:207], v[144:147], v[76:79]
    s_waitcnt vmcnt(16) lgkmcnt(0)
    s_barrier
    ds_read_b64_tr_b16 v[192:193], v32 offset:16384
    ds_read_b64_tr_b16 v[194:195], v32 offset:18432
    ds_read_b64_tr_b16 v[196:197], v33 offset:16384
    ds_read_b64_tr_b16 v[198:199], v33 offset:18432
    ds_read_b64_tr_b16 v[200:201], v34 offset:16384
    ds_read_b64_tr_b16 v[202:203], v34 offset:18432
    ds_read_b64_tr_b16 v[204:205], v35 offset:16384
    ds_read_b64_tr_b16 v[206:207], v35 offset:18432
    v_mfma_f32_16x16x32_bf16 v[64:67], v[208:211], v[152:155], v[64:67]
    v_mfma_f32_16x16x32_bf16 v[80:83], v[208:211], v[156:159], v[80:83]
    v_mfma_f32_16x16x32_bf16 v[84:87], v[212:215], v[156:159], v[84:87]
    v_mfma_f32_16x16x32_bf16 v[68:71], v[212:215], v[152:155], v[68:71]
    s_add_u32 m0, s38, 0
    s_nop 0
    buffer_load_dwordx4 v24, s[28:31], s44 offen offset:0 lds
    buffer_load_dwordx4 v25, s[28:31], s44 offen offset:1024 lds
    buffer_load_dwordx4 v26, s[28:31], s44 offen offset:2048 lds
    v_mfma_f32_16x16x32_bf16 v[72:75], v[216:219], v[152:155], v[72:75]
    v_mfma_f32_16x16x32_bf16 v[88:91], v[216:219], v[156:159], v[88:91]
    v_mfma_f32_16x16x32_bf16 v[92:95], v[220:223], v[156:159], v[92:95]
    v_mfma_f32_16x16x32_bf16 v[76:79], v[220:223], v[152:155], v[76:79]
    buffer_load_dwordx4 v27, s[28:31], s44 offen offset:3072 lds
    s_add_u32 s44, s44, 262144
    buffer_load_dwordx4 v[128:131], v8, s[4:7], s43 offen offset:0 sc1
    buffer_load_dwordx4 v[132:135], v8, s[4:7], s43 offen offset:1024 sc1
    ds_read_b64_tr_b16 v[208:209], v32 offset:20480
    ds_read_b64_tr_b16 v[210:211], v32 offset:22528
    ds_read_b64_tr_b16 v[212:213], v33 offset:20480
    ds_read_b64_tr_b16 v[214:215], v33 offset:22528
    ds_read_b64_tr_b16 v[216:217], v34 offset:20480
    ds_read_b64_tr_b16 v[218:219], v34 offset:22528
    ds_read_b64_tr_b16 v[220:221], v35 offset:20480
    ds_read_b64_tr_b16 v[222:223], v35 offset:22528
    s_waitcnt lgkmcnt(8) vmcnt(14)
    v_mfma_f32_16x16x32_bf16 v[64:67], v[192:195], v[160:163], v[64:67]
    v_mfma_f32_16x16x32_bf16 v[80:83], v[192:195], v[164:167], v[80:83]
    v_mfma_f32_16x16x32_bf16 v[84:87], v[196:199], v[164:167], v[84:87]
    v_mfma_f32_16x16x32_bf16 v[68:71], v[196:199], v[160:163], v[68:71]
    s_add_u32 s43, s43, 8192
    buffer_load_dwordx4 v[136:139], v8, s[4:7], s43 offen offset:0 sc1
    buffer_load_dwordx4 v[140:143], v8, s[4:7], s43 offen offset:1024 sc1
    s_add_u32 s43, s43, 8192
    buffer_load_dwordx4 v[144:147], v8, s[4:7], s43 offen offset:0 sc1
    v_mfma_f32_16x16x32_bf16 v[72:75], v[200:203], v[160:163], v[72:75]
    v_mfma_f32_16x16x32_bf16 v[88:91], v[200:203], v[164:167], v[88:91]
    v_mfma_f32_16x16x32_bf16 v[92:95], v[204:207], v[164:167], v[92:95]
    v_mfma_f32_16x16x32_bf16 v[76:79], v[204:207], v[160:163], v[76:79]
    buffer_load_dwordx4 v[148:151], v8, s[4:7], s43 offen offset:1024 sc1
    s_add_u32 s43, s43, 8192
    buffer_load_dwordx4 v[152:155], v8, s[4:7], s43 offen offset:0 sc1
    buffer_load_dwordx4 v[156:159], v8, s[4:7], s43 offen offset:1024 sc1
    ds_read_b64_tr_b16 v[192:193], v32 offset:24576
    ds_read_b64_tr_b16 v[194:195], v32 offset:26624
    ds_read_b64_tr_b16 v[196:197], v33 offset:24576
    ds_read_b64_tr_b16 v[198:199], v33 offset:26624
    ds_read_b64_tr_b16 v[200:201], v34 offset:24576
    ds_read_b64_tr_b16 v[202:203], v34 offset:26624
    ds_read_b64_tr_b16 v[204:205], v35 offset:24576
    ds_read_b64_tr_b16 v[206:207], v35 offset:26624
    s_waitcnt lgkmcnt(8)
    v_mfma_f32_16x16x32_bf16 v[64:67], v[208:211], v[168:171], v[64:67]
    v_mfma_f32_16x16x32_bf16 v[80:83], v[208:211], v[172:175], v[80:83]
    v_mfma_f32_16x16x32_bf16 v[84:87], v[212:215], v[172:175], v[84:87]
    v_mfma_f32_16x16x32_bf16 v[68:71], v[212:215], v[168:171], v[68:71]
    s_add_u32 s43, s43, 8192
    s_andn2_b32 s39, s36, s35
    s_bcnt1_i32_b32 s3, s39
    s_cmp_ge_u32 s3, 2
    s_cbranch_scc1 L_kvok_26
    s_mov_b32 s62, 0x8000
L_kvr_25:
    buffer_load_dword v20, v17, s[4:7], s34 offen sc1
    s_waitcnt vmcnt(0)
    v_cmp_eq_u32 vcc, s12, v20
    s_mov_b32 s36, vcc_lo
    s_andn2_b32 s39, s36, s35
    s_bcnt1_i32_b32 s3, s39
    s_cmp_ge_u32 s3, 2
    s_cbranch_scc1 L_kvok_26
    s_sleep 2
    s_sub_u32 s62, s62, 1
    s_cmp_lg_u32 s62, 0
    s_cbranch_scc1 L_kvr_25
    s_not_b32 s39, s35
L_kvok_26:
    s_ff1_i32_b32 s3, s39
    s_bitset1_b32 s35, s3
    s_bitset0_b32 s39, s3
    s_and_b32 s41, s3, 1
    s_lshl_b32 s41, s41, 12
    s_add_u32 s41, s41, s33
    s_lshr_b32 s3, s3, 1
    s_add_u32 s3, s3, s14
    s_and_b32 s3, s3, 15
    s_add_u32 m0, s37, 32768
    s_lshl_b32 s3, s3, 15
    s_add_u32 s41, s41, s3
    buffer_load_dwordx4 v8, s[4:7], s41 offen offset:0 sc1 lds
    buffer_load_dwordx4 v8, s[4:7], s41 offen offset:1024 sc1 lds
    buffer_load_dwordx4 v8, s[4:7], s41 offen offset:2048 sc1 lds
    v_mfma_f32_16x16x32_bf16 v[72:75], v[216:219], v[168:171], v[72:75]
    v_mfma_f32_16x16x32_bf16 v[88:91], v[216:219], v[172:175], v[88:91]
    v_mfma_f32_16x16x32_bf16 v[92:95], v[220:223], v[172:175], v[92:95]
    v_mfma_f32_16x16x32_bf16 v[76:79], v[220:223], v[168:171], v[76:79]
    buffer_load_dwordx4 v8, s[4:7], s41 offen offset:3072 sc1 lds
    s_ff1_i32_b32 s3, s39
    s_bitset1_b32 s35, s3
    s_bitset0_b32 s39, s3
    s_and_b32 s41, s3, 1
    s_lshl_b32 s41, s41, 12
    s_add_u32 s41, s41, s33
    s_lshr_b32 s3, s3, 1
    s_add_u32 s3, s3, s14
    s_and_b32 s3, s3, 15
    s_add_u32 m0, s37, 36864
    s_lshl_b32 s3, s3, 15
    s_add_u32 s41, s41, s3
    buffer_load_dwordx4 v8, s[4:7], s41 offen offset:0 sc1 lds
    buffer_load_dwordx4 v8, s[4:7], s41 offen offset:1024 sc1 lds
    ds_read_b64_tr_b16 v[208:209], v32 offset:28672
    ds_read_b64_tr_b16 v[210:211], v32 offset:30720
    ds_read_b64_tr_b16 v[212:213], v33 offset:28672
    ds_read_b64_tr_b16 v[214:215], v33 offset:30720
    ds_read_b64_tr_b16 v[216:217], v34 offset:28672
    ds_read_b64_tr_b16 v[218:219], v34 offset:30720
    ds_read_b64_tr_b16 v[220:221], v35 offset:28672
    ds_read_b64_tr_b16 v[222:223], v35 offset:30720
    s_waitcnt lgkmcnt(8)
    v_mfma_f32_16x16x32_bf16 v[64:67], v[192:195], v[176:179], v[64:67]
    v_mfma_f32_16x16x32_bf16 v[80:83], v[192:195], v[180:183], v[80:83]
    v_mfma_f32_16x16x32_bf16 v[84:87], v[196:199], v[180:183], v[84:87]
    v_mfma_f32_16x16x32_bf16 v[68:71], v[196:199], v[176:179], v[68:71]
    buffer_load_dwordx4 v8, s[4:7], s41 offen offset:2048 sc1 lds
    buffer_load_dwordx4 v8, s[4:7], s41 offen offset:3072 sc1 lds
    v_mfma_f32_16x16x32_bf16 v[72:75], v[200:203], v[176:179], v[72:75]
    v_mfma_f32_16x16x32_bf16 v[88:91], v[200:203], v[180:183], v[88:91]
    v_mfma_f32_16x16x32_bf16 v[92:95], v[204:207], v[180:183], v[92:95]
    v_mfma_f32_16x16x32_bf16 v[76:79], v[204:207], v[176:179], v[76:79]
    s_waitcnt vmcnt(16) lgkmcnt(0)
    s_barrier
    ds_read_b64_tr_b16 v[192:193], v32 offset:0
    ds_read_b64_tr_b16 v[194:195], v32 offset:2048
    ds_read_b64_tr_b16 v[196:197], v33 offset:0
    ds_read_b64_tr_b16 v[198:199], v33 offset:2048
    ds_read_b64_tr_b16 v[200:201], v34 offset:0
    ds_read_b64_tr_b16 v[202:203], v34 offset:2048
    ds_read_b64_tr_b16 v[204:205], v35 offset:0
    ds_read_b64_tr_b16 v[206:207], v35 offset:2048
    v_mfma_f32_16x16x32_bf16 v[64:67], v[208:211], v[184:187], v[64:67]
    v_mfma_f32_16x16x32_bf16 v[80:83], v[208:211], v[188:191], v[80:83]
    v_mfma_f32_16x16x32_bf16 v[84:87], v[212:215], v[188:191], v[84:87]
    v_mfma_f32_16x16x32_bf16 v[68:71], v[212:215], v[184:187], v[68:71]
    s_add_u32 m0, s38, 16384
    s_nop 0
    buffer_load_dwordx4 v24, s[28:31], s44 offen offset:0 lds
    buffer_load_dwordx4 v25, s[28:31], s44 offen offset:1024 lds
    buffer_load_dwordx4 v26, s[28:31], s44 offen offset:2048 lds
    v_mfma_f32_16x16x32_bf16 v[72:75], v[216:219], v[184:187], v[72:75]
    v_mfma_f32_16x16x32_bf16 v[88:91], v[216:219], v[188:191], v[88:91]
    v_mfma_f32_16x16x32_bf16 v[92:95], v[220:223], v[188:191], v[92:95]
    v_mfma_f32_16x16x32_bf16 v[76:79], v[220:223], v[184:187], v[76:79]
    buffer_load_dwordx4 v27, s[28:31], s44 offen offset:3072 lds
    s_add_u32 s44, s44, 262144
    buffer_load_dwordx4 v[160:163], v8, s[4:7], s43 offen offset:0 sc1
    buffer_load_dwordx4 v[164:167], v8, s[4:7], s43 offen offset:1024 sc1
    ds_read_b64_tr_b16 v[208:209], v32 offset:4096
    ds_read_b64_tr_b16 v[210:211], v32 offset:6144
    ds_read_b64_tr_b16 v[212:213], v33 offset:4096
    ds_read_b64_tr_b16 v[214:215], v33 offset:6144
    ds_read_b64_tr_b16 v[216:217], v34 offset:4096
    ds_read_b64_tr_b16 v[218:219], v34 offset:6144
    ds_read_b64_tr_b16 v[220:221], v35 offset:4096
    ds_read_b64_tr_b16 v[222:223], v35 offset:6144
    s_waitcnt lgkmcnt(8) vmcnt(14)
    v_mfma_f32_16x16x32_bf16 v[64:67], v[192:195], v[128:131], v[64:67]
    v_mfma_f32_16x16x32_bf16 v[80:83], v[192:195], v[132:135], v[80:83]
    v_mfma_f32_16x16x32_bf16 v[84:87], v[196:199], v[132:135], v[84:87]
    v_mfma_f32_16x16x32_bf16 v[68:71], v[196:199], v[128:131], v[68:71]
    s_add_u32 s43, s43, 8192
    buffer_load_dwordx4 v[168:171], v8, s[4:7], s43 offen offset:0 sc1
    buffer_load_dwordx4 v[172:175], v8, s[4:7], s43 offen offset:1024 sc1
    s_add_u32 s43, s43, 8192
    buffer_load_dwordx4 v[176:179], v8, s[4:7], s43 offen offset:0 sc1
    v_mfma_f32_16x16x32_bf16 v[72:75], v[200:203], v[128:131], v[72:75]
    v_mfma_f32_16x16x32_bf16 v[88:91], v[200:203], v[132:135], v[88:91]
    v_mfma_f32_16x16x32_bf16 v[92:95], v[204:207], v[132:135], v[92:95]
    v_mfma_f32_16x16x32_bf16 v[76:79], v[204:207], v[128:131], v[76:79]
    buffer_load_dwordx4 v[180:183], v8, s[4:7], s43 offen offset:1024 sc1
    s_add_u32 s43, s43, 8192
    buffer_load_dwordx4 v[184:187], v8, s[4:7], s43 offen offset:0 sc1
    buffer_load_dwordx4 v[188:191], v8, s[4:7], s43 offen offset:1024 sc1
    ds_read_b64_tr_b16 v[192:193], v32 offset:8192
    ds_read_b64_tr_b16 v[194:195], v32 offset:10240
    ds_read_b64_tr_b16 v[196:197], v33 offset:8192
    ds_read_b64_tr_b16 v[198:199], v33 offset:10240
    ds_read_b64_tr_b16 v[200:201], v34 offset:8192
    ds_read_b64_tr_b16 v[202:203], v34 offset:10240
    ds_read_b64_tr_b16 v[204:205], v35 offset:8192
    ds_read_b64_tr_b16 v[206:207], v35 offset:10240
    s_waitcnt lgkmcnt(8)
    v_mfma_f32_16x16x32_bf16 v[64:67], v[208:211], v[136:139], v[64:67]
    v_mfma_f32_16x16x32_bf16 v[80:83], v[208:211], v[140:143], v[80:83]
    v_mfma_f32_16x16x32_bf16 v[84:87], v[212:215], v[140:143], v[84:87]
    v_mfma_f32_16x16x32_bf16 v[68:71], v[212:215], v[136:139], v[68:71]
    s_add_u32 s43, s43, 8192
    s_andn2_b32 s39, s36, s35
    s_bcnt1_i32_b32 s3, s39
    s_cmp_ge_u32 s3, 2
    s_cbranch_scc1 L_kvok_28
    s_mov_b32 s62, 0x8000
L_kvr_27:
    buffer_load_dword v20, v17, s[4:7], s34 offen sc1
    s_waitcnt vmcnt(0)
    v_cmp_eq_u32 vcc, s12, v20
    s_mov_b32 s36, vcc_lo
    s_andn2_b32 s39, s36, s35
    s_bcnt1_i32_b32 s3, s39
    s_cmp_ge_u32 s3, 2
    s_cbranch_scc1 L_kvok_28
    s_sleep 2
    s_sub_u32 s62, s62, 1
    s_cmp_lg_u32 s62, 0
    s_cbranch_scc1 L_kvr_27
    s_not_b32 s39, s35
L_kvok_28:
    s_ff1_i32_b32 s3, s39
    s_bitset1_b32 s35, s3
    s_bitset0_b32 s39, s3
    s_and_b32 s41, s3, 1
    s_lshl_b32 s41, s41, 12
    s_add_u32 s41, s41, s33
    s_lshr_b32 s3, s3, 1
    s_add_u32 s3, s3, s14
    s_and_b32 s3, s3, 15
    s_add_u32 m0, s37, 65536
    s_lshl_b32 s3, s3, 15
    s_add_u32 s41, s41, s3
    buffer_load_dwordx4 v8, s[4:7], s41 offen offset:0 sc1 lds
    buffer_load_dwordx4 v8, s[4:7], s41 offen offset:1024 sc1 lds
    buffer_load_dwordx4 v8, s[4:7], s41 offen offset:2048 sc1 lds
    v_mfma_f32_16x16x32_bf16 v[72:75], v[216:219], v[136:139], v[72:75]
    v_mfma_f32_16x16x32_bf16 v[88:91], v[216:219], v[140:143], v[88:91]
    v_mfma_f32_16x16x32_bf16 v[92:95], v[220:223], v[140:143], v[92:95]
    v_mfma_f32_16x16x32_bf16 v[76:79], v[220:223], v[136:139], v[76:79]
    buffer_load_dwordx4 v8, s[4:7], s41 offen offset:3072 sc1 lds
    s_ff1_i32_b32 s3, s39
    s_bitset1_b32 s35, s3
    s_bitset0_b32 s39, s3
    s_and_b32 s41, s3, 1
    s_lshl_b32 s41, s41, 12
    s_add_u32 s41, s41, s33
    s_lshr_b32 s3, s3, 1
    s_add_u32 s3, s3, s14
    s_and_b32 s3, s3, 15
    s_add_u32 m0, s37, 69632
    s_lshl_b32 s3, s3, 15
    s_add_u32 s41, s41, s3
    buffer_load_dwordx4 v8, s[4:7], s41 offen offset:0 sc1 lds
    buffer_load_dwordx4 v8, s[4:7], s41 offen offset:1024 sc1 lds
    ds_read_b64_tr_b16 v[208:209], v32 offset:12288
    ds_read_b64_tr_b16 v[210:211], v32 offset:14336
    ds_read_b64_tr_b16 v[212:213], v33 offset:12288
    ds_read_b64_tr_b16 v[214:215], v33 offset:14336
    ds_read_b64_tr_b16 v[216:217], v34 offset:12288
    ds_read_b64_tr_b16 v[218:219], v34 offset:14336
    ds_read_b64_tr_b16 v[220:221], v35 offset:12288
    ds_read_b64_tr_b16 v[222:223], v35 offset:14336
    s_waitcnt lgkmcnt(8)
    v_mfma_f32_16x16x32_bf16 v[64:67], v[192:195], v[144:147], v[64:67]
    v_mfma_f32_16x16x32_bf16 v[80:83], v[192:195], v[148:151], v[80:83]
    v_mfma_f32_16x16x32_bf16 v[84:87], v[196:199], v[148:151], v[84:87]
    v_mfma_f32_16x16x32_bf16 v[68:71], v[196:199], v[144:147], v[68:71]
    buffer_load_dwordx4 v8, s[4:7], s41 offen offset:2048 sc1 lds
    buffer_load_dwordx4 v8, s[4:7], s41 offen offset:3072 sc1 lds
    v_mfma_f32_16x16x32_bf16 v[72:75], v[200:203], v[144:147], v[72:75]
    v_mfma_f32_16x16x32_bf16 v[88:91], v[200:203], v[148:151], v[88:91]
    v_mfma_f32_16x16x32_bf16 v[92:95], v[204:207], v[148:151], v[92:95]
    v_mfma_f32_16x16x32_bf16 v[76:79], v[204:207], v[144:147], v[76:79]
    s_waitcnt vmcnt(16) lgkmcnt(0)
    s_barrier
    ds_read_b64_tr_b16 v[192:193], v32 offset:16384
    ds_read_b64_tr_b16 v[194:195], v32 offset:18432
    ds_read_b64_tr_b16 v[196:197], v33 offset:16384
    ds_read_b64_tr_b16 v[198:199], v33 offset:18432
    ds_read_b64_tr_b16 v[200:201], v34 offset:16384
    ds_read_b64_tr_b16 v[202:203], v34 offset:18432
    ds_read_b64_tr_b16 v[204:205], v35 offset:16384
    ds_read_b64_tr_b16 v[206:207], v35 offset:18432
    v_mfma_f32_16x16x32_bf16 v[64:67], v[208:211], v[152:155], v[64:67]
    v_mfma_f32_16x16x32_bf16 v[80:83], v[208:211], v[156:159], v[80:83]
    v_mfma_f32_16x16x32_bf16 v[84:87], v[212:215], v[156:159], v[84:87]
    v_mfma_f32_16x16x32_bf16 v[68:71], v[212:215], v[152:155], v[68:71]
    s_add_u32 m0, s38, 0
    s_nop 0
    buffer_load_dwordx4 v24, s[28:31], s44 offen offset:0 lds
    buffer_load_dwordx4 v25, s[28:31], s44 offen offset:1024 lds
    buffer_load_dwordx4 v26, s[28:31], s44 offen offset:2048 lds
    v_mfma_f32_16x16x32_bf16 v[72:75], v[216:219], v[152:155], v[72:75]
    v_mfma_f32_16x16x32_bf16 v[88:91], v[216:219], v[156:159], v[88:91]
    v_mfma_f32_16x16x32_bf16 v[92:95], v[220:223], v[156:159], v[92:95]
    v_mfma_f32_16x16x32_bf16 v[76:79], v[220:223], v[152:155], v[76:79]
    buffer_load_dwordx4 v27, s[28:31], s44 offen offset:3072 lds
    s_add_u32 s44, s44, 262144
    buffer_load_dwordx4 v[128:131], v8, s[4:7], s43 offen offset:0 sc1
    buffer_load_dwordx4 v[132:135], v8, s[4:7], s43 offen offset:1024 sc1
    ds_read_b64_tr_b16 v[208:209], v32 offset:20480
    ds_read_b64_tr_b16 v[210:211], v32 offset:22528
    ds_read_b64_tr_b16 v[212:213], v33 offset:20480
    ds_read_b64_tr_b16 v[214:215], v33 offset:22528
    ds_read_b64_tr_b16 v[216:217], v34 offset:20480
    ds_read_b64_tr_b16 v[218:219], v34 offset:22528
    ds_read_b64_tr_b16 v[220:221], v35 offset:20480
    ds_read_b64_tr_b16 v[222:223], v35 offset:22528
    s_waitcnt lgkmcnt(8) vmcnt(14)
    v_mfma_f32_16x16x32_bf16 v[64:67], v[192:195], v[160:163], v[64:67]
    v_mfma_f32_16x16x32_bf16 v[80:83], v[192:195], v[164:167], v[80:83]
    v_mfma_f32_16x16x32_bf16 v[84:87], v[196:199], v[164:167], v[84:87]
    v_mfma_f32_16x16x32_bf16 v[68:71], v[196:199], v[160:163], v[68:71]
    s_add_u32 s43, s43, 8192
    buffer_load_dwordx4 v[136:139], v8, s[4:7], s43 offen offset:0 sc1
    buffer_load_dwordx4 v[140:143], v8, s[4:7], s43 offen offset:1024 sc1
    s_add_u32 s43, s43, 8192
    buffer_load_dwordx4 v[144:147], v8, s[4:7], s43 offen offset:0 sc1
    v_mfma_f32_16x16x32_bf16 v[72:75], v[200:203], v[160:163], v[72:75]
    v_mfma_f32_16x16x32_bf16 v[88:91], v[200:203], v[164:167], v[88:91]
    v_mfma_f32_16x16x32_bf16 v[92:95], v[204:207], v[164:167], v[92:95]
    v_mfma_f32_16x16x32_bf16 v[76:79], v[204:207], v[160:163], v[76:79]
    buffer_load_dwordx4 v[148:151], v8, s[4:7], s43 offen offset:1024 sc1
    s_add_u32 s43, s43, 8192
    buffer_load_dwordx4 v[152:155], v8, s[4:7], s43 offen offset:0 sc1
    buffer_load_dwordx4 v[156:159], v8, s[4:7], s43 offen offset:1024 sc1
    ds_read_b64_tr_b16 v[192:193], v32 offset:24576
    ds_read_b64_tr_b16 v[194:195], v32 offset:26624
    ds_read_b64_tr_b16 v[196:197], v33 offset:24576
    ds_read_b64_tr_b16 v[198:199], v33 offset:26624
    ds_read_b64_tr_b16 v[200:201], v34 offset:24576
    ds_read_b64_tr_b16 v[202:203], v34 offset:26624
    ds_read_b64_tr_b16 v[204:205], v35 offset:24576
    ds_read_b64_tr_b16 v[206:207], v35 offset:26624
    s_waitcnt lgkmcnt(8)
    v_mfma_f32_16x16x32_bf16 v[64:67], v[208:211], v[168:171], v[64:67]
    v_mfma_f32_16x16x32_bf16 v[80:83], v[208:211], v[172:175], v[80:83]
    v_mfma_f32_16x16x32_bf16 v[84:87], v[212:215], v[172:175], v[84:87]
    v_mfma_f32_16x16x32_bf16 v[68:71], v[212:215], v[168:171], v[68:71]
    s_add_u32 s43, s43, 8192
    s_andn2_b32 s39, s36, s35
    s_bcnt1_i32_b32 s3, s39
    s_cmp_ge_u32 s3, 2
    s_cbranch_scc1 L_kvok_30
    s_mov_b32 s62, 0x8000
L_kvr_29:
    buffer_load_dword v20, v17, s[4:7], s34 offen sc1
    s_waitcnt vmcnt(0)
    v_cmp_eq_u32 vcc, s12, v20
    s_mov_b32 s36, vcc_lo
    s_andn2_b32 s39, s36, s35
    s_bcnt1_i32_b32 s3, s39
    s_cmp_ge_u32 s3, 2
    s_cbranch_scc1 L_kvok_30
    s_sleep 2
    s_sub_u32 s62, s62, 1
    s_cmp_lg_u32 s62, 0
    s_cbranch_scc1 L_kvr_29
    s_not_b32 s39, s35
L_kvok_30:
    s_ff1_i32_b32 s3, s39
    s_bitset1_b32 s35, s3
    s_bitset0_b32 s39, s3
    s_and_b32 s41, s3, 1
    s_lshl_b32 s41, s41, 12
    s_add_u32 s41, s41, s33
    s_lshr_b32 s3, s3, 1
    s_add_u32 s3, s3, s14
    s_and_b32 s3, s3, 15
    s_add_u32 m0, s37, 0
    s_lshl_b32 s3, s3, 15
    s_add_u32 s41, s41, s3
    buffer_load_dwordx4 v8, s[4:7], s41 offen offset:0 sc1 lds
    buffer_load_dwordx4 v8, s[4:7], s41 offen offset:1024 sc1 lds
    buffer_load_dwordx4 v8, s[4:7], s41 offen offset:2048 sc1 lds
    v_mfma_f32_16x16x32_bf16 v[72:75], v[216:219], v[168:171], v[72:75]
    v_mfma_f32_16x16x32_bf16 v[88:91], v[216:219], v[172:175], v[88:91]
    v_mfma_f32_16x16x32_bf16 v[92:95], v[220:223], v[172:175], v[92:95]
    v_mfma_f32_16x16x32_bf16 v[76:79], v[220:223], v[168:171], v[76:79]
    buffer_load_dwordx4 v8, s[4:7], s41 offen offset:3072 sc1 lds
    s_ff1_i32_b32 s3, s39
    s_bitset1_b32 s35, s3
    s_bitset0_b32 s39, s3
    s_and_b32 s41, s3, 1
    s_lshl_b32 s41, s41, 12
    s_add_u32 s41, s41, s33
    s_lshr_b32 s3, s3, 1
    s_add_u32 s3, s3, s14
    s_and_b32 s3, s3, 15
    s_add_u32 m0, s37, 4096
    s_lshl_b32 s3, s3, 15
    s_add_u32 s41, s41, s3
    buffer_load_dwordx4 v8, s[4:7], s41 offen offset:0 sc1 lds
    buffer_load_dwordx4 v8, s[4:7], s41 offen offset:1024 sc1 lds
    ds_read_b64_tr_b16 v[208:209], v32 offset:28672
    ds_read_b64_tr_b16 v[210:211], v32 offset:30720
    ds_read_b64_tr_b16 v[212:213], v33 offset:28672
    ds_read_b64_tr_b16 v[214:215], v33 offset:30720
    ds_read_b64_tr_b16 v[216:217], v34 offset:28672
    ds_read_b64_tr_b16 v[218:219], v34 offset:30720
    ds_read_b64_tr_b16 v[220:221], v35 offset:28672
    ds_read_b64_tr_b16 v[222:223], v35 offset:30720
    s_waitcnt lgkmcnt(8)
    v_mfma_f32_16x16x32_bf16 v[64:67], v[192:195], v[176:179], v[64:67]
    v_mfma_f32_16x16x32_bf16 v[80:83], v[192:195], v[180:183], v[80:83]
    v_mfma_f32_16x16x32_bf16 v[84:87], v[196:199], v[180:183], v[84:87]
    v_mfma_f32_16x16x32_bf16 v[68:71], v[196:199], v[176:179], v[68:71]
    buffer_load_dwordx4 v8, s[4:7], s41 offen offset:2048 sc1 lds
    buffer_load_dwordx4 v8, s[4:7], s41 offen offset:3072 sc1 lds
    v_mfma_f32_16x16x32_bf16 v[72:75], v[200:203], v[176:179], v[72:75]
    v_mfma_f32_16x16x32_bf16 v[88:91], v[200:203], v[180:183], v[88:91]
    v_mfma_f32_16x16x32_bf16 v[92:95], v[204:207], v[180:183], v[92:95]
    v_mfma_f32_16x16x32_bf16 v[76:79], v[204:207], v[176:179], v[76:79]
    s_waitcnt vmcnt(16) lgkmcnt(0)
    s_barrier
    ds_read_b64_tr_b16 v[192:193], v32 offset:0
    ds_read_b64_tr_b16 v[194:195], v32 offset:2048
    ds_read_b64_tr_b16 v[196:197], v33 offset:0
    ds_read_b64_tr_b16 v[198:199], v33 offset:2048
    ds_read_b64_tr_b16 v[200:201], v34 offset:0
    ds_read_b64_tr_b16 v[202:203], v34 offset:2048
    ds_read_b64_tr_b16 v[204:205], v35 offset:0
    ds_read_b64_tr_b16 v[206:207], v35 offset:2048
    v_mfma_f32_16x16x32_bf16 v[64:67], v[208:211], v[184:187], v[64:67]
    v_mfma_f32_16x16x32_bf16 v[80:83], v[208:211], v[188:191], v[80:83]
    v_mfma_f32_16x16x32_bf16 v[84:87], v[212:215], v[188:191], v[84:87]
    v_mfma_f32_16x16x32_bf16 v[68:71], v[212:215], v[184:187], v[68:71]
    s_add_u32 m0, s38, 16384
    s_nop 0
    buffer_load_dwordx4 v24, s[28:31], s44 offen offset:0 lds
    buffer_load_dwordx4 v25, s[28:31], s44 offen offset:1024 lds
    buffer_load_dwordx4 v26, s[28:31], s44 offen offset:2048 lds
    v_mfma_f32_16x16x32_bf16 v[72:75], v[216:219], v[184:187], v[72:75]
    v_mfma_f32_16x16x32_bf16 v[88:91], v[216:219], v[188:191], v[88:91]
    v_mfma_f32_16x16x32_bf16 v[92:95], v[220:223], v[188:191], v[92:95]
    v_mfma_f32_16x16x32_bf16 v[76:79], v[220:223], v[184:187], v[76:79]
    buffer_load_dwordx4 v27, s[28:31], s44 offen offset:3072 lds
    s_add_u32 s44, s44, 262144
    buffer_load_dwordx4 v[160:163], v8, s[4:7], s43 offen offset:0 sc1
    buffer_load_dwordx4 v[164:167], v8, s[4:7], s43 offen offset:1024 sc1
    ds_read_b64_tr_b16 v[208:209], v32 offset:4096
    ds_read_b64_tr_b16 v[210:211], v32 offset:6144
    ds_read_b64_tr_b16 v[212:213], v33 offset:4096
    ds_read_b64_tr_b16 v[214:215], v33 offset:6144
    ds_read_b64_tr_b16 v[216:217], v34 offset:4096
    ds_read_b64_tr_b16 v[218:219], v34 offset:6144
    ds_read_b64_tr_b16 v[220:221], v35 offset:4096
    ds_read_b64_tr_b16 v[222:223], v35 offset:6144
    s_waitcnt lgkmcnt(8) vmcnt(14)
    v_mfma_f32_16x16x32_bf16 v[64:67], v[192:195], v[128:131], v[64:67]
    v_mfma_f32_16x16x32_bf16 v[80:83], v[192:195], v[132:135], v[80:83]
    v_mfma_f32_16x16x32_bf16 v[84:87], v[196:199], v[132:135], v[84:87]
    v_mfma_f32_16x16x32_bf16 v[68:71], v[196:199], v[128:131], v[68:71]
    s_add_u32 s43, s43, 8192
    buffer_load_dwordx4 v[168:171], v8, s[4:7], s43 offen offset:0 sc1
    buffer_load_dwordx4 v[172:175], v8, s[4:7], s43 offen offset:1024 sc1
    s_add_u32 s43, s43, 8192
    buffer_load_dwordx4 v[176:179], v8, s[4:7], s43 offen offset:0 sc1
    v_mfma_f32_16x16x32_bf16 v[72:75], v[200:203], v[128:131], v[72:75]
    v_mfma_f32_16x16x32_bf16 v[88:91], v[200:203], v[132:135], v[88:91]
    v_mfma_f32_16x16x32_bf16 v[92:95], v[204:207], v[132:135], v[92:95]
    v_mfma_f32_16x16x32_bf16 v[76:79], v[204:207], v[128:131], v[76:79]
    buffer_load_dwordx4 v[180:183], v8, s[4:7], s43 offen offset:1024 sc1
    s_add_u32 s43, s43, 8192
    buffer_load_dwordx4 v[184:187], v8, s[4:7], s43 offen offset:0 sc1
    buffer_load_dwordx4 v[188:191], v8, s[4:7], s43 offen offset:1024 sc1
    ds_read_b64_tr_b16 v[192:193], v32 offset:8192
    ds_read_b64_tr_b16 v[194:195], v32 offset:10240
    ds_read_b64_tr_b16 v[196:197], v33 offset:8192
    ds_read_b64_tr_b16 v[198:199], v33 offset:10240
    ds_read_b64_tr_b16 v[200:201], v34 offset:8192
    ds_read_b64_tr_b16 v[202:203], v34 offset:10240
    ds_read_b64_tr_b16 v[204:205], v35 offset:8192
    ds_read_b64_tr_b16 v[206:207], v35 offset:10240
    s_waitcnt lgkmcnt(8)
    v_mfma_f32_16x16x32_bf16 v[64:67], v[208:211], v[136:139], v[64:67]
    v_mfma_f32_16x16x32_bf16 v[80:83], v[208:211], v[140:143], v[80:83]
    v_mfma_f32_16x16x32_bf16 v[84:87], v[212:215], v[140:143], v[84:87]
    v_mfma_f32_16x16x32_bf16 v[68:71], v[212:215], v[136:139], v[68:71]
    s_add_u32 s43, s43, 8192
    s_andn2_b32 s39, s36, s35
    s_bcnt1_i32_b32 s3, s39
    s_cmp_ge_u32 s3, 2
    s_cbranch_scc1 L_kvok_32
    s_mov_b32 s62, 0x8000
L_kvr_31:
    buffer_load_dword v20, v17, s[4:7], s34 offen sc1
    s_waitcnt vmcnt(0)
    v_cmp_eq_u32 vcc, s12, v20
    s_mov_b32 s36, vcc_lo
    s_andn2_b32 s39, s36, s35
    s_bcnt1_i32_b32 s3, s39
    s_cmp_ge_u32 s3, 2
    s_cbranch_scc1 L_kvok_32
    s_sleep 2
    s_sub_u32 s62, s62, 1
    s_cmp_lg_u32 s62, 0
    s_cbranch_scc1 L_kvr_31
    s_not_b32 s39, s35
L_kvok_32:
    s_ff1_i32_b32 s3, s39
    s_bitset1_b32 s35, s3
    s_bitset0_b32 s39, s3
    s_and_b32 s41, s3, 1
    s_lshl_b32 s41, s41, 12
    s_add_u32 s41, s41, s33
    s_lshr_b32 s3, s3, 1
    s_add_u32 s3, s3, s14
    s_and_b32 s3, s3, 15
    s_add_u32 m0, s37, 32768
    s_lshl_b32 s3, s3, 15
    s_add_u32 s41, s41, s3
    buffer_load_dwordx4 v8, s[4:7], s41 offen offset:0 sc1 lds
    buffer_load_dwordx4 v8, s[4:7], s41 offen offset:1024 sc1 lds
    buffer_load_dwordx4 v8, s[4:7], s41 offen offset:2048 sc1 lds
    v_mfma_f32_16x16x32_bf16 v[72:75], v[216:219], v[136:139], v[72:75]
    v_mfma_f32_16x16x32_bf16 v[88:91], v[216:219], v[140:143], v[88:91]
    v_mfma_f32_16x16x32_bf16 v[92:95], v[220:223], v[140:143], v[92:95]
    v_mfma_f32_16x16x32_bf16 v[76:79], v[220:223], v[136:139], v[76:79]
    buffer_load_dwordx4 v8, s[4:7], s41 offen offset:3072 sc1 lds
    s_ff1_i32_b32 s3, s39
    s_bitset1_b32 s35, s3
    s_bitset0_b32 s39, s3
    s_and_b32 s41, s3, 1
    s_lshl_b32 s41, s41, 12
    s_add_u32 s41, s41, s33
    s_lshr_b32 s3, s3, 1
    s_add_u32 s3, s3, s14
    s_and_b32 s3, s3, 15
    s_add_u32 m0, s37, 36864
    s_lshl_b32 s3, s3, 15
    s_add_u32 s41, s41, s3
    buffer_load_dwordx4 v8, s[4:7], s41 offen offset:0 sc1 lds
    buffer_load_dwordx4 v8, s[4:7], s41 offen offset:1024 sc1 lds
    ds_read_b64_tr_b16 v[208:209], v32 offset:12288
    ds_read_b64_tr_b16 v[210:211], v32 offset:14336
    ds_read_b64_tr_b16 v[212:213], v33 offset:12288
    ds_read_b64_tr_b16 v[214:215], v33 offset:14336
    ds_read_b64_tr_b16 v[216:217], v34 offset:12288
    ds_read_b64_tr_b16 v[218:219], v34 offset:14336
    ds_read_b64_tr_b16 v[220:221], v35 offset:12288
    ds_read_b64_tr_b16 v[222:223], v35 offset:14336
    s_waitcnt lgkmcnt(8)
    v_mfma_f32_16x16x32_bf16 v[64:67], v[192:195], v[144:147], v[64:67]
    v_mfma_f32_16x16x32_bf16 v[80:83], v[192:195], v[148:151], v[80:83]
    v_mfma_f32_16x16x32_bf16 v[84:87], v[196:199], v[148:151], v[84:87]
    v_mfma_f32_16x16x32_bf16 v[68:71], v[196:199], v[144:147], v[68:71]
    buffer_load_dwordx4 v8, s[4:7], s41 offen offset:2048 sc1 lds
    buffer_load_dwordx4 v8, s[4:7], s41 offen offset:3072 sc1 lds
    v_mfma_f32_16x16x32_bf16 v[72:75], v[200:203], v[144:147], v[72:75]
    v_mfma_f32_16x16x32_bf16 v[88:91], v[200:203], v[148:151], v[88:91]
    v_mfma_f32_16x16x32_bf16 v[92:95], v[204:207], v[148:151], v[92:95]
    v_mfma_f32_16x16x32_bf16 v[76:79], v[204:207], v[144:147], v[76:79]
    s_waitcnt vmcnt(16) lgkmcnt(0)
    s_barrier
    ds_read_b64_tr_b16 v[192:193], v32 offset:16384
    ds_read_b64_tr_b16 v[194:195], v32 offset:18432
    ds_read_b64_tr_b16 v[196:197], v33 offset:16384
    ds_read_b64_tr_b16 v[198:199], v33 offset:18432
    ds_read_b64_tr_b16 v[200:201], v34 offset:16384
    ds_read_b64_tr_b16 v[202:203], v34 offset:18432
    ds_read_b64_tr_b16 v[204:205], v35 offset:16384
    ds_read_b64_tr_b16 v[206:207], v35 offset:18432
    v_mfma_f32_16x16x32_bf16 v[64:67], v[208:211], v[152:155], v[64:67]
    v_mfma_f32_16x16x32_bf16 v[80:83], v[208:211], v[156:159], v[80:83]
    v_mfma_f32_16x16x32_bf16 v[84:87], v[212:215], v[156:159], v[84:87]
    v_mfma_f32_16x16x32_bf16 v[68:71], v[212:215], v[152:155], v[68:71]
    s_andn2_b32 s39, s36, s35
    s_bcnt1_i32_b32 s3, s39
    s_cmp_ge_u32 s3, 2
    s_cbranch_scc1 L_kvok_34
    s_mov_b32 s62, 0x8000
L_kvr_33:
    buffer_load_dword v20, v17, s[4:7], s34 offen sc1
    s_waitcnt vmcnt(0)
    v_cmp_eq_u32 vcc, s12, v20
    s_mov_b32 s36, vcc_lo
    s_andn2_b32 s39, s36, s35
    s_bcnt1_i32_b32 s3, s39
    s_cmp_ge_u32 s3, 2
    s_cbranch_scc1 L_kvok_34
    s_sleep 2
    s_sub_u32 s62, s62, 1
    s_cmp_lg_u32 s62, 0
    s_cbranch_scc1 L_kvr_33
    s_not_b32 s39, s35
L_kvok_34:
    s_ff1_i32_b32 s3, s39
    s_bitset1_b32 s35, s3
    s_bitset0_b32 s39, s3
    s_and_b32 s41, s3, 1
    s_lshl_b32 s41, s41, 12
    s_add_u32 s41, s41, s33
    s_lshr_b32 s3, s3, 1
    s_add_u32 s3, s3, s14
    s_and_b32 s3, s3, 15
    s_add_u32 m0, s37, 65536
    s_lshl_b32 s3, s3, 15
    s_add_u32 s41, s41, s3
    buffer_load_dwordx4 v8, s[4:7], s41 offen offset:0 sc1 lds
    buffer_load_dwordx4 v8, s[4:7], s41 offen offset:1024 sc1 lds
    v_mfma_f32_16x16x32_bf16 v[72:75], v[216:219], v[152:155], v[72:75]
    v_mfma_f32_16x16x32_bf16 v[88:91], v[216:219], v[156:159], v[88:91]
    v_mfma_f32_16x16x32_bf16 v[92:95], v[220:223], v[156:159], v[92:95]
    v_mfma_f32_16x16x32_bf16 v[76:79], v[220:223], v[152:155], v[76:79]
    buffer_load_dwordx4 v8, s[4:7], s41 offen offset:2048 sc1 lds
    ds_read_b64_tr_b16 v[208:209], v32 offset:20480
    ds_read_b64_tr_b16 v[210:211], v32 offset:22528
    ds_read_b64_tr_b16 v[212:213], v33 offset:20480
    ds_read_b64_tr_b16 v[214:215], v33 offset:22528
    ds_read_b64_tr_b16 v[216:217], v34 offset:20480
    ds_read_b64_tr_b16 v[218:219], v34 offset:22528
    ds_read_b64_tr_b16 v[220:221], v35 offset:20480
    ds_read_b64_tr_b16 v[222:223], v35 offset:22528
    s_waitcnt lgkmcnt(8) vmcnt(11)
    v_mfma_f32_16x16x32_bf16 v[64:67], v[192:195], v[160:163], v[64:67]
    v_mfma_f32_16x16x32_bf16 v[80:83], v[192:195], v[164:167], v[80:83]
    v_mfma_f32_16x16x32_bf16 v[84:87], v[196:199], v[164:167], v[84:87]
    v_mfma_f32_16x16x32_bf16 v[68:71], v[196:199], v[160:163], v[68:71]
    buffer_load_dwordx4 v8, s[4:7], s41 offen offset:3072 sc1 lds
    v_mfma_f32_16x16x32_bf16 v[72:75], v[200:203], v[160:163], v[72:75]
    v_mfma_f32_16x16x32_bf16 v[88:91], v[200:203], v[164:167], v[88:91]
    v_mfma_f32_16x16x32_bf16 v[92:95], v[204:207], v[164:167], v[92:95]
    v_mfma_f32_16x16x32_bf16 v[76:79], v[204:207], v[160:163], v[76:79]
    s_ff1_i32_b32 s3, s39
    s_bitset1_b32 s35, s3
    s_bitset0_b32 s39, s3
    s_and_b32 s41, s3, 1
    s_lshl_b32 s41, s41, 12
    s_add_u32 s41, s41, s33
    s_lshr_b32 s3, s3, 1
    s_add_u32 s3, s3, s14
    s_and_b32 s3, s3, 15
    s_add_u32 m0, s37, 69632
    s_lshl_b32 s3, s3, 15
    s_add_u32 s41, s41, s3
    buffer_load_dwordx4 v8, s[4:7], s41 offen offset:0 sc1 lds
    ds_read_b64_tr_b16 v[192:193], v32 offset:24576
    ds_read_b64_tr_b16 v[194:195], v32 offset:26624
    ds_read_b64_tr_b16 v[196:197], v33 offset:24576
    ds_read_b64_tr_b16 v[198:199], v33 offset:26624
    ds_read_b64_tr_b16 v[200:201], v34 offset:24576
    ds_read_b64_tr_b16 v[202:203], v34 offset:26624
    ds_read_b64_tr_b16 v[204:205], v35 offset:24576
    ds_read_b64_tr_b16 v[206:207], v35 offset:26624
    s_waitcnt lgkmcnt(8)
    v_mfma_f32_16x16x32_bf16 v[64:67], v[208:211], v[168:171], v[64:67]
    v_mfma_f32_16x16x32_bf16 v[80:83], v[208:211], v[172:175], v[80:83]
    v_mfma_f32_16x16x32_bf16 v[84:87], v[212:215], v[172:175], v[84:87]
    v_mfma_f32_16x16x32_bf16 v[68:71], v[212:215], v[168:171], v[68:71]
    buffer_load_dwordx4 v8, s[4:7], s41 offen offset:1024 sc1 lds
    v_mfma_f32_16x16x32_bf16 v[72:75], v[216:219], v[168:171], v[72:75]
    v_mfma_f32_16x16x32_bf16 v[88:91], v[216:219], v[172:175], v[88:91]
    v_mfma_f32_16x16x32_bf16 v[92:95], v[220:223], v[172:175], v[92:95]
    v_mfma_f32_16x16x32_bf16 v[76:79], v[220:223], v[168:171], v[76:79]
    buffer_load_dwordx4 v8, s[4:7], s41 offen offset:2048 sc1 lds
    ds_read_b64_tr_b16 v[208:209], v32 offset:28672
    ds_read_b64_tr_b16 v[210:211], v32 offset:30720
    ds_read_b64_tr_b16 v[212:213], v33 offset:28672
    ds_read_b64_tr_b16 v[214:215], v33 offset:30720
    ds_read_b64_tr_b16 v[216:217], v34 offset:28672
    ds_read_b64_tr_b16 v[218:219], v34 offset:30720
    ds_read_b64_tr_b16 v[220:221], v35 offset:28672
    ds_read_b64_tr_b16 v[222:223], v35 offset:30720
    s_waitcnt lgkmcnt(8)
    v_mfma_f32_16x16x32_bf16 v[64:67], v[192:195], v[176:179], v[64:67]
    v_mfma_f32_16x16x32_bf16 v[80:83], v[192:195], v[180:183], v[80:83]
    v_mfma_f32_16x16x32_bf16 v[84:87], v[196:199], v[180:183], v[84:87]
    v_mfma_f32_16x16x32_bf16 v[68:71], v[196:199], v[176:179], v[68:71]
    buffer_load_dwordx4 v8, s[4:7], s41 offen offset:3072 sc1 lds
    buffer_load_dword v60, v54, s[56:59], s63 offen
    s_add_u32 s63, s63, 1048576
    buffer_load_dword v60, v54, s[56:59], s63 offen
    s_add_u32 s63, s63, 1048576
    s_sub_u32 s63, s63, 2097152
    buffer_load_dword v60, v54, s[52:55], s63 offen
    s_add_u32 s63, s63, 1048576
    v_mfma_f32_16x16x32_bf16 v[72:75], v[200:203], v[176:179], v[72:75]
    v_mfma_f32_16x16x32_bf16 v[88:91], v[200:203], v[180:183], v[88:91]
    v_mfma_f32_16x16x32_bf16 v[92:95], v[204:207], v[180:183], v[92:95]
    v_mfma_f32_16x16x32_bf16 v[76:79], v[204:207], v[176:179], v[76:79]
    s_waitcnt vmcnt(11) lgkmcnt(0)
    s_barrier
    v_mfma_f32_16x16x32_bf16 v[64:67], v[208:211], v[184:187], v[64:67]
    v_mfma_f32_16x16x32_bf16 v[80:83], v[208:211], v[188:191], v[80:83]
    v_mfma_f32_16x16x32_bf16 v[84:87], v[212:215], v[188:191], v[84:87]
    v_mfma_f32_16x16x32_bf16 v[68:71], v[212:215], v[184:187], v[68:71]
    v_mfma_f32_16x16x32_bf16 v[72:75], v[216:219], v[184:187], v[72:75]
    v_mfma_f32_16x16x32_bf16 v[88:91], v[216:219], v[188:191], v[88:91]
    v_mfma_f32_16x16x32_bf16 v[92:95], v[220:223], v[188:191], v[92:95]
    v_mfma_f32_16x16x32_bf16 v[76:79], v[220:223], v[184:187], v[76:79]
    s_setprio 2
    s_lshl_b32 s45, s16, 18
    s_lshl_b32 s3, s17, 14
    s_add_u32 s45, s45, s3
    s_lshl_b32 s3, s18, 11
    s_add_u32 s45, s45, s3
    s_add_u32 s45, s45, 16777216
    s_add_u32 s47, s45, 8192
    s_nop 1
    v_cvt_pk_bf16_f32 v128, v64, v65
    v_cvt_pk_bf16_f32 v129, v66, v67
    v_cvt_pk_bf16_f32 v130, v68, v69
    v_cvt_pk_bf16_f32 v131, v70, v71
    v_cvt_pk_bf16_f32 v132, v72, v73
    v_cvt_pk_bf16_f32 v133, v74, v75
    v_cvt_pk_bf16_f32 v134, v76, v77
    v_cvt_pk_bf16_f32 v135, v78, v79
    v_cvt_pk_bf16_f32 v136, v80, v81
    v_cvt_pk_bf16_f32 v137, v82, v83
    v_cvt_pk_bf16_f32 v138, v84, v85
    v_cvt_pk_bf16_f32 v139, v86, v87
    v_cvt_pk_bf16_f32 v140, v88, v89
    v_cvt_pk_bf16_f32 v141, v90, v91
    v_cvt_pk_bf16_f32 v142, v92, v93
    v_cvt_pk_bf16_f32 v143, v94, v95
    buffer_store_dwordx4 v[128:131], v8, s[4:7], s45 offen offset:0 sc1
    buffer_store_dwordx4 v[132:135], v8, s[4:7], s47 offen offset:0 sc1
    buffer_store_dwordx4 v[136:139], v8, s[4:7], s45 offen offset:1024 sc1
    buffer_store_dwordx4 v[140:143], v8, s[4:7], s47 offen offset:1024 sc1
    v_mfma_f32_16x16x32_bf16 v[112:115], v[108:111], v[128:131], 0
    v_mfma_f32_16x16x32_bf16 v[120:123], v[128:131], v[128:131], 0
    v_mfma_f32_16x16x32_bf16 v[116:119], v[108:111], v[136:139], 0
    v_mfma_f32_16x16x32_bf16 v[124:127], v[136:139], v[136:139], 0
    v_mfma_f32_16x16x32_bf16 v[112:115], v[108:111], v[132:135], v[112:115]
    v_mfma_f32_16x16x32_bf16 v[120:123], v[132:135], v[132:135], v[120:123]
    v_mfma_f32_16x16x32_bf16 v[116:119], v[108:111], v[140:143], v[116:119]
    v_mfma_f32_16x16x32_bf16 v[124:127], v[140:143], v[140:143], v[124:127]
    v_and_b32 v5, 3, v3
    v_cmp_eq_u32 s[88:89], 1, v5
    v_cmp_eq_u32 s[90:91], 2, v5
    v_cmp_eq_u32 vcc, 3, v5
    s_lshl_b32 s41, s19, 10
    s_lshl_b32 s3, s18, 8
    s_add_u32 s41, s41, s3
    s_add_u32 s41, s41, 39911424
    v_lshlrev_b32 v6, 4, v3
    v_cndmask_b32 v120, v120, v121, s[88:89]
    v_cndmask_b32 v120, v120, v122, s[90:91]
    v_cndmask_b32 v114, v120, v123, vcc
    v_cndmask_b32 v124, v124, v125, s[88:89]
    v_cndmask_b32 v124, v124, v126, s[90:91]
    v_cndmask_b32 v115, v124, v127, vcc
    v_mov_b32 v113, v116
    s_mov_b32 exec_lo, 0x00f0000f
    s_mov_b32 exec_hi, 0xf0000f00
    buffer_store_dwordx4 v[112:115], v6, s[4:7], s41 offen sc1
    s_mov_b64 exec, -1
    s_lshl_b32 s3, s18, 7
    s_add_u32 s3, s3, 158720
    v_add_u32 v5, s3, v23
    ds_write_b32 v5, v36
    s_lshl_b32 s45, s19, 4
    s_lshl_b32 s3, s18, 2
    s_add_u32 s45, s45, s3
    s_add_u32 s45, s45, 46661632
    v_add_f32_dpp v44, v44, v44 row_ror:8 row_mask:0xf bank_mask:0xf
    v_add_f32_dpp v45, v45, v45 row_ror:8 row_mask:0xf bank_mask:0xf
    v_add_f32_dpp v46, v46, v46 row_ror:8 row_mask:0xf bank_mask:0xf
    v_add_f32_dpp v47, v47, v47 row_ror:8 row_mask:0xf bank_mask:0xf
    v_lshlrev_b32 v5, 5, v3
    v_lshl_add_u32 v5, v4, 4, v5
    s_mul_i32 s41, s16, 14336
    s_mul_i32 s49, s17, 896
    s_mul_i32 s3, s18, 224
    s_add_u32 s49, s49, s3
    s_add_u32 s49, s49, 40894464
    s_add_u32 s41, s41, s49
    s_mov_b32 exec_lo, 0x007f007f
    s_mov_b32 exec_hi, 0
    buffer_store_dwordx4 v[44:47], v5, s[4:7], s41 offen sc1
    s_mov_b64 exec, -1
    s_andn2_b32 s39, s36, s35
    s_bcnt1_i32_b32 s3, s39
    s_cmp_ge_u32 s3, 2
    s_cbranch_scc1 L_kvok_36
    s_mov_b32 s62, 0x8000
L_kvr_35:
    buffer_load_dword v20, v17, s[4:7], s34 offen sc1
    s_waitcnt vmcnt(0)
    v_cmp_eq_u32 vcc, s12, v20
    s_mov_b32 s36, vcc_lo
    s_andn2_b32 s39, s36, s35
    s_bcnt1_i32_b32 s3, s39
    s_cmp_ge_u32 s3, 2
    s_cbranch_scc1 L_kvok_36
    s_sleep 2
    s_sub_u32 s62, s62, 1
    s_cmp_lg_u32 s62, 0
    s_cbranch_scc1 L_kvr_35
    s_not_b32 s39, s35
L_kvok_36:
    s_ff1_i32_b32 s3, s39
    s_bitset1_b32 s35, s3
    s_bitset0_b32 s39, s3
    s_and_b32 s41, s3, 1
    s_lshl_b32 s41, s41, 12
    s_add_u32 s41, s41, s33
    s_lshr_b32 s3, s3, 1
    s_add_u32 s3, s3, s14
    s_and_b32 s3, s3, 15
    s_add_u32 m0, s37, 0
    s_lshl_b32 s3, s3, 15
    s_add_u32 s41, s41, s3
    buffer_load_dwordx4 v8, s[4:7], s41 offen offset:0 sc1 lds
    buffer_load_dwordx4 v8, s[4:7], s41 offen offset:1024 sc1 lds
    buffer_load_dwordx4 v8, s[4:7], s41 offen offset:2048 sc1 lds
    buffer_load_dwordx4 v8, s[4:7], s41 offen offset:3072 sc1 lds
    s_ff1_i32_b32 s3, s39
    s_bitset1_b32 s35, s3
    s_bitset0_b32 s39, s3
    s_and_b32 s41, s3, 1
    s_lshl_b32 s41, s41, 12
    s_add_u32 s41, s41, s33
    s_lshr_b32 s3, s3, 1
    s_add_u32 s3, s3, s14
    s_and_b32 s3, s3, 15
    s_add_u32 m0, s37, 4096
    s_lshl_b32 s3, s3, 15
    s_add_u32 s41, s41, s3
    buffer_load_dwordx4 v8, s[4:7], s41 offen offset:0 sc1 lds
    buffer_load_dwordx4 v8, s[4:7], s41 offen offset:1024 sc1 lds
    buffer_load_dwordx4 v8, s[4:7], s41 offen offset:2048 sc1 lds
    buffer_load_dwordx4 v8, s[4:7], s41 offen offset:3072 sc1 lds
    buffer_load_dword v60, v54, s[52:55], s63 offen
    s_add_u32 s63, s63, 1048576
    buffer_load_dword v60, v54, s[52:55], s63 offen
    s_add_u32 s63, s63, 1048576
    buffer_load_dword v60, v54, s[52:55], s63 offen
    s_add_u32 s63, s63, 1048576
    s_waitcnt vmcnt(20) lgkmcnt(0)
    s_barrier
    s_waitcnt vmcnt(11)
    v_mov_b32 v1, s12
    s_mov_b64 exec, 1
    buffer_store_dword v1, off, s[4:7], s45 sc1
    s_mov_b64 exec, -1
    s_andn2_b32 s39, s36, s35
    s_bcnt1_i32_b32 s3, s39
    s_cmp_ge_u32 s3, 2
    s_cbranch_scc1 L_kvok_38
    s_mov_b32 s62, 0x8000
L_kvr_37:
    buffer_load_dword v20, v17, s[4:7], s34 offen sc1
    s_waitcnt vmcnt(0)
    v_cmp_eq_u32 vcc, s12, v20
    s_mov_b32 s36, vcc_lo
    s_andn2_b32 s39, s36, s35
    s_bcnt1_i32_b32 s3, s39
    s_cmp_ge_u32 s3, 2
    s_cbranch_scc1 L_kvok_38
    s_sleep 2
    s_sub_u32 s62, s62, 1
    s_cmp_lg_u32 s62, 0
    s_cbranch_scc1 L_kvr_37
    s_not_b32 s39, s35
L_kvok_38:
    s_ff1_i32_b32 s3, s39
    s_bitset1_b32 s35, s3
    s_bitset0_b32 s39, s3
    s_and_b32 s41, s3, 1
    s_lshl_b32 s41, s41, 12
    s_add_u32 s41, s41, s33
    s_lshr_b32 s3, s3, 1
    s_add_u32 s3, s3, s14
    s_and_b32 s3, s3, 15
    s_add_u32 m0, s37, 32768
    s_lshl_b32 s3, s3, 15
    s_add_u32 s41, s41, s3
    buffer_load_dwordx4 v8, s[4:7], s41 offen offset:0 sc1 lds
    buffer_load_dwordx4 v8, s[4:7], s41 offen offset:1024 sc1 lds
    buffer_load_dwordx4 v8, s[4:7], s41 offen offset:2048 sc1 lds
    buffer_load_dwordx4 v8, s[4:7], s41 offen offset:3072 sc1 lds
    s_ff1_i32_b32 s3, s39
    s_bitset1_b32 s35, s3
    s_bitset0_b32 s39, s3
    s_and_b32 s41, s3, 1
    s_lshl_b32 s41, s41, 12
    s_add_u32 s41, s41, s33
    s_lshr_b32 s3, s3, 1
    s_add_u32 s3, s3, s14
    s_and_b32 s3, s3, 15
    s_add_u32 m0, s37, 36864
    s_lshl_b32 s3, s3, 15
    s_add_u32 s41, s41, s3
    buffer_load_dwordx4 v8, s[4:7], s41 offen offset:0 sc1 lds
    buffer_load_dwordx4 v8, s[4:7], s41 offen offset:1024 sc1 lds
    buffer_load_dwordx4 v8, s[4:7], s41 offen offset:2048 sc1 lds
    buffer_load_dwordx4 v8, s[4:7], s41 offen offset:3072 sc1 lds
    s_mov_b32 s28, s76
    s_and_b32 s29, s77, 0xffff
    s_mov_b32 s30, 7340032
    s_mov_b32 s31, 0x20000
    s_lshl_b32 s43, s16, 18
    s_add_u32 s43, s43, s46
    s_add_u32 s43, s43, 16777216
    s_mul_i32 s44, s18, 114688
    s_mul_i32 s3, s17, 448
    s_add_u32 s44, s44, s3
    s_mul_i32 s38, s18, 7168
    s_add_u32 s38, s38, 16384
    s_lshl_b32 s48, s16, 8
    s_add_u32 s48, s48, 46661632
    buffer_load_dword v60, v54, s[52:55], s63 offen
    s_add_u32 s63, s63, 1048576
    buffer_load_dword v60, v54, s[52:55], s63 offen
    s_add_u32 s63, s63, 1048576
    buffer_load_dword v60, v54, s[52:55], s63 offen
    s_add_u32 s63, s63, 1048576
    s_waitcnt vmcnt(15)
    s_barrier
    s_mul_i32 s50, s16, 0
    s_mul_i32 s3, s17, 0
    s_add_u32 s50, s50, s3
    s_and_b32 s50, s50, 15
    s_mov_b32 s51, s50
    s_add_u32 m0, s38, 65536
    s_mul_i32 s41, s51, 458752
    s_add_u32 s41, s41, s44
    buffer_load_dwordx4 v96, s[28:31], s41 offen offset:0 lds
    buffer_load_dwordx4 v97, s[28:31], s41 offen offset:1024 lds
    buffer_load_dwordx4 v98, s[28:31], s41 offen offset:2048 lds
    buffer_load_dwordx4 v99, s[28:31], s41 offen offset:3072 lds
    s_add_u32 m0, m0, 4096
    s_add_u32 s51, s51, 1
    buffer_load_dwordx4 v100, s[28:31], s41 offen offset:0 lds
    buffer_load_dwordx4 v101, s[28:31], s41 offen offset:1024 lds
    buffer_load_dwordx4 v102, s[28:31], s41 offen offset:2048 lds
    s_and_b32 s51, s51, 15
    s_lshl_b32 s45, s16, 14
    s_lshl_b32 s3, s18, 8
    s_add_u32 s45, s45, s3
    s_add_u32 s45, s45, 39911424
    v_lshlrev_b32 v21, 4, v3
    v_mul_u32_u24 v22, 14336, v4
    v_add_u32 v22, v22, v21
    v_lshl_add_u32 v21, v4, 10, v21
    s_lshl_b32 s60, s2, 2
    s_add_u32 s60, s60, s18
    s_lshr_b32 s61, s60, 1
    s_sub_u32 s3, s61, 448
    s_mov_b32 s22, 7340032
    s_cmp_ge_u32 s61, 448
    s_cselect_b32 s20, s56, s52
    s_cselect_b32 s21, s57, s53
    s_cselect_b32 s22, 2097152, s22
    s_cselect_b32 s3, s3, s61
    s_mov_b32 s23, 0x20000
    s_lshl_b32 s3, s3, 14
    s_and_b32 s41, s60, 1
    s_lshl_b32 s41, s41, 10
    s_add_u32 s41, s41, 384
    s_add_u32 s3, s3, s41
    buffer_load_dwordx4 v[48:51], v55, s[20:23], s3 offen
    s_add_u32 s3, s61, 64
    s_lshl_b32 s3, s3, 14
    s_add_u32 s3, s3, s41
    buffer_load_dwordx4 v[12:15], v55, s[56:59], s3 offen
    s_waitcnt vmcnt(9)
    s_barrier
    buffer_load_dword v20, v61, s[4:7], s48 offen sc1
    s_add_u32 m0, s38, 110592
    s_mul_i32 s41, s51, 458752
    s_add_u32 s41, s41, s44
    buffer_load_dwordx4 v96, s[28:31], s41 offen offset:0 lds
    buffer_load_dwordx4 v97, s[28:31], s41 offen offset:1024 lds
    buffer_load_dwordx4 v98, s[28:31], s41 offen offset:2048 lds
    buffer_load_dwordx4 v99, s[28:31], s41 offen offset:3072 lds
    s_add_u32 m0, m0, 4096
    s_add_u32 s51, s51, 1
    buffer_load_dwordx4 v100, s[28:31], s41 offen offset:0 lds
    buffer_load_dwordx4 v101, s[28:31], s41 offen offset:1024 lds
    buffer_load_dwordx4 v102, s[28:31], s41 offen offset:2048 lds
    s_and_b32 s51, s51, 15
    s_waitcnt vmcnt(7)
    s_mov_b32 s62, 0x8000
L_x1sp_40:
    v_cmp_ne_u32 vcc, s12, v20
    s_cbranch_vccz L_x1ok_39
    s_sub_u32 s62, s62, 1
    s_cmp_eq_u32 s62, 0
    s_cbranch_scc1 L_x1ok_39
    s_sleep 2
    buffer_load_dword v20, v61, s[4:7], s48 offen sc1
    s_waitcnt vmcnt(0)
    s_branch L_x1sp_40
L_x1ok_39:
    buffer_load_dwordx4 v[64:67], v21, s[4:7], s45 offen sc1
    s_add_u32 s45, s45, 4096
    buffer_load_dwordx4 v[68:71], v21, s[4:7], s45 offen sc1
    s_add_u32 s45, s45, 4096
    buffer_load_dwordx4 v[72:75], v21, s[4:7], s45 offen sc1
    s_add_u32 s45, s45, 4096
    buffer_load_dwordx4 v[76:79], v21, s[4:7], s45 offen sc1
    s_add_u32 m0, s46, 65536
    s_lshl_b32 s41, s50, 14
    s_add_u32 s41, s41, s43
    buffer_load_dwordx4 v8, s[4:7], s41 offen offset:0 sc1 lds
    buffer_load_dwordx4 v8, s[4:7], s41 offen offset:1024 sc1 lds
    buffer_load_dwordx4 v8, s[4:7], s41 offen offset:2048 sc1 lds
    buffer_load_dwordx4 v8, s[4:7], s41 offen offset:3072 sc1 lds
    s_add_u32 s50, s50, 1
    s_and_b32 s50, s50, 15
    s_add_u32 m0, s46, 110592
    s_lshl_b32 s41, s50, 14
    s_add_u32 s41, s41, s43
    buffer_load_dwordx4 v8, s[4:7], s41 offen offset:0 sc1 lds
    buffer_load_dwordx4 v8, s[4:7], s41 offen offset:1024 sc1 lds
    buffer_load_dwordx4 v8, s[4:7], s41 offen offset:2048 sc1 lds
    buffer_load_dwordx4 v8, s[4:7], s41 offen offset:3072 sc1 lds
    s_add_u32 s50, s50, 1
    s_and_b32 s50, s50, 15
    v_and_b32 v5, 0xffffff80, v8
    v_add_u32 v28, v5, v8
    s_and_b32 s3, s60, 1
    s_mul_i32 s3, s3, 1179648
    s_lshl_b32 s41, s61, 11
    s_add_u32 s41, s41, s3
    s_add_u32 s41, s41, 47185920
    buffer_store_dwordx4 v[48:51], v28, s[4:7], s41 offen sc1
    s_add_u32 s41, s41, 1048576
    s_cmp_lt_u32 s60, 128
    s_cselect_b32 s41, s41, 2147483632
    buffer_store_dwordx4 v[12:15], v28, s[4:7], s41 offen sc1
    s_waitcnt vmcnt(6)
    v_add_f32 v64, v64, v68
    v_add_f32 v72, v72, v76
    v_add_f32 v65, v65, v69
    v_add_f32 v73, v73, v77
    v_add_f32 v66, v66, v70
    v_add_f32 v74, v74, v78
    v_add_f32 v67, v67, v71
    v_add_f32 v75, v75, v79
    v_add_f32 v64, v64, v72
    v_add_f32 v65, v65, v73
    v_add_f32 v66, v66, v74
    v_add_f32 v67, v67, v75
    s_nop 0
    v_permlane32_swap_b32 v64, v66
    v_permlane32_swap_b32 v65, v67
    v_add_f32 v64, v64, v66
    v_add_f32 v65, v65, v67
    s_nop 1
    v_permlane16_swap_b32 v64, v65
    v_add_f32 v64, v64, v65
    v_sub_f32 v37, 1.0, v36
    v_mul_f32 v64, 0x3a800000, v64
    v_cvt_pk_bf16_f32 v37, v37, v37
    v_mov_b32 v65, v64
    v_and_b32 v37, v9, v37
    s_nop 0
    v_permlane32_swap_b32 v64, v65
    v_fma_f32 v65, -v64, v64, v65
    v_max_f32 v65, 0, v65
    v_add_f32 v65, 0x3727c5ac, v65
    v_rsq_f32 v5, v65
    v_sqrt_f32 v67, v65
    v_rcp_f32 v37, v37
    v_mul_f32 v66, v5, v5
    v_mul_f32 v65, 0xc0135761, v5
    v_mul_f32 v66, v66, v5
    v_mul_f32 v66, 0xbdd2d3e8, v66
    v_mul_f32 v67, v67, v37
    v_min_f32 v67, 0x7f7fffff, v67
    s_lshl_b32 s3, s18, 9
    s_add_u32 s3, s3, 155648
    v_lshl_add_u32 v5, v23, 2, s3
    ds_write_b128 v5, v[64:67]
    s_setprio 0
    s_barrier
    s_waitcnt lgkmcnt(0)
    s_barrier
    s_mov_b32 s45, 20480
    s_lshr_b32 s21, s17, 3
    s_lshl_b32 s48, s16, 8
    s_lshl_b32 s3, s21, 7
    s_add_u32 s48, s48, s3
    s_add_u32 s48, s48, 46792704
    v_and_b32 v61, 127, v61
    s_lshl_b32 s60, s18, 10
    s_add_u32 s60, s60, 46792704
    s_add_u32 m0, s46, 20480
    s_lshl_b32 s41, s50, 14
    s_add_u32 s41, s41, s43
    buffer_load_dwordx4 v8, s[4:7], s41 offen offset:0 sc1 lds
    buffer_load_dwordx4 v8, s[4:7], s41 offen offset:1024 sc1 lds
    buffer_load_dwordx4 v8, s[4:7], s41 offen offset:2048 sc1 lds
    buffer_load_dwordx4 v8, s[4:7], s41 offen offset:3072 sc1 lds
    s_add_u32 s50, s50, 1
    s_and_b32 s50, s50, 15
    s_waitcnt vmcnt(0)
    s_add_u32 m0, s38, 20480
    s_mul_i32 s41, s51, 458752
    s_add_u32 s41, s41, s44
    buffer_load_dwordx4 v96, s[28:31], s41 offen offset:0 lds
    buffer_load_dwordx4 v97, s[28:31], s41 offen offset:1024 lds
    buffer_load_dwordx4 v98, s[28:31], s41 offen offset:2048 lds
    buffer_load_dwordx4 v99, s[28:31], s41 offen offset:3072 lds
    s_add_u32 m0, m0, 4096
    s_add_u32 s51, s51, 1
    buffer_load_dwordx4 v100, s[28:31], s41 offen offset:0 lds
    buffer_load_dwordx4 v101, s[28:31], s41 offen offset:1024 lds
    buffer_load_dwordx4 v102, s[28:31], s41 offen offset:2048 lds
    s_and_b32 s51, s51, 15
    s_barrier
    s_mov_b32 s45, 65536
    s_mov_b32 s40, 10
L_p3a_41:
    s_add_u32 m0, s46, s45
    s_lshl_b32 s41, s50, 14
    s_add_u32 s41, s41, s43
    buffer_load_dwordx4 v8, s[4:7], s41 offen offset:0 sc1 lds
    buffer_load_dwordx4 v8, s[4:7], s41 offen offset:1024 sc1 lds
    buffer_load_dwordx4 v8, s[4:7], s41 offen offset:2048 sc1 lds
    buffer_load_dwordx4 v8, s[4:7], s41 offen offset:3072 sc1 lds
    s_add_u32 s50, s50, 1
    s_and_b32 s50, s50, 15
    s_add_u32 m0, s38, s45
    s_mul_i32 s41, s51, 458752
    s_add_u32 s41, s41, s44
    buffer_load_dwordx4 v96, s[28:31], s41 offen offset:0 lds
    buffer_load_dwordx4 v97, s[28:31], s41 offen offset:1024 lds
    buffer_load_dwordx4 v98, s[28:31], s41 offen offset:2048 lds
    buffer_load_dwordx4 v99, s[28:31], s41 offen offset:3072 lds
    s_add_u32 m0, m0, 4096
    s_add_u32 s51, s51, 1
    buffer_load_dwordx4 v100, s[28:31], s41 offen offset:0 lds
    buffer_load_dwordx4 v101, s[28:31], s41 offen offset:1024 lds
    buffer_load_dwordx4 v102, s[28:31], s41 offen offset:2048 lds
    s_and_b32 s51, s51, 15
    s_add_u32 s45, s45, 45056
    s_cmp_eq_u32 s45, 155648
    s_cselect_b32 s45, 20480, s45
    s_waitcnt vmcnt(11)
    s_barrier
    s_sub_u32 s40, s40, 1
    s_cmp_lg_u32 s40, 0
    s_cbranch_scc1 L_p3a_41
    buffer_load_dwordx4 v[24:27], v8, s[4:7], s60 offen sc1
    s_mov_b32 s40, 2
L_p3b_42:
    s_add_u32 m0, s46, s45
    s_lshl_b32 s41, s50, 14
    s_add_u32 s41, s41, s43
    buffer_load_dwordx4 v8, s[4:7], s41 offen offset:0 sc1 lds
    buffer_load_dwordx4 v8, s[4:7], s41 offen offset:1024 sc1 lds
    buffer_load_dwordx4 v8, s[4:7], s41 offen offset:2048 sc1 lds
    buffer_load_dwordx4 v8, s[4:7], s41 offen offset:3072 sc1 lds
    s_add_u32 s50, s50, 1
    s_and_b32 s50, s50, 15
    s_add_u32 m0, s38, s45
    s_mul_i32 s41, s51, 458752
    s_add_u32 s41, s41, s44
    buffer_load_dwordx4 v96, s[28:31], s41 offen offset:0 lds
    buffer_load_dwordx4 v97, s[28:31], s41 offen offset:1024 lds
    buffer_load_dwordx4 v98, s[28:31], s41 offen offset:2048 lds
    buffer_load_dwordx4 v99, s[28:31], s41 offen offset:3072 lds
    s_add_u32 m0, m0, 4096
    s_add_u32 s51, s51, 1
    buffer_load_dwordx4 v100, s[28:31], s41 offen offset:0 lds
    buffer_load_dwordx4 v101, s[28:31], s41 offen offset:1024 lds
    buffer_load_dwordx4 v102, s[28:31], s41 offen offset:2048 lds
    s_and_b32 s51, s51, 15
    s_add_u32 s45, s45, 45056
    s_cmp_eq_u32 s45, 155648
    s_cselect_b32 s45, 20480, s45
    s_waitcnt vmcnt(11)
    s_barrier
    s_sub_u32 s40, s40, 1
    s_cmp_lg_u32 s40, 0
    s_cbranch_scc1 L_p3b_42
    s_mov_b32 s62, 0x8000
L_allsp_44:
    v_xor_b32 v24, s12, v24
    v_xor_b32 v25, s12, v25
    v_xor_b32 v26, s12, v26
    v_xor_b32 v27, s12, v27
    v_or3_b32 v24, v24, v25, v26
    v_or_b32 v24, v24, v27
    v_cmp_ne_u32 vcc, 0, v24
    s_cbranch_vccz L_allok_43
    s_sub_u32 s62, s62, 1
    s_cmp_eq_u32 s62, 0
    s_cbranch_scc1 L_allok_43
    s_sleep 2
    buffer_load_dwordx4 v[24:27], v8, s[4:7], s60 offen sc1
    s_waitcnt vmcnt(0)
    s_branch L_allsp_44
L_allok_43:
    s_mov_b32 s40, 1
L_p3c_45:
    s_add_u32 m0, s46, s45
    s_lshl_b32 s41, s50, 14
    s_add_u32 s41, s41, s43
    buffer_load_dwordx4 v8, s[4:7], s41 offen offset:0 sc1 lds
    buffer_load_dwordx4 v8, s[4:7], s41 offen offset:1024 sc1 lds
    buffer_load_dwordx4 v8, s[4:7], s41 offen offset:2048 sc1 lds
    buffer_load_dwordx4 v8, s[4:7], s41 offen offset:3072 sc1 lds
    s_add_u32 s50, s50, 1
    s_and_b32 s50, s50, 15
    s_add_u32 m0, s38, s45
    s_mul_i32 s41, s51, 458752
    s_add_u32 s41, s41, s44
    buffer_load_dwordx4 v96, s[28:31], s41 offen offset:0 lds
    buffer_load_dwordx4 v97, s[28:31], s41 offen offset:1024 lds
    buffer_load_dwordx4 v98, s[28:31], s41 offen offset:2048 lds
    buffer_load_dwordx4 v99, s[28:31], s41 offen offset:3072 lds
    s_add_u32 m0, m0, 4096
    s_add_u32 s51, s51, 1
    buffer_load_dwordx4 v100, s[28:31], s41 offen offset:0 lds
    buffer_load_dwordx4 v101, s[28:31], s41 offen offset:1024 lds
    buffer_load_dwordx4 v102, s[28:31], s41 offen offset:2048 lds
    s_and_b32 s51, s51, 15
    s_add_u32 s45, s45, 45056
    s_cmp_eq_u32 s45, 155648
    s_cselect_b32 s45, 20480, s45
    s_waitcnt vmcnt(11)
    s_barrier
    s_sub_u32 s40, s40, 1
    s_cmp_lg_u32 s40, 0
    s_cbranch_scc1 L_p3c_45
    buffer_load_dwordx4 v[128:131], v22, s[4:7], s49 offen sc1
    s_add_u32 s49, s49, 57344
    buffer_load_dwordx4 v[132:135], v22, s[4:7], s49 offen sc1
    s_add_u32 s49, s49, 57344
    buffer_load_dwordx4 v[136:139], v22, s[4:7], s49 offen sc1
    s_add_u32 s49, s49, 57344
    buffer_load_dwordx4 v[140:143], v22, s[4:7], s49 offen sc1
    s_and_b32 s3, s17, 7
    s_lshl_b32 s3, s3, 1
    s_lshr_b32 s41, s18, 1
    s_add_u32 s34, s3, s41
    s_lshr_b32 s3, s34, 3
    s_mul_i32 s3, s3, 1179648
    s_add_u32 s35, s3, 47185920
    s_add_u32 s36, s35, 917504
    s_lshl_b32 s39, s34, 7
    s_and_b32 s3, s34, 7
    s_cmp_eq_u32 s3, 3
    s_cselect_b32 s32, 8, 11
    s_cselect_b32 s35, s35, s39
    s_cselect_b32 s36, s36, s39
    s_cselect_b32 s28, s4, s56
    s_cselect_b32 s29, s5, s57
    s_cselect_b32 s30, s6, s58
    s_cselect_b32 s52, s4, s52
    s_cselect_b32 s53, s5, s53
    s_cselect_b32 s54, s6, s54
    s_mov_b32 s31, 0x20000
    v_lshrrev_b32 v5, 3, v2
    v_and_b32 v6, 7, v2
    v_and_b32 v7, 6, v5
    v_xor_b32 v7, v7, v6
    s_and_b32 s3, s18, 1
    s_lshl_b32 s3, s3, 5
    v_add_u32 v5, s3, v5
    v_lshlrev_b32 v5, s32, v5
    v_lshl_add_u32 v11, v7, 4, v5
    s_lshl_b32 s3, 8, s32
    s_sub_u32 s3, s3, 1024
    v_add_u32 v12, s3, v11
    v_add_u32 v13, s3, v12
    v_add_u32 v14, s3, v13
    s_add_u32 s32, s32, 6
    s_mul_i32 s33, s16, 2359296
    s_lshl_b32 s3, s46, 1
    s_add_u32 s33, s33, s3
    s_add_u32 s33, s33, 50331648
    s_lshl_b32 s3, s21, 18
    s_add_u32 s43, s33, s3
    s_add_u32 s43, s43, 1835008
    s_lshl_b32 s3, s21, 3
    s_lshl_b32 s3, s3, s32
    s_add_u32 s44, s36, s3
    s_add_u32 s38, s46, 16384
    v_and_b32 v5, 0xffffff80, v8
    v_add_u32 v28, v5, v8
    v_add_u32 v29, 1024, v28
    v_add_u32 v30, 2048, v28
    v_add_u32 v31, 3072, v28
    s_add_u32 s50, s16, s17
    s_and_b32 s50, s50, 3
    s_lshl_b32 s50, s50, 3
    s_mov_b32 s41, 3
    s_add_u32 m0, s38, 98304
    s_lshl_b32 s41, s41, s32
    s_add_u32 s41, s41, s44
    buffer_load_dwordx4 v11, s[28:31], s41 offen offset:0 sc1 lds
    buffer_load_dwordx4 v12, s[28:31], s41 offen offset:1024 sc1 lds
    buffer_load_dwordx4 v13, s[28:31], s41 offen offset:2048 sc1 lds
    buffer_load_dwordx4 v14, s[28:31], s41 offen offset:3072 sc1 lds
    s_waitcnt vmcnt(8)
    s_barrier
    s_mov_b32 s41, 0
    s_add_u32 m0, s46, 0
    s_lshl_b32 s41, s41, 15
    s_add_u32 s41, s41, s43
    buffer_load_dwordx4 v28, s[4:7], s41 offen offset:0 sc1 lds
    buffer_load_dwordx4 v29, s[4:7], s41 offen offset:1024 sc1 lds
    buffer_load_dwordx4 v30, s[4:7], s41 offen offset:2048 sc1 lds
    buffer_load_dwordx4 v31, s[4:7], s41 offen offset:3072 sc1 lds
    s_mov_b32 s41, 0
    s_add_u32 m0, s38, 0
    s_lshl_b32 s41, s41, s32
    s_add_u32 s41, s41, s44
    buffer_load_dwordx4 v11, s[28:31], s41 offen offset:0 sc1 lds
    buffer_load_dwordx4 v12, s[28:31], s41 offen offset:1024 sc1 lds
    buffer_load_dwordx4 v13, s[28:31], s41 offen offset:2048 sc1 lds
    buffer_load_dwordx4 v14, s[28:31], s41 offen offset:3072 sc1 lds
    s_waitcnt vmcnt(12)
    v_add_f32 v128, v128, v132
    v_add_f32 v136, v136, v140
    v_add_f32 v129, v129, v133
    v_add_f32 v137, v137, v141
    v_add_f32 v130, v130, v134
    v_add_f32 v138, v138, v142
    v_add_f32 v131, v131, v135
    v_add_f32 v139, v139, v143
    v_add_f32 v128, v128, v136
    v_add_f32 v129, v129, v137
    v_add_f32 v130, v130, v138
    v_add_f32 v131, v131, v139
    s_nop 0
    v_permlane32_swap_b32 v128, v130
    v_permlane32_swap_b32 v129, v131
    v_add_f32 v128, v128, v130
    v_add_f32 v129, v129, v131
    s_nop 1
    v_permlane16_swap_b32 v128, v129
    v_add_f32 v128, v128, v129
    s_mul_i32 s3, s18, 224
    s_add_u32 s3, s3, 157696
    v_lshl_add_u32 v22, v3, 4, s3
    v_lshl_add_u32 v22, v4, 2, v22
    s_mov_b32 exec_lo, 0x3fff3fff
    s_mov_b32 exec_hi, 0x3fff3fff
    ds_write_b32 v22, v128
    s_mov_b64 exec, -1
    s_waitcnt lgkmcnt(0)
    s_mov_b32 s41, 1
    s_add_u32 m0, s46, 32768
    s_lshl_b32 s41, s41, 15
    s_add_u32 s41, s41, s43
    buffer_load_dwordx4 v28, s[4:7], s41 offen offset:0 sc1 lds
    buffer_load_dwordx4 v29, s[4:7], s41 offen offset:1024 sc1 lds
    buffer_load_dwordx4 v30, s[4:7], s41 offen offset:2048 sc1 lds
    buffer_load_dwordx4 v31, s[4:7], s41 offen offset:3072 sc1 lds
    s_barrier
    s_mov_b32 s41, 1
    s_add_u32 m0, s38, 32768
    s_lshl_b32 s41, s41, s32
    s_add_u32 s41, s41, s44
    buffer_load_dwordx4 v11, s[28:31], s41 offen offset:0 sc1 lds
    buffer_load_dwordx4 v12, s[28:31], s41 offen offset:1024 sc1 lds
    buffer_load_dwordx4 v13, s[28:31], s41 offen offset:2048 sc1 lds
    buffer_load_dwordx4 v14, s[28:31], s41 offen offset:3072 sc1 lds
    s_mov_b32 s41, 2
    s_add_u32 m0, s46, 65536
    s_lshl_b32 s41, s41, 15
    s_add_u32 s41, s41, s43
    buffer_load_dwordx4 v28, s[4:7], s41 offen offset:0 sc1 lds
    buffer_load_dwordx4 v29, s[4:7], s41 offen offset:1024 sc1 lds
    buffer_load_dwordx4 v30, s[4:7], s41 offen offset:2048 sc1 lds
    buffer_load_dwordx4 v31, s[4:7], s41 offen offset:3072 sc1 lds
    s_mov_b32 s41, 2
    s_add_u32 m0, s38, 65536
    s_lshl_b32 s41, s41, s32
    s_add_u32 s41, s41, s44
    buffer_load_dwordx4 v11, s[28:31], s41 offen offset:0 sc1 lds
    buffer_load_dwordx4 v12, s[28:31], s41 offen offset:1024 sc1 lds
    buffer_load_dwordx4 v13, s[28:31], s41 offen offset:2048 sc1 lds
    buffer_load_dwordx4 v14, s[28:31], s41 offen offset:3072 sc1 lds
    s_mov_b32 s41, 3
    s_add_u32 m0, s46, 98304
    s_lshl_b32 s41, s41, 15
    s_add_u32 s41, s41, s43
    buffer_load_dwordx4 v28, s[4:7], s41 offen offset:0 sc1 lds
    buffer_load_dwordx4 v29, s[4:7], s41 offen offset:1024 sc1 lds
    buffer_load_dwordx4 v30, s[4:7], s41 offen offset:2048 sc1 lds
    buffer_load_dwordx4 v31, s[4:7], s41 offen offset:3072 sc1 lds
    s_add_u32 s48, s48, 131072
    s_waitcnt vmcnt(20)
    s_barrier
    s_waitcnt vmcnt(12)
    s_barrier
    s_mov_b32 s41, 4
    s_add_u32 m0, s46, 0
    s_lshl_b32 s41, s41, 15
    s_add_u32 s41, s41, s43
    buffer_load_dwordx4 v28, s[4:7], s41 offen offset:0 sc1 lds
    buffer_load_dwordx4 v29, s[4:7], s41 offen offset:1024 sc1 lds
    buffer_load_dwordx4 v30, s[4:7], s41 offen offset:2048 sc1 lds
    buffer_load_dwordx4 v31, s[4:7], s41 offen offset:3072 sc1 lds
    s_mov_b32 s41, 4
    s_add_u32 m0, s38, 0
    s_lshl_b32 s41, s41, s32
    s_add_u32 s41, s41, s44
    buffer_load_dwordx4 v11, s[28:31], s41 offen offset:0 sc1 lds
    buffer_load_dwordx4 v12, s[28:31], s41 offen offset:1024 sc1 lds
    buffer_load_dwordx4 v13, s[28:31], s41 offen offset:2048 sc1 lds
    buffer_load_dwordx4 v14, s[28:31], s41 offen offset:3072 sc1 lds
    s_waitcnt vmcnt(12)
    s_barrier
    s_mov_b32 s41, 5
    s_add_u32 m0, s46, 32768
    s_lshl_b32 s41, s41, 15
    s_add_u32 s41, s41, s43
    buffer_load_dwordx4 v28, s[4:7], s41 offen offset:0 sc1 lds
    buffer_load_dwordx4 v29, s[4:7], s41 offen offset:1024 sc1 lds
    buffer_load_dwordx4 v30, s[4:7], s41 offen offset:2048 sc1 lds
    buffer_load_dwordx4 v31, s[4:7], s41 offen offset:3072 sc1 lds
    s_mov_b32 s41, 5
    s_add_u32 m0, s38, 32768
    s_lshl_b32 s41, s41, s32
    s_add_u32 s41, s41, s44
    buffer_load_dwordx4 v11, s[28:31], s41 offen offset:0 sc1 lds
    buffer_load_dwordx4 v12, s[28:31], s41 offen offset:1024 sc1 lds
    buffer_load_dwordx4 v13, s[28:31], s41 offen offset:2048 sc1 lds
    buffer_load_dwordx4 v14, s[28:31], s41 offen offset:3072 sc1 lds
    s_waitcnt vmcnt(16)
    s_barrier
    s_mov_b32 s41, 6
    s_add_u32 m0, s46, 65536
    s_lshl_b32 s41, s41, 15
    s_add_u32 s41, s41, s43
    buffer_load_dwordx4 v28, s[4:7], s41 offen offset:0 sc1 lds
    buffer_load_dwordx4 v29, s[4:7], s41 offen offset:1024 sc1 lds
    buffer_load_dwordx4 v30, s[4:7], s41 offen offset:2048 sc1 lds
    buffer_load_dwordx4 v31, s[4:7], s41 offen offset:3072 sc1 lds
    s_mov_b32 s41, 6
    s_add_u32 m0, s38, 65536
    s_lshl_b32 s41, s41, s32
    s_add_u32 s41, s41, s44
    buffer_load_dwordx4 v11, s[28:31], s41 offen offset:0 sc1 lds
    buffer_load_dwordx4 v12, s[28:31], s41 offen offset:1024 sc1 lds
    buffer_load_dwordx4 v13, s[28:31], s41 offen offset:2048 sc1 lds
    buffer_load_dwordx4 v14, s[28:31], s41 offen offset:3072 sc1 lds
    s_waitcnt vmcnt(16)
    s_barrier
    s_mov_b32 s41, 7
    s_add_u32 m0, s46, 98304
    s_lshl_b32 s41, s41, 15
    s_add_u32 s41, s41, s43
    buffer_load_dwordx4 v28, s[4:7], s41 offen offset:0 sc1 lds
    buffer_load_dwordx4 v29, s[4:7], s41 offen offset:1024 sc1 lds
    buffer_load_dwordx4 v30, s[4:7], s41 offen offset:2048 sc1 lds
    buffer_load_dwordx4 v31, s[4:7], s41 offen offset:3072 sc1 lds
    s_mov_b32 s41, 7
    s_add_u32 m0, s38, 98304
    s_lshl_b32 s41, s41, s32
    s_add_u32 s41, s41, s44
    buffer_load_dwordx4 v11, s[28:31], s41 offen offset:0 sc1 lds
    buffer_load_dwordx4 v12, s[28:31], s41 offen offset:1024 sc1 lds
    buffer_load_dwordx4 v13, s[28:31], s41 offen offset:2048 sc1 lds
    buffer_load_dwordx4 v14, s[28:31], s41 offen offset:3072 sc1 lds
    s_mul_i32 s44, s21, 31
    s_lshl_b32 s44, s44, s32
    s_add_u32 s44, s44, s35
    s_waitcnt vmcnt(16)
    s_barrier
    s_mul_i32 s3, s21, 1015808
    s_add_u32 s43, s33, s3
    buffer_load_dword v20, v61, s[4:7], s48 offen sc1
    s_mov_b32 s41, 0
    s_add_u32 m0, s38, 0
    s_lshl_b32 s41, s41, s32
    s_add_u32 s41, s41, s44
    buffer_load_dwordx4 v11, s[52:55], s41 offen offset:0 sc1 lds
    buffer_load_dwordx4 v12, s[52:55], s41 offen offset:1024 sc1 lds
    buffer_load_dwordx4 v13, s[52:55], s41 offen offset:2048 sc1 lds
    buffer_load_dwordx4 v14, s[52:55], s41 offen offset:3072 sc1 lds
    s_waitcnt vmcnt(4)
    v_cmp_ne_u32 vcc, s12, v20
    s_cbranch_vccnz L_h2at6_46
    s_mov_b32 s41, 0
    s_add_u32 m0, s46, 0
    s_lshl_b32 s41, s41, 15
    s_add_u32 s41, s41, s43
    buffer_load_dwordx4 v28, s[4:7], s41 offen offset:0 sc1 lds
    buffer_load_dwordx4 v29, s[4:7], s41 offen offset:1024 sc1 lds
    buffer_load_dwordx4 v30, s[4:7], s41 offen offset:2048 sc1 lds
    buffer_load_dwordx4 v31, s[4:7], s41 offen offset:3072 sc1 lds
    s_barrier
    s_mov_b32 s41, 1
    s_add_u32 m0, s38, 32768
    s_lshl_b32 s41, s41, s32
    s_add_u32 s41, s41, s44
    buffer_load_dwordx4 v11, s[52:55], s41 offen offset:0 sc1 lds
    buffer_load_dwordx4 v12, s[52:55], s41 offen offset:1024 sc1 lds
    buffer_load_dwordx4 v13, s[52:55], s41 offen offset:2048 sc1 lds
    buffer_load_dwordx4 v14, s[52:55], s41 offen offset:3072 sc1 lds
    s_mov_b32 s41, 1
    s_add_u32 m0, s46, 32768
    s_lshl_b32 s41, s41, 15
    s_add_u32 s41, s41, s43
    buffer_load_dwordx4 v28, s[4:7], s41 offen offset:0 sc1 lds
    buffer_load_dwordx4 v29, s[4:7], s41 offen offset:1024 sc1 lds
    buffer_load_dwordx4 v30, s[4:7], s41 offen offset:2048 sc1 lds
    buffer_load_dwordx4 v31, s[4:7], s41 offen offset:3072 sc1 lds
    s_waitcnt vmcnt(16)
    s_barrier
    s_mov_b32 s41, 2
    s_add_u32 m0, s38, 65536
    s_lshl_b32 s41, s41, s32
    s_add_u32 s41, s41, s44
    buffer_load_dwordx4 v11, s[52:55], s41 offen offset:0 sc1 lds
    buffer_load_dwordx4 v12, s[52:55], s41 offen offset:1024 sc1 lds
    buffer_load_dwordx4 v13, s[52:55], s41 offen offset:2048 sc1 lds
    buffer_load_dwordx4 v14, s[52:55], s41 offen offset:3072 sc1 lds
    s_mov_b32 s41, 2
    s_add_u32 m0, s46, 65536
    s_lshl_b32 s41, s41, 15
    s_add_u32 s41, s41, s43
    buffer_load_dwordx4 v28, s[4:7], s41 offen offset:0 sc1 lds
    buffer_load_dwordx4 v29, s[4:7], s41 offen offset:1024 sc1 lds
    buffer_load_dwordx4 v30, s[4:7], s41 offen offset:2048 sc1 lds
    buffer_load_dwordx4 v31, s[4:7], s41 offen offset:3072 sc1 lds
    s_waitcnt vmcnt(16)
    s_barrier
    s_branch L_h2go_50
L_h2at6_46:
    s_barrier
    buffer_load_dword v20, v61, s[4:7], s48 offen sc1
    s_mov_b32 s41, 1
    s_add_u32 m0, s38, 32768
    s_lshl_b32 s41, s41, s32
    s_add_u32 s41, s41, s44
    buffer_load_dwordx4 v11, s[52:55], s41 offen offset:0 sc1 lds
    buffer_load_dwordx4 v12, s[52:55], s41 offen offset:1024 sc1 lds
    buffer_load_dwordx4 v13, s[52:55], s41 offen offset:2048 sc1 lds
    buffer_load_dwordx4 v14, s[52:55], s41 offen offset:3072 sc1 lds
    s_waitcnt vmcnt(4)
    v_cmp_ne_u32 vcc, s12, v20
    s_cbranch_vccnz L_h2at7_47
    s_mov_b32 s41, 0
    s_add_u32 m0, s46, 0
    s_lshl_b32 s41, s41, 15
    s_add_u32 s41, s41, s43
    buffer_load_dwordx4 v28, s[4:7], s41 offen offset:0 sc1 lds
    buffer_load_dwordx4 v29, s[4:7], s41 offen offset:1024 sc1 lds
    buffer_load_dwordx4 v30, s[4:7], s41 offen offset:2048 sc1 lds
    buffer_load_dwordx4 v31, s[4:7], s41 offen offset:3072 sc1 lds
    s_mov_b32 s41, 1
    s_add_u32 m0, s46, 32768
    s_lshl_b32 s41, s41, 15
    s_add_u32 s41, s41, s43
    buffer_load_dwordx4 v28, s[4:7], s41 offen offset:0 sc1 lds
    buffer_load_dwordx4 v29, s[4:7], s41 offen offset:1024 sc1 lds
    buffer_load_dwordx4 v30, s[4:7], s41 offen offset:2048 sc1 lds
    buffer_load_dwordx4 v31, s[4:7], s41 offen offset:3072 sc1 lds
    s_barrier
    s_mov_b32 s41, 2
    s_add_u32 m0, s38, 65536
    s_lshl_b32 s41, s41, s32
    s_add_u32 s41, s41, s44
    buffer_load_dwordx4 v11, s[52:55], s41 offen offset:0 sc1 lds
    buffer_load_dwordx4 v12, s[52:55], s41 offen offset:1024 sc1 lds
    buffer_load_dwordx4 v13, s[52:55], s41 offen offset:2048 sc1 lds
    buffer_load_dwordx4 v14, s[52:55], s41 offen offset:3072 sc1 lds
    s_mov_b32 s41, 2
    s_add_u32 m0, s46, 65536
    s_lshl_b32 s41, s41, 15
    s_add_u32 s41, s41, s43
    buffer_load_dwordx4 v28, s[4:7], s41 offen offset:0 sc1 lds
    buffer_load_dwordx4 v29, s[4:7], s41 offen offset:1024 sc1 lds
    buffer_load_dwordx4 v30, s[4:7], s41 offen offset:2048 sc1 lds
    buffer_load_dwordx4 v31, s[4:7], s41 offen offset:3072 sc1 lds
    s_waitcnt vmcnt(12)
    s_barrier
    s_branch L_h2go_50
L_h2at7_47:
    s_barrier
    buffer_load_dword v20, v61, s[4:7], s48 offen sc1
    s_mov_b32 s41, 2
    s_add_u32 m0, s38, 65536
    s_lshl_b32 s41, s41, s32
    s_add_u32 s41, s41, s44
    buffer_load_dwordx4 v11, s[52:55], s41 offen offset:0 sc1 lds
    buffer_load_dwordx4 v12, s[52:55], s41 offen offset:1024 sc1 lds
    buffer_load_dwordx4 v13, s[52:55], s41 offen offset:2048 sc1 lds
    buffer_load_dwordx4 v14, s[52:55], s41 offen offset:3072 sc1 lds
    s_waitcnt vmcnt(4)
    s_mov_b32 s62, 0x8000
L_h2sp_52:
    v_cmp_ne_u32 vcc, s12, v20
    s_cbranch_vccz L_h2ok_51
    s_sub_u32 s62, s62, 1
    s_cmp_eq_u32 s62, 0
    s_cbranch_scc1 L_h2ok_51
    s_sleep 2
    buffer_load_dword v20, v61, s[4:7], s48 offen sc1
    s_waitcnt vmcnt(0)
    s_branch L_h2sp_52
L_h2ok_51:
    s_mov_b32 s41, 0
    s_add_u32 m0, s46, 0
    s_lshl_b32 s41, s41, 15
    s_add_u32 s41, s41, s43
    buffer_load_dwordx4 v28, s[4:7], s41 offen offset:0 sc1 lds
    buffer_load_dwordx4 v29, s[4:7], s41 offen offset:1024 sc1 lds
    buffer_load_dwordx4 v30, s[4:7], s41 offen offset:2048 sc1 lds
    buffer_load_dwordx4 v31, s[4:7], s41 offen offset:3072 sc1 lds
    s_mov_b32 s41, 1
    s_add_u32 m0, s46, 32768
    s_lshl_b32 s41, s41, 15
    s_add_u32 s41, s41, s43
    buffer_load_dwordx4 v28, s[4:7], s41 offen offset:0 sc1 lds
    buffer_load_dwordx4 v29, s[4:7], s41 offen offset:1024 sc1 lds
    buffer_load_dwordx4 v30, s[4:7], s41 offen offset:2048 sc1 lds
    buffer_load_dwordx4 v31, s[4:7], s41 offen offset:3072 sc1 lds
    s_mov_b32 s41, 2
    s_add_u32 m0, s46, 65536
    s_lshl_b32 s41, s41, 15
    s_add_u32 s41, s41, s43
    buffer_load_dwordx4 v28, s[4:7], s41 offen offset:0 sc1 lds
    buffer_load_dwordx4 v29, s[4:7], s41 offen offset:1024 sc1 lds
    buffer_load_dwordx4 v30, s[4:7], s41 offen offset:2048 sc1 lds
    buffer_load_dwordx4 v31, s[4:7], s41 offen offset:3072 sc1 lds
    s_waitcnt vmcnt(8)
    s_barrier
    s_waitcnt vmcnt(4)
L_h2go_50:
    s_mov_b32 s41, 3
    s_add_u32 m0, s46, 98304
    s_lshl_b32 s41, s41, 15
    s_add_u32 s41, s41, s43
    buffer_load_dwordx4 v28, s[4:7], s41 offen offset:0 sc1 lds
    buffer_load_dwordx4 v29, s[4:7], s41 offen offset:1024 sc1 lds
    buffer_load_dwordx4 v30, s[4:7], s41 offen offset:2048 sc1 lds
    buffer_load_dwordx4 v31, s[4:7], s41 offen offset:3072 sc1 lds
    s_mov_b32 s41, 3
    s_add_u32 m0, s38, 98304
    s_lshl_b32 s41, s41, s32
    s_add_u32 s41, s41, s44
    buffer_load_dwordx4 v11, s[52:55], s41 offen offset:0 sc1 lds
    buffer_load_dwordx4 v12, s[52:55], s41 offen offset:1024 sc1 lds
    buffer_load_dwordx4 v13, s[52:55], s41 offen offset:2048 sc1 lds
    buffer_load_dwordx4 v14, s[52:55], s41 offen offset:3072 sc1 lds
    s_waitcnt vmcnt(16)
    s_barrier
    s_mov_b32 s41, 4
    s_add_u32 m0, s46, 0
    s_lshl_b32 s41, s41, 15
    s_add_u32 s41, s41, s43
    buffer_load_dwordx4 v28, s[4:7], s41 offen offset:0 sc1 lds
    buffer_load_dwordx4 v29, s[4:7], s41 offen offset:1024 sc1 lds
    buffer_load_dwordx4 v30, s[4:7], s41 offen offset:2048 sc1 lds
    buffer_load_dwordx4 v31, s[4:7], s41 offen offset:3072 sc1 lds
    s_mov_b32 s41, 4
    s_add_u32 m0, s38, 0
    s_lshl_b32 s41, s41, s32
    s_add_u32 s41, s41, s44
    buffer_load_dwordx4 v11, s[52:55], s41 offen offset:0 sc1 lds
    buffer_load_dwordx4 v12, s[52:55], s41 offen offset:1024 sc1 lds
    buffer_load_dwordx4 v13, s[52:55], s41 offen offset:2048 sc1 lds
    buffer_load_dwordx4 v14, s[52:55], s41 offen offset:3072 sc1 lds
    s_waitcnt vmcnt(16)
    s_barrier
    s_mov_b32 s41, 5
    s_add_u32 m0, s46, 32768
    s_lshl_b32 s41, s41, 15
    s_add_u32 s41, s41, s43
    buffer_load_dwordx4 v28, s[4:7], s41 offen offset:0 sc1 lds
    buffer_load_dwordx4 v29, s[4:7], s41 offen offset:1024 sc1 lds
    buffer_load_dwordx4 v30, s[4:7], s41 offen offset:2048 sc1 lds
    buffer_load_dwordx4 v31, s[4:7], s41 offen offset:3072 sc1 lds
    s_mov_b32 s41, 5
    s_add_u32 m0, s38, 32768
    s_lshl_b32 s41, s41, s32
    s_add_u32 s41, s41, s44
    buffer_load_dwordx4 v11, s[52:55], s41 offen offset:0 sc1 lds
    buffer_load_dwordx4 v12, s[52:55], s41 offen offset:1024 sc1 lds
    buffer_load_dwordx4 v13, s[52:55], s41 offen offset:2048 sc1 lds
    buffer_load_dwordx4 v14, s[52:55], s41 offen offset:3072 sc1 lds
    s_waitcnt vmcnt(16)
    s_barrier
    s_mov_b32 s41, 6
    s_add_u32 m0, s46, 65536
    s_lshl_b32 s41, s41, 15
    s_add_u32 s41, s41, s43
    buffer_load_dwordx4 v28, s[4:7], s41 offen offset:0 sc1 lds
    buffer_load_dwordx4 v29, s[4:7], s41 offen offset:1024 sc1 lds
    buffer_load_dwordx4 v30, s[4:7], s41 offen offset:2048 sc1 lds
    buffer_load_dwordx4 v31, s[4:7], s41 offen offset:3072 sc1 lds
    s_mov_b32 s41, 6
    s_add_u32 m0, s38, 65536
    s_lshl_b32 s41, s41, s32
    s_add_u32 s41, s41, s44
    buffer_load_dwordx4 v11, s[52:55], s41 offen offset:0 sc1 lds
    buffer_load_dwordx4 v12, s[52:55], s41 offen offset:1024 sc1 lds
    buffer_load_dwordx4 v13, s[52:55], s41 offen offset:2048 sc1 lds
    buffer_load_dwordx4 v14, s[52:55], s41 offen offset:3072 sc1 lds
    s_waitcnt vmcnt(16)
    s_barrier
    s_mov_b32 s41, 7
    s_add_u32 m0, s46, 98304
    s_lshl_b32 s41, s41, 15
    s_add_u32 s41, s41, s43
    buffer_load_dwordx4 v28, s[4:7], s41 offen offset:0 sc1 lds
    buffer_load_dwordx4 v29, s[4:7], s41 offen offset:1024 sc1 lds
    buffer_load_dwordx4 v30, s[4:7], s41 offen offset:2048 sc1 lds
    buffer_load_dwordx4 v31, s[4:7], s41 offen offset:3072 sc1 lds
    s_mov_b32 s41, 7
    s_add_u32 m0, s38, 98304
    s_lshl_b32 s41, s41, s32
    s_add_u32 s41, s41, s44
    buffer_load_dwordx4 v11, s[52:55], s41 offen offset:0 sc1 lds
    buffer_load_dwordx4 v12, s[52:55], s41 offen offset:1024 sc1 lds
    buffer_load_dwordx4 v13, s[52:55], s41 offen offset:2048 sc1 lds
    buffer_load_dwordx4 v14, s[52:55], s41 offen offset:3072 sc1 lds
    s_waitcnt vmcnt(16)
    s_barrier
    s_mov_b32 s41, 8
    s_add_u32 m0, s46, 0
    s_lshl_b32 s41, s41, 15
    s_add_u32 s41, s41, s43
    buffer_load_dwordx4 v28, s[4:7], s41 offen offset:0 sc1 lds
    buffer_load_dwordx4 v29, s[4:7], s41 offen offset:1024 sc1 lds
    buffer_load_dwordx4 v30, s[4:7], s41 offen offset:2048 sc1 lds
    buffer_load_dwordx4 v31, s[4:7], s41 offen offset:3072 sc1 lds
    s_mov_b32 s41, 8
    s_add_u32 m0, s38, 0
    s_lshl_b32 s41, s41, s32
    s_add_u32 s41, s41, s44
    buffer_load_dwordx4 v11, s[52:55], s41 offen offset:0 sc1 lds
    buffer_load_dwordx4 v12, s[52:55], s41 offen offset:1024 sc1 lds
    buffer_load_dwordx4 v13, s[52:55], s41 offen offset:2048 sc1 lds
    buffer_load_dwordx4 v14, s[52:55], s41 offen offset:3072 sc1 lds
    s_waitcnt vmcnt(16)
    s_barrier
    s_mov_b32 s41, 9
    s_add_u32 m0, s46, 32768
    s_lshl_b32 s41, s41, 15
    s_add_u32 s41, s41, s43
    buffer_load_dwordx4 v28, s[4:7], s41 offen offset:0 sc1 lds
    buffer_load_dwordx4 v29, s[4:7], s41 offen offset:1024 sc1 lds
    buffer_load_dwordx4 v30, s[4:7], s41 offen offset:2048 sc1 lds
    buffer_load_dwordx4 v31, s[4:7], s41 offen offset:3072 sc1 lds
    s_mov_b32 s41, 9
    s_add_u32 m0, s38, 32768
    s_lshl_b32 s41, s41, s32
    s_add_u32 s41, s41, s44
    buffer_load_dwordx4 v11, s[52:55], s41 offen offset:0 sc1 lds
    buffer_load_dwordx4 v12, s[52:55], s41 offen offset:1024 sc1 lds
    buffer_load_dwordx4 v13, s[52:55], s41 offen offset:2048 sc1 lds
    buffer_load_dwordx4 v14, s[52:55], s41 offen offset:3072 sc1 lds
    s_waitcnt vmcnt(16)
    s_barrier
    s_mov_b32 s41, 10
    s_add_u32 m0, s46, 65536
    s_lshl_b32 s41, s41, 15
    s_add_u32 s41, s41, s43
    buffer_load_dwordx4 v28, s[4:7], s41 offen offset:0 sc1 lds
    buffer_load_dwordx4 v29, s[4:7], s41 offen offset:1024 sc1 lds
    buffer_load_dwordx4 v30, s[4:7], s41 offen offset:2048 sc1 lds
    buffer_load_dwordx4 v31, s[4:7], s41 offen offset:3072 sc1 lds
    s_mov_b32 s41, 10
    s_add_u32 m0, s38, 65536
    s_lshl_b32 s41, s41, s32
    s_add_u32 s41, s41, s44
    buffer_load_dwordx4 v11, s[52:55], s41 offen offset:0 sc1 lds
    buffer_load_dwordx4 v12, s[52:55], s41 offen offset:1024 sc1 lds
    buffer_load_dwordx4 v13, s[52:55], s41 offen offset:2048 sc1 lds
    buffer_load_dwordx4 v14, s[52:55], s41 offen offset:3072 sc1 lds
    s_waitcnt vmcnt(16)
    s_barrier
    s_mov_b32 s41, 11
    s_add_u32 m0, s46, 98304
    s_lshl_b32 s41, s41, 15
    s_add_u32 s41, s41, s43
    buffer_load_dwordx4 v28, s[4:7], s41 offen offset:0 sc1 lds
    buffer_load_dwordx4 v29, s[4:7], s41 offen offset:1024 sc1 lds
    buffer_load_dwordx4 v30, s[4:7], s41 offen offset:2048 sc1 lds
    buffer_load_dwordx4 v31, s[4:7], s41 offen offset:3072 sc1 lds
    s_mov_b32 s41, 11
    s_add_u32 m0, s38, 98304
    s_lshl_b32 s41, s41, s32
    s_add_u32 s41, s41, s44
    buffer_load_dwordx4 v11, s[52:55], s41 offen offset:0 sc1 lds
    buffer_load_dwordx4 v12, s[52:55], s41 offen offset:1024 sc1 lds
    buffer_load_dwordx4 v13, s[52:55], s41 offen offset:2048 sc1 lds
    buffer_load_dwordx4 v14, s[52:55], s41 offen offset:3072 sc1 lds
    s_waitcnt vmcnt(16)
    s_barrier
    s_mov_b32 s41, 12
    s_add_u32 m0, s46, 0
    s_lshl_b32 s41, s41, 15
    s_add_u32 s41, s41, s43
    buffer_load_dwordx4 v28, s[4:7], s41 offen offset:0 sc1 lds
    buffer_load_dwordx4 v29, s[4:7], s41 offen offset:1024 sc1 lds
    buffer_load_dwordx4 v30, s[4:7], s41 offen offset:2048 sc1 lds
    buffer_load_dwordx4 v31, s[4:7], s41 offen offset:3072 sc1 lds
    s_mov_b32 s41, 12
    s_add_u32 m0, s38, 0
    s_lshl_b32 s41, s41, s32
    s_add_u32 s41, s41, s44
    buffer_load_dwordx4 v11, s[52:55], s41 offen offset:0 sc1 lds
    buffer_load_dwordx4 v12, s[52:55], s41 offen offset:1024 sc1 lds
    buffer_load_dwordx4 v13, s[52:55], s41 offen offset:2048 sc1 lds
    buffer_load_dwordx4 v14, s[52:55], s41 offen offset:3072 sc1 lds
    s_waitcnt vmcnt(16)
    s_barrier
    s_mov_b32 s41, 13
    s_add_u32 m0, s46, 32768
    s_lshl_b32 s41, s41, 15
    s_add_u32 s41, s41, s43
    buffer_load_dwordx4 v28, s[4:7], s41 offen offset:0 sc1 lds
    buffer_load_dwordx4 v29, s[4:7], s41 offen offset:1024 sc1 lds
    buffer_load_dwordx4 v30, s[4:7], s41 offen offset:2048 sc1 lds
    buffer_load_dwordx4 v31, s[4:7], s41 offen offset:3072 sc1 lds
    s_mov_b32 s41, 13
    s_add_u32 m0, s38, 32768
    s_lshl_b32 s41, s41, s32
    s_add_u32 s41, s41, s44
    buffer_load_dwordx4 v11, s[52:55], s41 offen offset:0 sc1 lds
    buffer_load_dwordx4 v12, s[52:55], s41 offen offset:1024 sc1 lds
    buffer_load_dwordx4 v13, s[52:55], s41 offen offset:2048 sc1 lds
    buffer_load_dwordx4 v14, s[52:55], s41 offen offset:3072 sc1 lds
    s_waitcnt vmcnt(16)
    s_barrier
    s_mov_b32 s41, 14
    s_add_u32 m0, s46, 65536
    s_lshl_b32 s41, s41, 15
    s_add_u32 s41, s41, s43
    buffer_load_dwordx4 v28, s[4:7], s41 offen offset:0 sc1 lds
    buffer_load_dwordx4 v29, s[4:7], s41 offen offset:1024 sc1 lds
    buffer_load_dwordx4 v30, s[4:7], s41 offen offset:2048 sc1 lds
    buffer_load_dwordx4 v31, s[4:7], s41 offen offset:3072 sc1 lds
    s_mov_b32 s41, 14
    s_add_u32 m0, s38, 65536
    s_lshl_b32 s41, s41, s32
    s_add_u32 s41, s41, s44
    buffer_load_dwordx4 v11, s[52:55], s41 offen offset:0 sc1 lds
    buffer_load_dwordx4 v12, s[52:55], s41 offen offset:1024 sc1 lds
    buffer_load_dwordx4 v13, s[52:55], s41 offen offset:2048 sc1 lds
    buffer_load_dwordx4 v14, s[52:55], s41 offen offset:3072 sc1 lds
    s_waitcnt vmcnt(16)
    s_barrier
    s_mov_b32 s41, 15
    s_add_u32 m0, s46, 98304
    s_lshl_b32 s41, s41, 15
    s_add_u32 s41, s41, s43
    buffer_load_dwordx4 v28, s[4:7], s41 offen offset:0 sc1 lds
    buffer_load_dwordx4 v29, s[4:7], s41 offen offset:1024 sc1 lds
    buffer_load_dwordx4 v30, s[4:7], s41 offen offset:2048 sc1 lds
    buffer_load_dwordx4 v31, s[4:7], s41 offen offset:3072 sc1 lds
    s_mov_b32 s41, 15
    s_add_u32 m0, s38, 98304
    s_lshl_b32 s41, s41, s32
    s_add_u32 s41, s41, s44
    buffer_load_dwordx4 v11, s[52:55], s41 offen offset:0 sc1 lds
    buffer_load_dwordx4 v12, s[52:55], s41 offen offset:1024 sc1 lds
    buffer_load_dwordx4 v13, s[52:55], s41 offen offset:2048 sc1 lds
    buffer_load_dwordx4 v14, s[52:55], s41 offen offset:3072 sc1 lds
    s_xor_b32 s48, s48, 128
    buffer_load_dword v20, v61, s[4:7], s48 offen sc1
    s_waitcnt vmcnt(17)
    s_barrier
    s_mov_b32 s41, 16
    s_add_u32 m0, s46, 0
    s_lshl_b32 s41, s41, 15
    s_add_u32 s41, s41, s43
    buffer_load_dwordx4 v28, s[4:7], s41 offen offset:0 sc1 lds
    buffer_load_dwordx4 v29, s[4:7], s41 offen offset:1024 sc1 lds
    buffer_load_dwordx4 v30, s[4:7], s41 offen offset:2048 sc1 lds
    buffer_load_dwordx4 v31, s[4:7], s41 offen offset:3072 sc1 lds
    s_mov_b32 s41, 16
    s_add_u32 m0, s38, 0
    s_lshl_b32 s41, s41, s32
    s_add_u32 s41, s41, s44
    buffer_load_dwordx4 v11, s[52:55], s41 offen offset:0 sc1 lds
    buffer_load_dwordx4 v12, s[52:55], s41 offen offset:1024 sc1 lds
    buffer_load_dwordx4 v13, s[52:55], s41 offen offset:2048 sc1 lds
    buffer_load_dwordx4 v14, s[52:55], s41 offen offset:3072 sc1 lds
    s_waitcnt vmcnt(17)
    s_barrier
    s_mov_b32 s41, 17
    s_add_u32 m0, s46, 32768
    s_lshl_b32 s41, s41, 15
    s_add_u32 s41, s41, s43
    buffer_load_dwordx4 v28, s[4:7], s41 offen offset:0 sc1 lds
    buffer_load_dwordx4 v29, s[4:7], s41 offen offset:1024 sc1 lds
    buffer_load_dwordx4 v30, s[4:7], s41 offen offset:2048 sc1 lds
    buffer_load_dwordx4 v31, s[4:7], s41 offen offset:3072 sc1 lds
    s_mov_b32 s41, 17
    s_add_u32 m0, s38, 32768
    s_lshl_b32 s41, s41, s32
    s_add_u32 s41, s41, s44
    buffer_load_dwordx4 v11, s[52:55], s41 offen offset:0 sc1 lds
    buffer_load_dwordx4 v12, s[52:55], s41 offen offset:1024 sc1 lds
    buffer_load_dwordx4 v13, s[52:55], s41 offen offset:2048 sc1 lds
    buffer_load_dwordx4 v14, s[52:55], s41 offen offset:3072 sc1 lds
    s_waitcnt vmcnt(17)
    s_barrier
    s_mov_b32 s41, 18
    s_add_u32 m0, s46, 65536
    s_lshl_b32 s41, s41, 15
    s_add_u32 s41, s41, s43
    buffer_load_dwordx4 v28, s[4:7], s41 offen offset:0 sc1 lds
    buffer_load_dwordx4 v29, s[4:7], s41 offen offset:1024 sc1 lds
    buffer_load_dwordx4 v30, s[4:7], s41 offen offset:2048 sc1 lds
    buffer_load_dwordx4 v31, s[4:7], s41 offen offset:3072 sc1 lds
    s_mov_b32 s41, 18
    s_add_u32 m0, s38, 65536
    s_lshl_b32 s41, s41, s32
    s_add_u32 s41, s41, s44
    buffer_load_dwordx4 v11, s[52:55], s41 offen offset:0 sc1 lds
    buffer_load_dwordx4 v12, s[52:55], s41 offen offset:1024 sc1 lds
    buffer_load_dwordx4 v13, s[52:55], s41 offen offset:2048 sc1 lds
    buffer_load_dwordx4 v14, s[52:55], s41 offen offset:3072 sc1 lds
    s_waitcnt vmcnt(16)
    s_barrier
    s_waitcnt vmcnt(24)
    s_mov_b32 s62, 0x8000
L_h2bsp_54:
    v_cmp_ne_u32 vcc, s12, v20
    s_cbranch_vccz L_h2bok_53
    s_sub_u32 s62, s62, 1
    s_cmp_eq_u32 s62, 0
    s_cbranch_scc1 L_h2bok_53
    s_sleep 2
    buffer_load_dword v20, v61, s[4:7], s48 offen sc1
    s_waitcnt vmcnt(0)
    s_branch L_h2bsp_54
L_h2bok_53:
    s_xor_b32 s3, s19, 8
    s_lshl_b32 s47, s3, 14
    s_lshl_b32 s45, s18, 12
    s_add_u32 s47, s47, s45
    s_add_u32 s47, s47, 41943040
    s_lshl_b32 s48, s3, 9
    s_lshl_b32 s41, s18, 7
    s_add_u32 s48, s48, s41
    s_add_u32 s48, s48, 46399488
    s_mov_b32 s41, 19
    s_add_u32 m0, s46, 98304
    s_lshl_b32 s41, s41, 15
    s_add_u32 s41, s41, s43
    buffer_load_dwordx4 v28, s[4:7], s41 offen offset:0 sc1 lds
    buffer_load_dwordx4 v29, s[4:7], s41 offen offset:1024 sc1 lds
    buffer_load_dwordx4 v30, s[4:7], s41 offen offset:2048 sc1 lds
    buffer_load_dwordx4 v31, s[4:7], s41 offen offset:3072 sc1 lds
    s_mov_b32 s41, 19
    s_add_u32 m0, s38, 98304
    s_lshl_b32 s41, s41, s32
    s_add_u32 s41, s41, s44
    buffer_load_dwordx4 v11, s[52:55], s41 offen offset:0 sc1 lds
    buffer_load_dwordx4 v12, s[52:55], s41 offen offset:1024 sc1 lds
    buffer_load_dwordx4 v13, s[52:55], s41 offen offset:2048 sc1 lds
    buffer_load_dwordx4 v14, s[52:55], s41 offen offset:3072 sc1 lds
    s_waitcnt vmcnt(16)
    s_barrier
    s_mov_b32 s41, 20
    s_add_u32 m0, s46, 0
    s_lshl_b32 s41, s41, 15
    s_add_u32 s41, s41, s43
    buffer_load_dwordx4 v28, s[4:7], s41 offen offset:0 sc1 lds
    buffer_load_dwordx4 v29, s[4:7], s41 offen offset:1024 sc1 lds
    buffer_load_dwordx4 v30, s[4:7], s41 offen offset:2048 sc1 lds
    buffer_load_dwordx4 v31, s[4:7], s41 offen offset:3072 sc1 lds
    s_mov_b32 s41, 20
    s_add_u32 m0, s38, 0
    s_lshl_b32 s41, s41, s32
    s_add_u32 s41, s41, s44
    buffer_load_dwordx4 v11, s[52:55], s41 offen offset:0 sc1 lds
    buffer_load_dwordx4 v12, s[52:55], s41 offen offset:1024 sc1 lds
    buffer_load_dwordx4 v13, s[52:55], s41 offen offset:2048 sc1 lds
    buffer_load_dwordx4 v14, s[52:55], s41 offen offset:3072 sc1 lds
    s_waitcnt vmcnt(16)
    s_barrier
    s_mov_b32 s41, 21
    s_add_u32 m0, s46, 32768
    s_lshl_b32 s41, s41, 15
    s_add_u32 s41, s41, s43
    buffer_load_dwordx4 v28, s[4:7], s41 offen offset:0 sc1 lds
    buffer_load_dwordx4 v29, s[4:7], s41 offen offset:1024 sc1 lds
    buffer_load_dwordx4 v30, s[4:7], s41 offen offset:2048 sc1 lds
    buffer_load_dwordx4 v31, s[4:7], s41 offen offset:3072 sc1 lds
    s_mov_b32 s41, 21
    s_add_u32 m0, s38, 32768
    s_lshl_b32 s41, s41, s32
    s_add_u32 s41, s41, s44
    buffer_load_dwordx4 v11, s[52:55], s41 offen offset:0 sc1 lds
    buffer_load_dwordx4 v12, s[52:55], s41 offen offset:1024 sc1 lds
    buffer_load_dwordx4 v13, s[52:55], s41 offen offset:2048 sc1 lds
    buffer_load_dwordx4 v14, s[52:55], s41 offen offset:3072 sc1 lds
    s_waitcnt vmcnt(16)
    s_barrier
    s_mov_b32 s41, 22
    s_add_u32 m0, s46, 65536
    s_lshl_b32 s41, s41, 15
    s_add_u32 s41, s41, s43
    buffer_load_dwordx4 v28, s[4:7], s41 offen offset:0 sc1 lds
    buffer_load_dwordx4 v29, s[4:7], s41 offen offset:1024 sc1 lds
    buffer_load_dwordx4 v30, s[4:7], s41 offen offset:2048 sc1 lds
    buffer_load_dwordx4 v31, s[4:7], s41 offen offset:3072 sc1 lds
    s_mov_b32 s41, 22
    s_add_u32 m0, s38, 65536
    s_lshl_b32 s41, s41, s32
    s_add_u32 s41, s41, s44
    buffer_load_dwordx4 v11, s[52:55], s41 offen offset:0 sc1 lds
    buffer_load_dwordx4 v12, s[52:55], s41 offen offset:1024 sc1 lds
    buffer_load_dwordx4 v13, s[52:55], s41 offen offset:2048 sc1 lds
    buffer_load_dwordx4 v14, s[52:55], s41 offen offset:3072 sc1 lds
    s_waitcnt vmcnt(16)
    s_barrier
    s_mov_b32 s41, 23
    s_add_u32 m0, s46, 98304
    s_lshl_b32 s41, s41, 15
    s_add_u32 s41, s41, s43
    buffer_load_dwordx4 v28, s[4:7], s41 offen offset:0 sc1 lds
    buffer_load_dwordx4 v29, s[4:7], s41 offen offset:1024 sc1 lds
    buffer_load_dwordx4 v30, s[4:7], s41 offen offset:2048 sc1 lds
    buffer_load_dwordx4 v31, s[4:7], s41 offen offset:3072 sc1 lds
    s_mov_b32 s41, 23
    s_add_u32 m0, s38, 98304
    s_lshl_b32 s41, s41, s32
    s_add_u32 s41, s41, s44
    buffer_load_dwordx4 v11, s[52:55], s41 offen offset:0 sc1 lds
    buffer_load_dwordx4 v12, s[52:55], s41 offen offset:1024 sc1 lds
    buffer_load_dwordx4 v13, s[52:55], s41 offen offset:2048 sc1 lds
    buffer_load_dwordx4 v14, s[52:55], s41 offen offset:3072 sc1 lds
    s_waitcnt vmcnt(16)
    s_barrier
    s_mov_b32 s41, 24
    s_add_u32 m0, s46, 0
    s_lshl_b32 s41, s41, 15
    s_add_u32 s41, s41, s43
    buffer_load_dwordx4 v28, s[4:7], s41 offen offset:0 sc1 lds
    buffer_load_dwordx4 v29, s[4:7], s41 offen offset:1024 sc1 lds
    buffer_load_dwordx4 v30, s[4:7], s41 offen offset:2048 sc1 lds
    buffer_load_dwordx4 v31, s[4:7], s41 offen offset:3072 sc1 lds
    s_mov_b32 s41, 24
    s_add_u32 m0, s38, 0
    s_lshl_b32 s41, s41, s32
    s_add_u32 s41, s41, s44
    buffer_load_dwordx4 v11, s[52:55], s41 offen offset:0 sc1 lds
    buffer_load_dwordx4 v12, s[52:55], s41 offen offset:1024 sc1 lds
    buffer_load_dwordx4 v13, s[52:55], s41 offen offset:2048 sc1 lds
    buffer_load_dwordx4 v14, s[52:55], s41 offen offset:3072 sc1 lds
    s_waitcnt vmcnt(16)
    s_barrier
    s_lshl_b32 s3, s21, 11
    s_add_u32 s46, s46, s3
    s_lshl_b32 s3, s3, 1
    s_add_u32 s43, s33, s3
    s_add_u32 s43, s43, 819200
    s_lshl_b32 s44, 25, s32
    s_add_u32 s44, s44, s35
    s_mov_b32 s41, 0
    s_add_u32 m0, s46, 32768
    s_lshl_b32 s41, s41, 15
    s_add_u32 s41, s41, s43
    buffer_load_dwordx4 v28, s[4:7], s41 offen offset:0 sc1 lds
    buffer_load_dwordx4 v29, s[4:7], s41 offen offset:1024 sc1 lds
    s_mov_b32 s41, 0
    s_add_u32 m0, s38, 32768
    s_lshl_b32 s41, s41, s32
    s_add_u32 s41, s41, s44
    buffer_load_dwordx4 v11, s[52:55], s41 offen offset:0 sc1 lds
    buffer_load_dwordx4 v12, s[52:55], s41 offen offset:1024 sc1 lds
    buffer_load_dwordx4 v13, s[52:55], s41 offen offset:2048 sc1 lds
    buffer_load_dwordx4 v14, s[52:55], s41 offen offset:3072 sc1 lds
    s_waitcnt vmcnt(14)
    s_barrier
    s_mov_b32 s41, 1
    s_add_u32 m0, s46, 65536
    s_lshl_b32 s41, s41, 15
    s_add_u32 s41, s41, s43
    buffer_load_dwordx4 v28, s[4:7], s41 offen offset:0 sc1 lds
    buffer_load_dwordx4 v29, s[4:7], s41 offen offset:1024 sc1 lds
    s_mov_b32 s41, 1
    s_add_u32 m0, s38, 65536
    s_lshl_b32 s41, s41, s32
    s_add_u32 s41, s41, s44
    buffer_load_dwordx4 v11, s[52:55], s41 offen offset:0 sc1 lds
    buffer_load_dwordx4 v12, s[52:55], s41 offen offset:1024 sc1 lds
    buffer_load_dwordx4 v13, s[52:55], s41 offen offset:2048 sc1 lds
    buffer_load_dwordx4 v14, s[52:55], s41 offen offset:3072 sc1 lds
    s_waitcnt vmcnt(12)
    s_barrier
    s_mov_b32 s41, 2
    s_add_u32 m0, s46, 98304
    s_lshl_b32 s41, s41, 15
    s_add_u32 s41, s41, s43
    buffer_load_dwordx4 v28, s[4:7], s41 offen offset:0 sc1 lds
    buffer_load_dwordx4 v29, s[4:7], s41 offen offset:1024 sc1 lds
    s_mov_b32 s41, 2
    s_add_u32 m0, s38, 98304
    s_lshl_b32 s41, s41, s32
    s_add_u32 s41, s41, s44
    buffer_load_dwordx4 v11, s[52:55], s41 offen offset:0 sc1 lds
    buffer_load_dwordx4 v12, s[52:55], s41 offen offset:1024 sc1 lds
    buffer_load_dwordx4 v13, s[52:55], s41 offen offset:2048 sc1 lds
    buffer_load_dwordx4 v14, s[52:55], s41 offen offset:3072 sc1 lds
    s_waitcnt vmcnt(12)
    s_barrier
    s_mov_b32 s41, 3
    s_add_u32 m0, s46, 0
    s_lshl_b32 s41, s41, 15
    s_add_u32 s41, s41, s43
    buffer_load_dwordx4 v28, s[4:7], s41 offen offset:0 sc1 lds
    buffer_load_dwordx4 v29, s[4:7], s41 offen offset:1024 sc1 lds
    s_mov_b32 s41, 3
    s_add_u32 m0, s38, 0
    s_lshl_b32 s41, s41, s32
    s_add_u32 s41, s41, s44
    buffer_load_dwordx4 v11, s[52:55], s41 offen offset:0 sc1 lds
    buffer_load_dwordx4 v12, s[52:55], s41 offen offset:1024 sc1 lds
    buffer_load_dwordx4 v13, s[52:55], s41 offen offset:2048 sc1 lds
    buffer_load_dwordx4 v14, s[52:55], s41 offen offset:3072 sc1 lds
    s_waitcnt vmcnt(12)
    s_barrier
    s_mov_b32 s41, 4
    s_add_u32 m0, s46, 32768
    s_lshl_b32 s41, s41, 15
    s_add_u32 s41, s41, s43
    buffer_load_dwordx4 v28, s[4:7], s41 offen offset:0 sc1 lds
    buffer_load_dwordx4 v29, s[4:7], s41 offen offset:1024 sc1 lds
    s_mov_b32 s41, 4
    s_add_u32 m0, s38, 32768
    s_lshl_b32 s41, s41, s32
    s_add_u32 s41, s41, s44
    buffer_load_dwordx4 v11, s[52:55], s41 offen offset:0 sc1 lds
    buffer_load_dwordx4 v12, s[52:55], s41 offen offset:1024 sc1 lds
    buffer_load_dwordx4 v13, s[52:55], s41 offen offset:2048 sc1 lds
    buffer_load_dwordx4 v14, s[52:55], s41 offen offset:3072 sc1 lds
    s_waitcnt vmcnt(12)
    s_barrier
    buffer_load_dword v20, off, s[4:7], s48 sc1
    s_mov_b32 s41, 5
    s_add_u32 m0, s46, 65536
    s_lshl_b32 s41, s41, 15
    s_add_u32 s41, s41, s43
    buffer_load_dwordx4 v28, s[4:7], s41 offen offset:0 sc1 lds
    buffer_load_dwordx4 v29, s[4:7], s41 offen offset:1024 sc1 lds
    s_mov_b32 s41, 5
    s_add_u32 m0, s38, 65536
    s_lshl_b32 s41, s41, s32
    s_add_u32 s41, s41, s44
    buffer_load_dwordx4 v11, s[52:55], s41 offen offset:0 sc1 lds
    buffer_load_dwordx4 v12, s[52:55], s41 offen offset:1024 sc1 lds
    buffer_load_dwordx4 v13, s[52:55], s41 offen offset:2048 sc1 lds
    buffer_load_dwordx4 v14, s[52:55], s41 offen offset:3072 sc1 lds
    s_waitcnt vmcnt(13)
    s_barrier
    s_waitcnt vmcnt(6)
    v_cmp_ne_u32 vcc, s12, v20
    s_cbranch_vccnz L_exlate_56
    s_add_u32 m0, s45, 131072
    s_nop 0
    buffer_load_dwordx4 v8, s[4:7], s47 offen offset:0 sc1 lds
    buffer_load_dwordx4 v8, s[4:7], s47 offen offset:1024 sc1 lds
    buffer_load_dwordx4 v8, s[4:7], s47 offen offset:2048 sc1 lds
    buffer_load_dwordx4 v8, s[4:7], s47 offen offset:3072 sc1 lds
    s_barrier
    s_waitcnt vmcnt(4)
    s_barrier
    s_branch L_exdone_55
L_exlate_56:
    buffer_load_dword v20, off, s[4:7], s48 sc1
    s_barrier
    s_waitcnt vmcnt(1)
    s_barrier
    s_waitcnt vmcnt(0)
    s_mov_b32 s62, 0x8000
L_exsp_58:
    v_cmp_ne_u32 vcc, s12, v20
    s_cbranch_vccz L_exok_57
    s_sub_u32 s62, s62, 1
    s_cmp_eq_u32 s62, 0
    s_cbranch_scc1 L_exok_57
    s_sleep 2
    buffer_load_dword v20, off, s[4:7], s48 sc1
    s_waitcnt vmcnt(0)
    s_branch L_exsp_58
L_exok_57:
    s_add_u32 m0, s45, 131072
    s_nop 0
    buffer_load_dwordx4 v8, s[4:7], s47 offen offset:0 sc1 lds
    buffer_load_dwordx4 v8, s[4:7], s47 offen offset:1024 sc1 lds
    buffer_load_dwordx4 v8, s[4:7], s47 offen offset:2048 sc1 lds
    buffer_load_dwordx4 v8, s[4:7], s47 offen offset:3072 sc1 lds
L_exdone_55:
    s_waitcnt vmcnt(0)
    s_barrier
L_end_1:
    s_endpgm
H_end:
L_comp_2:
    s_lshl_b32 s41, s15, 2
    s_add_u32 s41, s41, s18
    s_getpc_b64 s[90:91]
L_pc_59:
    s_sub_u32 s90, s90, L_pc_59-H_begin
    s_subb_u32 s91, s91, 0
    v_min_u32 v60, 3, v2
    s_mul_i32 s3, s41, 4
    v_add_u32 v60, s3, v60
    v_lshlrev_b32 v60, 7, v60
    v_min_u32 v60, C_slow-H_begin-4, v60
    v_mov_b32 v61, s91
    v_add_co_u32 v60, vcc, s90, v60
    s_nop 1
    v_addc_co_u32 v61, vcc, 0, v61, vcc
    global_load_dword v23, v[60:61], off
    s_lshr_b32 s19, s18, 1
    s_and_b32 s20, s18, 1
    v_and_b32 v3, 15, v2
    v_lshrrev_b32 v4, 4, v2
    s_lshl_b32 s3, s19, 6
    v_add_u32 v5, s3, v3
    v_lshlrev_b32 v5, 7, v5
    v_lshrrev_b32 v6, 1, v3
    v_xor_b32 v6, v6, v4
    v_lshlrev_b32 v7, 4, v6
    v_add_u32 v14, v5, v7
    v_xor_b32 v15, 64, v14
    v_lshrrev_b32 v5, 2, v3
    v_and_b32 v6, 3, v3
    v_lshl_add_u32 v7, v4, 3, v5
    v_lshlrev_b32 v7, 7, v7
    v_lshl_add_u32 v7, v6, 3, v7
    v_lshrrev_b32 v8, 1, v5
    v_and_b32 v9, 1, v4
    v_lshl_or_b32 v8, v9, 1, v8
    s_lshl_b32 s3, s20, 1
    v_xor_b32 v8, s3, v8
    v_lshl_add_u32 v16, v8, 5, v7
    v_xor_b32 v17, 32, v16
    v_mov_b32 v10, v14
    v_mov_b32 v11, v15
    v_mov_b32 v12, v16
    v_mov_b32 v13, v17
    s_mov_b32 s21, 0
    s_memrealtime s[28:29]
    s_waitcnt lgkmcnt(0)
    s_or_b32 s3, s2, s18
    s_cmp_lg_u32 s3, 0
    s_cbranch_scc1 L_nononce_60
    s_mov_b32 s24, s84
    s_and_b32 s25, s85, 0xffff
    s_mov_b32 s26, 4
    s_mov_b32 s27, 0x20000
    s_or_b32 s28, s28, 1
    v_mov_b32 v5, s28
    v_lshlrev_b32 v6, 2, v2
    buffer_store_dword v5, v6, s[24:27], 0 offen sc1
L_nononce_60:
    s_mov_b32 s4, s86
    s_and_b32 s5, s87, 0xffff
    s_mov_b32 s6, 88080384
    s_mov_b32 s7, 0x20000
    v_mov_b64 v[128:129], 0
    v_mov_b64 v[130:131], 0
    v_mov_b64 v[132:133], 0
    v_mov_b64 v[134:135], 0
    v_mov_b64 v[136:137], 0
    v_mov_b64 v[138:139], 0
    v_mov_b64 v[140:141], 0
    v_mov_b64 v[142:143], 0
    v_mov_b64 v[144:145], 0
    v_mov_b64 v[146:147], 0
    v_mov_b64 v[148:149], 0
    v_mov_b64 v[150:151], 0
    v_mov_b64 v[152:153], 0
    v_mov_b64 v[154:155], 0
    v_mov_b64 v[156:157], 0
    v_mov_b64 v[158:159], 0
    v_mov_b64 v[160:161], 0
    v_mov_b64 v[162:163], 0
    v_mov_b64 v[164:165], 0
    v_mov_b64 v[166:167], 0
    v_mov_b64 v[168:169], 0
    v_mov_b64 v[170:171], 0
    v_mov_b64 v[172:173], 0
    v_mov_b64 v[174:175], 0
    v_mov_b64 v[176:177], 0
    v_mov_b64 v[178:179], 0
    v_mov_b64 v[180:181], 0
    v_mov_b64 v[182:183], 0
    v_mov_b64 v[184:185], 0
    v_mov_b64 v[186:187], 0
    v_mov_b64 v[188:189], 0
    v_mov_b64 v[190:191], 0
    v_mov_b64 v[192:193], 0
    v_mov_b64 v[194:195], 0
    v_mov_b64 v[196:197], 0
    v_mov_b64 v[198:199], 0
    v_mov_b64 v[200:201], 0
    v_mov_b64 v[202:203], 0
    v_mov_b64 v[204:205], 0
    v_mov_b64 v[206:207], 0
    v_mov_b64 v[208:209], 0
    v_mov_b64 v[210:211], 0
    v_mov_b64 v[212:213], 0
    v_mov_b64 v[214:215], 0
    v_mov_b64 v[216:217], 0
    v_mov_b64 v[218:219], 0
    v_mov_b64 v[220:221], 0
    v_mov_b64 v[222:223], 0
    v_mov_b64 v[224:225], 0
    v_mov_b64 v[226:227], 0
    v_mov_b64 v[228:229], 0
    v_mov_b64 v[230:231], 0
    v_mov_b64 v[232:233], 0
    v_mov_b64 v[234:235], 0
    v_mov_b64 v[236:237], 0
    v_mov_b64 v[238:239], 0
    v_mov_b64 v[240:241], 0
    v_mov_b64 v[242:243], 0
    v_mov_b64 v[244:245], 0
    v_mov_b64 v[246:247], 0
    v_mov_b64 v[248:249], 0
    v_mov_b64 v[250:251], 0
    v_mov_b64 v[252:253], 0
    v_mov_b64 v[254:255], 0
    v_and_b32 v5, 1, v4
    v_lshrrev_b32 v6, 1, v4
    v_lshlrev_b32 v5, 6, v5
    v_lshl_add_u32 v5, v6, 9, v5
    v_lshrrev_b32 v6, 2, v3
    v_and_b32 v7, 3, v3
    v_lshl_add_u32 v6, v6, 3, v7
    v_lshl_add_u32 v21, v6, 4, v5
    v_lshlrev_b32 v5, 9, v4
    v_lshrrev_b32 v6, 3, v3
    v_and_b32 v7, 7, v3
    v_lshl_add_u32 v6, v6, 4, v7
    v_lshl_add_u32 v22, v6, 4, v5
    s_lshl_b32 s3, s20, 14
    s_lshl_b32 s22, s19, 13
    s_add_u32 s3, s3, s22
    v_add_u32 v21, s3, v21
    v_add_u32 v22, s3, v22
    s_lshl_b32 s3, s19, 10
    v_lshl_add_u32 v18, v3, 4, s3
    v_add_u32 v18, 155648, v18
    s_lshl_b32 s3, s20, 7
    v_lshl_add_u32 v19, v4, 4, s3
    v_add_u32 v19, 157696, v19
    v_mov_b32 v20, 159232
    s_mov_b32 s38, 0x3e8293ee
    s_lshl_b32 s22, s13, 1
    s_add_u32 s22, s22, s20
    s_lshr_b32 s3, s22, 3
    s_lshr_b32 s32, s3, 1
    s_add_u32 s32, s32, 1
    s_sub_u32 s33, 0, s32
    s_and_b32 s3, s3, 1
    s_cmp_eq_u32 s3, 1
    s_cselect_b32 s32, s33, s32
    s_lshl_b32 s33, s16, 7
    s_lshl_b32 s3, s19, 6
    s_add_u32 s33, s33, s3
    s_add_u32 s33, s33, s32
    s_lshl_b32 s34, s22, 13
    s_add_u32 s34, s34, 12582912
    v_add_u32 v50, s33, v3
    v_and_b32 v49, 15, v50
    v_lshlrev_b32 v49, 4, v49
    v_lshl_add_u32 v49, v4, 8, v49
    v_cmp_gt_u32 vcc, 2048, v50
    s_mov_b64 s[42:43], vcc
    v_bfe_u32 v51, v50, 7, 4
    v_bfe_u32 v48, v50, 4, 3
    v_lshl_add_u32 v51, v51, 18, v49
    v_lshl_add_u32 v56, v48, 10, v51
    v_add_u32 v50, 16, v50
    v_bfe_u32 v51, v50, 7, 4
    v_bfe_u32 v48, v50, 4, 3
    v_lshl_add_u32 v51, v51, 18, v49
    v_lshl_add_u32 v57, v48, 10, v51
    v_add_u32 v50, 16, v50
    v_bfe_u32 v51, v50, 7, 4
    v_bfe_u32 v48, v50, 4, 3
    v_lshl_add_u32 v51, v51, 18, v49
    v_lshl_add_u32 v58, v48, 10, v51
    v_add_u32 v50, 16, v50
    v_bfe_u32 v51, v50, 7, 4
    v_bfe_u32 v48, v50, 4, 3
    v_lshl_add_u32 v51, v51, 18, v49
    v_lshl_add_u32 v59, v48, 10, v51
    s_and_b32 s3, s32, 15
    v_add_u32 v48, s3, v3
    v_cmp_le_u32 s[50:51], 16, v48
    v_mov_b32 v48, v59
    s_nop 0
    v_cndmask_b32 v59, v59, v58, s[50:51]
    v_cndmask_b32 v58, v58, v57, s[50:51]
    v_cndmask_b32 v57, v57, v56, s[50:51]
    v_cndmask_b32 v56, v56, v48, s[50:51]
    v_cmp_gt_u32 vcc, 2048, v50
    s_mov_b64 s[44:45], vcc
    s_lshl_b32 s23, s16, 8
    s_lshl_b32 s3, s17, 4
    s_add_u32 s23, s23, s3
    s_lshl_b32 s3, s18, 2
    s_add_u32 s23, s23, s3
    s_lshl_b32 s3, s17, 4
    s_add_u32 s3, s3, s16
    s_lshl_b32 s46, s3, 15
    s_add_u32 s46, s46, 4194304
    s_add_u32 s47, s46, 4096
    s_lshl_b32 s48, s3, 10
    s_lshl_b32 s3, s20, 8
    s_add_u32 s48, s48, s3
    s_lshl_b32 s3, s19, 7
    s_add_u32 s48, s48, s3
    s_add_u32 s48, s48, 46137344
    s_mov_b32 s49, 1
    v_add_u32 v24, 0, v14
    v_add_u32 v25, 0, v15
    v_add_u32 v26, 0, v16
    v_add_u32 v27, 0, v17
    v_add_u32 v28, 49152, v14
    v_add_u32 v29, 49152, v15
    v_add_u32 v30, 49152, v16
    v_add_u32 v31, 49152, v17
    v_add_u32 v32, 98304, v14
    v_add_u32 v33, 98304, v15
    v_add_u32 v34, 98304, v16
    v_add_u32 v35, 98304, v17
    s_barrier
    ds_read_b64_tr_b16 v[96:97], v26 offset:16384
    ds_read_b64_tr_b16 v[98:99], v26 offset:16896
    ds_read_b128 v[64:67], v24 offset:0
    ds_read_b128 v[68:71], v24 offset:2048
    ds_read_b128 v[72:75], v24 offset:4096
    ds_read_b128 v[76:79], v24 offset:6144
    ds_read_b64_tr_b16 v[100:101], v27 offset:16384
    ds_read_b64_tr_b16 v[102:103], v27 offset:16896
    ds_read_b64_tr_b16 v[104:105], v26 offset:24576
    ds_read_b64_tr_b16 v[106:107], v26 offset:25088
    ds_read_b64_tr_b16 v[108:109], v27 offset:24576
    ds_read_b64_tr_b16 v[110:111], v27 offset:25088
    ds_read_b64_tr_b16 v[112:113], v26 offset:32768
    ds_read_b64_tr_b16 v[114:115], v26 offset:33280
    ds_read_b64_tr_b16 v[116:117], v27 offset:32768
    ds_read_b64_tr_b16 v[118:119], v27 offset:33280
    ds_read_b64_tr_b16 v[120:121], v26 offset:40960
    ds_read_b64_tr_b16 v[122:123], v26 offset:41472
    ds_read_b64_tr_b16 v[124:125], v27 offset:40960
    s_mov_b32 s40, 5
L_p1cloop_61:
    s_waitcnt lgkmcnt(5)
    v_mfma_f32_16x16x32_bf16 v[128:131], v[96:99], v[64:67], v[128:131]
    ds_read_b64_tr_b16 v[126:127], v27 offset:41472
    v_mfma_f32_16x16x32_bf16 v[160:163], v[96:99], v[68:71], v[160:163]
    ds_read_b128 v[80:83], v25 offset:0
    v_mfma_f32_16x16x32_bf16 v[192:195], v[96:99], v[72:75], v[192:195]
    ds_read_b128 v[84:87], v25 offset:2048
    v_mfma_f32_16x16x32_bf16 v[224:227], v[96:99], v[76:79], v[224:227]
    ds_read_b64_tr_b16 v[96:97], v26 offset:20480
    v_mfma_f32_16x16x32_bf16 v[228:231], v[100:103], v[76:79], v[228:231]
    ds_read_b64_tr_b16 v[98:99], v26 offset:20992
    v_mfma_f32_16x16x32_bf16 v[196:199], v[100:103], v[72:75], v[196:199]
    ds_read_b128 v[88:91], v25 offset:4096
    v_mfma_f32_16x16x32_bf16 v[164:167], v[100:103], v[68:71], v[164:167]
    ds_read_b128 v[92:95], v25 offset:6144
    v_mfma_f32_16x16x32_bf16 v[132:135], v[100:103], v[64:67], v[132:135]
    ds_read_b64_tr_b16 v[100:101], v27 offset:20480
    v_mfma_f32_16x16x32_bf16 v[136:139], v[104:107], v[64:67], v[136:139]
    ds_read_b64_tr_b16 v[102:103], v27 offset:20992
    v_mfma_f32_16x16x32_bf16 v[168:171], v[104:107], v[68:71], v[168:171]
    v_mfma_f32_16x16x32_bf16 v[200:203], v[104:107], v[72:75], v[200:203]
    v_mfma_f32_16x16x32_bf16 v[232:235], v[104:107], v[76:79], v[232:235]
    ds_read_b64_tr_b16 v[104:105], v26 offset:28672
    v_mfma_f32_16x16x32_bf16 v[236:239], v[108:111], v[76:79], v[236:239]
    ds_read_b64_tr_b16 v[106:107], v26 offset:29184
    v_mfma_f32_16x16x32_bf16 v[204:207], v[108:111], v[72:75], v[204:207]
    v_mfma_f32_16x16x32_bf16 v[172:175], v[108:111], v[68:71], v[172:175]
    v_mfma_f32_16x16x32_bf16 v[140:143], v[108:111], v[64:67], v[140:143]
    ds_read_b64_tr_b16 v[108:109], v27 offset:28672
    v_mfma_f32_16x16x32_bf16 v[144:147], v[64:67], v[112:115], v[144:147]
    ds_read_b64_tr_b16 v[110:111], v27 offset:29184
    v_mfma_f32_16x16x32_bf16 v[176:179], v[68:71], v[112:115], v[176:179]
    v_mfma_f32_16x16x32_bf16 v[208:211], v[72:75], v[112:115], v[208:211]
    v_mfma_f32_16x16x32_bf16 v[240:243], v[76:79], v[112:115], v[240:243]
    ds_read_b64_tr_b16 v[112:113], v26 offset:36864
    s_waitcnt lgkmcnt(5)
    v_mfma_f32_16x16x32_bf16 v[244:247], v[76:79], v[116:119], v[244:247]
    ds_read_b64_tr_b16 v[114:115], v26 offset:37376
    v_mfma_f32_16x16x32_bf16 v[212:215], v[72:75], v[116:119], v[212:215]
    v_mfma_f32_16x16x32_bf16 v[180:183], v[68:71], v[116:119], v[180:183]
    v_mfma_f32_16x16x32_bf16 v[148:151], v[64:67], v[116:119], v[148:151]
    ds_read_b64_tr_b16 v[116:117], v27 offset:36864
    v_mfma_f32_16x16x32_bf16 v[152:155], v[120:123], v[64:67], v[152:155]
    ds_read_b64_tr_b16 v[118:119], v27 offset:37376
    v_mfma_f32_16x16x32_bf16 v[184:187], v[120:123], v[68:71], v[184:187]
    v_mfma_f32_16x16x32_bf16 v[216:219], v[120:123], v[72:75], v[216:219]
    v_mfma_f32_16x16x32_bf16 v[248:251], v[120:123], v[76:79], v[248:251]
    ds_read_b64_tr_b16 v[120:121], v26 offset:45056
    v_mfma_f32_16x16x32_bf16 v[252:255], v[124:127], v[76:79], v[252:255]
    ds_read_b64_tr_b16 v[122:123], v26 offset:45568
    v_mfma_f32_16x16x32_bf16 v[220:223], v[124:127], v[72:75], v[220:223]
    v_mfma_f32_16x16x32_bf16 v[188:191], v[124:127], v[68:71], v[188:191]
    v_mfma_f32_16x16x32_bf16 v[156:159], v[124:127], v[64:67], v[156:159]
    ds_read_b64_tr_b16 v[124:125], v27 offset:45056
    v_mfma_f32_16x16x32_bf16 v[128:131], v[96:99], v[80:83], v[128:131]
    ds_read_b64_tr_b16 v[126:127], v27 offset:45568
    v_mfma_f32_16x16x32_bf16 v[160:163], v[96:99], v[84:87], v[160:163]
    v_mfma_f32_16x16x32_bf16 v[192:195], v[96:99], v[88:91], v[192:195]
    v_mfma_f32_16x16x32_bf16 v[224:227], v[96:99], v[92:95], v[224:227]
    v_mfma_f32_16x16x32_bf16 v[228:231], v[100:103], v[92:95], v[228:231]
    v_mfma_f32_16x16x32_bf16 v[196:199], v[100:103], v[88:91], v[196:199]
    v_mfma_f32_16x16x32_bf16 v[164:167], v[100:103], v[84:87], v[164:167]
    v_mfma_f32_16x16x32_bf16 v[132:135], v[100:103], v[80:83], v[132:135]
    s_waitcnt lgkmcnt(0)
    v_mfma_f32_16x16x32_bf16 v[136:139], v[104:107], v[80:83], v[136:139]
    s_barrier
    v_mfma_f32_16x16x32_bf16 v[168:171], v[104:107], v[84:87], v[168:171]
    ds_read_b64_tr_b16 v[96:97], v30 offset:16384
    v_mfma_f32_16x16x32_bf16 v[200:203], v[104:107], v[88:91], v[200:203]
    ds_read_b64_tr_b16 v[98:99], v30 offset:16896
    v_mfma_f32_16x16x32_bf16 v[232:235], v[104:107], v[92:95], v[232:235]
    ds_read_b128 v[64:67], v28 offset:0
    v_mfma_f32_16x16x32_bf16 v[236:239], v[108:111], v[92:95], v[236:239]
    ds_read_b128 v[68:71], v28 offset:2048
    v_mfma_f32_16x16x32_bf16 v[204:207], v[108:111], v[88:91], v[204:207]
    ds_read_b128 v[72:75], v28 offset:4096
    v_mfma_f32_16x16x32_bf16 v[172:175], v[108:111], v[84:87], v[172:175]
    ds_read_b128 v[76:79], v28 offset:6144
    v_mfma_f32_16x16x32_bf16 v[140:143], v[108:111], v[80:83], v[140:143]
    ds_read_b64_tr_b16 v[100:101], v31 offset:16384
    v_mfma_f32_16x16x32_bf16 v[144:147], v[80:83], v[112:115], v[144:147]
    ds_read_b64_tr_b16 v[102:103], v31 offset:16896
    v_mfma_f32_16x16x32_bf16 v[176:179], v[84:87], v[112:115], v[176:179]
    ds_read_b64_tr_b16 v[104:105], v30 offset:24576
    v_mfma_f32_16x16x32_bf16 v[208:211], v[88:91], v[112:115], v[208:211]
    ds_read_b64_tr_b16 v[106:107], v30 offset:25088
    v_mfma_f32_16x16x32_bf16 v[240:243], v[92:95], v[112:115], v[240:243]
    ds_read_b64_tr_b16 v[108:109], v31 offset:24576
    v_mfma_f32_16x16x32_bf16 v[244:247], v[92:95], v[116:119], v[244:247]
    ds_read_b64_tr_b16 v[110:111], v31 offset:25088
    v_mfma_f32_16x16x32_bf16 v[212:215], v[88:91], v[116:119], v[212:215]
    ds_read_b64_tr_b16 v[112:113], v30 offset:32768
    v_mfma_f32_16x16x32_bf16 v[180:183], v[84:87], v[116:119], v[180:183]
    ds_read_b64_tr_b16 v[114:115], v30 offset:33280
    v_mfma_f32_16x16x32_bf16 v[148:151], v[80:83], v[116:119], v[148:151]
    ds_read_b64_tr_b16 v[116:117], v31 offset:32768
    v_mfma_f32_16x16x32_bf16 v[152:155], v[120:123], v[80:83], v[152:155]
    ds_read_b64_tr_b16 v[118:119], v31 offset:33280
    v_mfma_f32_16x16x32_bf16 v[184:187], v[120:123], v[84:87], v[184:187]
    v_mfma_f32_16x16x32_bf16 v[216:219], v[120:123], v[88:91], v[216:219]
    v_mfma_f32_16x16x32_bf16 v[248:251], v[120:123], v[92:95], v[248:251]
    ds_read_b64_tr_b16 v[120:121], v30 offset:40960
    v_mfma_f32_16x16x32_bf16 v[252:255], v[124:127], v[92:95], v[252:255]
    ds_read_b64_tr_b16 v[122:123], v30 offset:41472
    v_mfma_f32_16x16x32_bf16 v[220:223], v[124:127], v[88:91], v[220:223]
    v_mfma_f32_16x16x32_bf16 v[188:191], v[124:127], v[84:87], v[188:191]
    v_mfma_f32_16x16x32_bf16 v[156:159], v[124:127], v[80:83], v[156:159]
    ds_read_b64_tr_b16 v[124:125], v31 offset:40960
    s_waitcnt lgkmcnt(5)
    v_mfma_f32_16x16x32_bf16 v[128:131], v[96:99], v[64:67], v[128:131]
    ds_read_b64_tr_b16 v[126:127], v31 offset:41472
    v_mfma_f32_16x16x32_bf16 v[160:163], v[96:99], v[68:71], v[160:163]
    ds_read_b128 v[80:83], v29 offset:0
    v_mfma_f32_16x16x32_bf16 v[192:195], v[96:99], v[72:75], v[192:195]
    ds_read_b128 v[84:87], v29 offset:2048
    v_mfma_f32_16x16x32_bf16 v[224:227], v[96:99], v[76:79], v[224:227]
    ds_read_b64_tr_b16 v[96:97], v30 offset:20480
    v_mfma_f32_16x16x32_bf16 v[228:231], v[100:103], v[76:79], v[228:231]
    ds_read_b64_tr_b16 v[98:99], v30 offset:20992
    v_mfma_f32_16x16x32_bf16 v[196:199], v[100:103], v[72:75], v[196:199]
    ds_read_b128 v[88:91], v29 offset:4096
    v_mfma_f32_16x16x32_bf16 v[164:167], v[100:103], v[68:71], v[164:167]
    ds_read_b128 v[92:95], v29 offset:6144
    v_mfma_f32_16x16x32_bf16 v[132:135], v[100:103], v[64:67], v[132:135]
    ds_read_b64_tr_b16 v[100:101], v31 offset:20480
    v_mfma_f32_16x16x32_bf16 v[136:139], v[104:107], v[64:67], v[136:139]
    ds_read_b64_tr_b16 v[102:103], v31 offset:20992
    v_mfma_f32_16x16x32_bf16 v[168:171], v[104:107], v[68:71], v[168:171]
    v_mfma_f32_16x16x32_bf16 v[200:203], v[104:107], v[72:75], v[200:203]
    v_mfma_f32_16x16x32_bf16 v[232:235], v[104:107], v[76:79], v[232:235]
    ds_read_b64_tr_b16 v[104:105], v30 offset:28672
    v_mfma_f32_16x16x32_bf16 v[236:239], v[108:111], v[76:79], v[236:239]
    ds_read_b64_tr_b16 v[106:107], v30 offset:29184
    v_mfma_f32_16x16x32_bf16 v[204:207], v[108:111], v[72:75], v[204:207]
    v_mfma_f32_16x16x32_bf16 v[172:175], v[108:111], v[68:71], v[172:175]
    v_mfma_f32_16x16x32_bf16 v[140:143], v[108:111], v[64:67], v[140:143]
    ds_read_b64_tr_b16 v[108:109], v31 offset:28672
    v_mfma_f32_16x16x32_bf16 v[144:147], v[64:67], v[112:115], v[144:147]
    ds_read_b64_tr_b16 v[110:111], v31 offset:29184
    v_mfma_f32_16x16x32_bf16 v[176:179], v[68:71], v[112:115], v[176:179]
    v_mfma_f32_16x16x32_bf16 v[208:211], v[72:75], v[112:115], v[208:211]
    v_mfma_f32_16x16x32_bf16 v[240:243], v[76:79], v[112:115], v[240:243]
    ds_read_b64_tr_b16 v[112:113], v30 offset:36864
    s_waitcnt lgkmcnt(5)
    v_mfma_f32_16x16x32_bf16 v[244:247], v[76:79], v[116:119], v[244:247]
    ds_read_b64_tr_b16 v[114:115], v30 offset:37376
    v_mfma_f32_16x16x32_bf16 v[212:215], v[72:75], v[116:119], v[212:215]
    v_mfma_f32_16x16x32_bf16 v[180:183], v[68:71], v[116:119], v[180:183]
    v_mfma_f32_16x16x32_bf16 v[148:151], v[64:67], v[116:119], v[148:151]
    ds_read_b64_tr_b16 v[116:117], v31 offset:36864
    v_mfma_f32_16x16x32_bf16 v[152:155], v[120:123], v[64:67], v[152:155]
    ds_read_b64_tr_b16 v[118:119], v31 offset:37376
    v_mfma_f32_16x16x32_bf16 v[184:187], v[120:123], v[68:71], v[184:187]
    v_mfma_f32_16x16x32_bf16 v[216:219], v[120:123], v[72:75], v[216:219]
    v_mfma_f32_16x16x32_bf16 v[248:251], v[120:123], v[76:79], v[248:251]
    ds_read_b64_tr_b16 v[120:121], v30 offset:45056
    v_mfma_f32_16x16x32_bf16 v[252:255], v[124:127], v[76:79], v[252:255]
    ds_read_b64_tr_b16 v[122:123], v30 offset:45568
    v_mfma_f32_16x16x32_bf16 v[220:223], v[124:127], v[72:75], v[220:223]
    v_mfma_f32_16x16x32_bf16 v[188:191], v[124:127], v[68:71], v[188:191]
    v_mfma_f32_16x16x32_bf16 v[156:159], v[124:127], v[64:67], v[156:159]
    ds_read_b64_tr_b16 v[124:125], v31 offset:45056
    v_mfma_f32_16x16x32_bf16 v[128:131], v[96:99], v[80:83], v[128:131]
    ds_read_b64_tr_b16 v[126:127], v31 offset:45568
    v_mfma_f32_16x16x32_bf16 v[160:163], v[96:99], v[84:87], v[160:163]
    v_mfma_f32_16x16x32_bf16 v[192:195], v[96:99], v[88:91], v[192:195]
    v_mfma_f32_16x16x32_bf16 v[224:227], v[96:99], v[92:95], v[224:227]
    v_mfma_f32_16x16x32_bf16 v[228:231], v[100:103], v[92:95], v[228:231]
    v_mfma_f32_16x16x32_bf16 v[196:199], v[100:103], v[88:91], v[196:199]
    v_mfma_f32_16x16x32_bf16 v[164:167], v[100:103], v[84:87], v[164:167]
    v_mfma_f32_16x16x32_bf16 v[132:135], v[100:103], v[80:83], v[132:135]
    s_waitcnt lgkmcnt(0)
    v_mfma_f32_16x16x32_bf16 v[136:139], v[104:107], v[80:83], v[136:139]
    s_barrier
    v_mfma_f32_16x16x32_bf16 v[168:171], v[104:107], v[84:87], v[168:171]
    ds_read_b64_tr_b16 v[96:97], v34 offset:16384
    v_mfma_f32_16x16x32_bf16 v[200:203], v[104:107], v[88:91], v[200:203]
    ds_read_b64_tr_b16 v[98:99], v34 offset:16896
    v_mfma_f32_16x16x32_bf16 v[232:235], v[104:107], v[92:95], v[232:235]
    ds_read_b128 v[64:67], v32 offset:0
    v_mfma_f32_16x16x32_bf16 v[236:239], v[108:111], v[92:95], v[236:239]
    ds_read_b128 v[68:71], v32 offset:2048
    v_mfma_f32_16x16x32_bf16 v[204:207], v[108:111], v[88:91], v[204:207]
    ds_read_b128 v[72:75], v32 offset:4096
    v_mfma_f32_16x16x32_bf16 v[172:175], v[108:111], v[84:87], v[172:175]
    ds_read_b128 v[76:79], v32 offset:6144
    v_mfma_f32_16x16x32_bf16 v[140:143], v[108:111], v[80:83], v[140:143]
    ds_read_b64_tr_b16 v[100:101], v35 offset:16384
    v_mfma_f32_16x16x32_bf16 v[144:147], v[80:83], v[112:115], v[144:147]
    ds_read_b64_tr_b16 v[102:103], v35 offset:16896
    v_mfma_f32_16x16x32_bf16 v[176:179], v[84:87], v[112:115], v[176:179]
    ds_read_b64_tr_b16 v[104:105], v34 offset:24576
    v_mfma_f32_16x16x32_bf16 v[208:211], v[88:91], v[112:115], v[208:211]
    ds_read_b64_tr_b16 v[106:107], v34 offset:25088
    v_mfma_f32_16x16x32_bf16 v[240:243], v[92:95], v[112:115], v[240:243]
    ds_read_b64_tr_b16 v[108:109], v35 offset:24576
    v_mfma_f32_16x16x32_bf16 v[244:247], v[92:95], v[116:119], v[244:247]
    ds_read_b64_tr_b16 v[110:111], v35 offset:25088
    v_mfma_f32_16x16x32_bf16 v[212:215], v[88:91], v[116:119], v[212:215]
    ds_read_b64_tr_b16 v[112:113], v34 offset:32768
    v_mfma_f32_16x16x32_bf16 v[180:183], v[84:87], v[116:119], v[180:183]
    ds_read_b64_tr_b16 v[114:115], v34 offset:33280
    v_mfma_f32_16x16x32_bf16 v[148:151], v[80:83], v[116:119], v[148:151]
    ds_read_b64_tr_b16 v[116:117], v35 offset:32768
    v_mfma_f32_16x16x32_bf16 v[152:155], v[120:123], v[80:83], v[152:155]
    ds_read_b64_tr_b16 v[118:119], v35 offset:33280
    v_mfma_f32_16x16x32_bf16 v[184:187], v[120:123], v[84:87], v[184:187]
    v_mfma_f32_16x16x32_bf16 v[216:219], v[120:123], v[88:91], v[216:219]
    v_mfma_f32_16x16x32_bf16 v[248:251], v[120:123], v[92:95], v[248:251]
    ds_read_b64_tr_b16 v[120:121], v34 offset:40960
    v_mfma_f32_16x16x32_bf16 v[252:255], v[124:127], v[92:95], v[252:255]
    ds_read_b64_tr_b16 v[122:123], v34 offset:41472
    v_mfma_f32_16x16x32_bf16 v[220:223], v[124:127], v[88:91], v[220:223]
    v_mfma_f32_16x16x32_bf16 v[188:191], v[124:127], v[84:87], v[188:191]
    v_mfma_f32_16x16x32_bf16 v[156:159], v[124:127], v[80:83], v[156:159]
    ds_read_b64_tr_b16 v[124:125], v35 offset:40960
    s_waitcnt lgkmcnt(5)
    v_mfma_f32_16x16x32_bf16 v[128:131], v[96:99], v[64:67], v[128:131]
    ds_read_b64_tr_b16 v[126:127], v35 offset:41472
    v_mfma_f32_16x16x32_bf16 v[160:163], v[96:99], v[68:71], v[160:163]
    ds_read_b128 v[80:83], v33 offset:0
    v_mfma_f32_16x16x32_bf16 v[192:195], v[96:99], v[72:75], v[192:195]
    ds_read_b128 v[84:87], v33 offset:2048
    v_mfma_f32_16x16x32_bf16 v[224:227], v[96:99], v[76:79], v[224:227]
    ds_read_b64_tr_b16 v[96:97], v34 offset:20480
    v_mfma_f32_16x16x32_bf16 v[228:231], v[100:103], v[76:79], v[228:231]
    ds_read_b64_tr_b16 v[98:99], v34 offset:20992
    v_mfma_f32_16x16x32_bf16 v[196:199], v[100:103], v[72:75], v[196:199]
    ds_read_b128 v[88:91], v33 offset:4096
    v_mfma_f32_16x16x32_bf16 v[164:167], v[100:103], v[68:71], v[164:167]
    ds_read_b128 v[92:95], v33 offset:6144
    v_mfma_f32_16x16x32_bf16 v[132:135], v[100:103], v[64:67], v[132:135]
    ds_read_b64_tr_b16 v[100:101], v35 offset:20480
    v_mfma_f32_16x16x32_bf16 v[136:139], v[104:107], v[64:67], v[136:139]
    ds_read_b64_tr_b16 v[102:103], v35 offset:20992
    v_mfma_f32_16x16x32_bf16 v[168:171], v[104:107], v[68:71], v[168:171]
    v_mfma_f32_16x16x32_bf16 v[200:203], v[104:107], v[72:75], v[200:203]
    v_mfma_f32_16x16x32_bf16 v[232:235], v[104:107], v[76:79], v[232:235]
    ds_read_b64_tr_b16 v[104:105], v34 offset:28672
    v_mfma_f32_16x16x32_bf16 v[236:239], v[108:111], v[76:79], v[236:239]
    ds_read_b64_tr_b16 v[106:107], v34 offset:29184
    v_mfma_f32_16x16x32_bf16 v[204:207], v[108:111], v[72:75], v[204:207]
    v_mfma_f32_16x16x32_bf16 v[172:175], v[108:111], v[68:71], v[172:175]
    v_mfma_f32_16x16x32_bf16 v[140:143], v[108:111], v[64:67], v[140:143]
    ds_read_b64_tr_b16 v[108:109], v35 offset:28672
    v_mfma_f32_16x16x32_bf16 v[144:147], v[64:67], v[112:115], v[144:147]
    ds_read_b64_tr_b16 v[110:111], v35 offset:29184
    v_mfma_f32_16x16x32_bf16 v[176:179], v[68:71], v[112:115], v[176:179]
    v_mfma_f32_16x16x32_bf16 v[208:211], v[72:75], v[112:115], v[208:211]
    v_mfma_f32_16x16x32_bf16 v[240:243], v[76:79], v[112:115], v[240:243]
    ds_read_b64_tr_b16 v[112:113], v34 offset:36864
    s_waitcnt lgkmcnt(5)
    v_mfma_f32_16x16x32_bf16 v[244:247], v[76:79], v[116:119], v[244:247]
    ds_read_b64_tr_b16 v[114:115], v34 offset:37376
    v_mfma_f32_16x16x32_bf16 v[212:215], v[72:75], v[116:119], v[212:215]
    v_mfma_f32_16x16x32_bf16 v[180:183], v[68:71], v[116:119], v[180:183]
    v_mfma_f32_16x16x32_bf16 v[148:151], v[64:67], v[116:119], v[148:151]
    ds_read_b64_tr_b16 v[116:117], v35 offset:36864
    v_mfma_f32_16x16x32_bf16 v[152:155], v[120:123], v[64:67], v[152:155]
    ds_read_b64_tr_b16 v[118:119], v35 offset:37376
    v_mfma_f32_16x16x32_bf16 v[184:187], v[120:123], v[68:71], v[184:187]
    v_mfma_f32_16x16x32_bf16 v[216:219], v[120:123], v[72:75], v[216:219]
    v_mfma_f32_16x16x32_bf16 v[248:251], v[120:123], v[76:79], v[248:251]
    ds_read_b64_tr_b16 v[120:121], v34 offset:45056
    v_mfma_f32_16x16x32_bf16 v[252:255], v[124:127], v[76:79], v[252:255]
    ds_read_b64_tr_b16 v[122:123], v34 offset:45568
    v_mfma_f32_16x16x32_bf16 v[220:223], v[124:127], v[72:75], v[220:223]
    v_mfma_f32_16x16x32_bf16 v[188:191], v[124:127], v[68:71], v[188:191]
    v_mfma_f32_16x16x32_bf16 v[156:159], v[124:127], v[64:67], v[156:159]
    ds_read_b64_tr_b16 v[124:125], v35 offset:45056
    v_mfma_f32_16x16x32_bf16 v[128:131], v[96:99], v[80:83], v[128:131]
    ds_read_b64_tr_b16 v[126:127], v35 offset:45568
    v_mfma_f32_16x16x32_bf16 v[160:163], v[96:99], v[84:87], v[160:163]
    v_mfma_f32_16x16x32_bf16 v[192:195], v[96:99], v[88:91], v[192:195]
    v_mfma_f32_16x16x32_bf16 v[224:227], v[96:99], v[92:95], v[224:227]
    v_mfma_f32_16x16x32_bf16 v[228:231], v[100:103], v[92:95], v[228:231]
    v_mfma_f32_16x16x32_bf16 v[196:199], v[100:103], v[88:91], v[196:199]
    v_mfma_f32_16x16x32_bf16 v[164:167], v[100:103], v[84:87], v[164:167]
    v_mfma_f32_16x16x32_bf16 v[132:135], v[100:103], v[80:83], v[132:135]
    s_waitcnt lgkmcnt(0)
    v_mfma_f32_16x16x32_bf16 v[136:139], v[104:107], v[80:83], v[136:139]
    s_barrier
    v_mfma_f32_16x16x32_bf16 v[168:171], v[104:107], v[84:87], v[168:171]
    ds_read_b64_tr_b16 v[96:97], v26 offset:16384
    v_mfma_f32_16x16x32_bf16 v[200:203], v[104:107], v[88:91], v[200:203]
    ds_read_b64_tr_b16 v[98:99], v26 offset:16896
    v_mfma_f32_16x16x32_bf16 v[232:235], v[104:107], v[92:95], v[232:235]
    ds_read_b128 v[64:67], v24 offset:0
    v_mfma_f32_16x16x32_bf16 v[236:239], v[108:111], v[92:95], v[236:239]
    ds_read_b128 v[68:71], v24 offset:2048
    v_mfma_f32_16x16x32_bf16 v[204:207], v[108:111], v[88:91], v[204:207]
    ds_read_b128 v[72:75], v24 offset:4096
    v_mfma_f32_16x16x32_bf16 v[172:175], v[108:111], v[84:87], v[172:175]
    ds_read_b128 v[76:79], v24 offset:6144
    v_mfma_f32_16x16x32_bf16 v[140:143], v[108:111], v[80:83], v[140:143]
    ds_read_b64_tr_b16 v[100:101], v27 offset:16384
    v_mfma_f32_16x16x32_bf16 v[144:147], v[80:83], v[112:115], v[144:147]
    ds_read_b64_tr_b16 v[102:103], v27 offset:16896
    v_mfma_f32_16x16x32_bf16 v[176:179], v[84:87], v[112:115], v[176:179]
    ds_read_b64_tr_b16 v[104:105], v26 offset:24576
    v_mfma_f32_16x16x32_bf16 v[208:211], v[88:91], v[112:115], v[208:211]
    ds_read_b64_tr_b16 v[106:107], v26 offset:25088
    v_mfma_f32_16x16x32_bf16 v[240:243], v[92:95], v[112:115], v[240:243]
    ds_read_b64_tr_b16 v[108:109], v27 offset:24576
    v_mfma_f32_16x16x32_bf16 v[244:247], v[92:95], v[116:119], v[244:247]
    ds_read_b64_tr_b16 v[110:111], v27 offset:25088
    v_mfma_f32_16x16x32_bf16 v[212:215], v[88:91], v[116:119], v[212:215]
    ds_read_b64_tr_b16 v[112:113], v26 offset:32768
    v_mfma_f32_16x16x32_bf16 v[180:183], v[84:87], v[116:119], v[180:183]
    ds_read_b64_tr_b16 v[114:115], v26 offset:33280
    v_mfma_f32_16x16x32_bf16 v[148:151], v[80:83], v[116:119], v[148:151]
    ds_read_b64_tr_b16 v[116:117], v27 offset:32768
    v_mfma_f32_16x16x32_bf16 v[152:155], v[120:123], v[80:83], v[152:155]
    ds_read_b64_tr_b16 v[118:119], v27 offset:33280
    v_mfma_f32_16x16x32_bf16 v[184:187], v[120:123], v[84:87], v[184:187]
    s_sub_u32 s40, s40, 1
    v_mfma_f32_16x16x32_bf16 v[216:219], v[120:123], v[88:91], v[216:219]
    s_cmp_lg_u32 s40, 0
    v_mfma_f32_16x16x32_bf16 v[248:251], v[120:123], v[92:95], v[248:251]
    ds_read_b64_tr_b16 v[120:121], v26 offset:40960
    v_mfma_f32_16x16x32_bf16 v[252:255], v[124:127], v[92:95], v[252:255]
    ds_read_b64_tr_b16 v[122:123], v26 offset:41472
    v_mfma_f32_16x16x32_bf16 v[220:223], v[124:127], v[88:91], v[220:223]
    v_mfma_f32_16x16x32_bf16 v[188:191], v[124:127], v[84:87], v[188:191]
    v_mfma_f32_16x16x32_bf16 v[156:159], v[124:127], v[80:83], v[156:159]
    ds_read_b64_tr_b16 v[124:125], v27 offset:40960
    s_cbranch_scc1 L_p1cloop_61
    s_waitcnt lgkmcnt(5)
    v_mfma_f32_16x16x32_bf16 v[128:131], v[96:99], v[64:67], v[128:131]
    ds_read_b64_tr_b16 v[126:127], v27 offset:41472
    v_mfma_f32_16x16x32_bf16 v[160:163], v[96:99], v[68:71], v[160:163]
    ds_read_b128 v[80:83], v25 offset:0
    v_mfma_f32_16x16x32_bf16 v[192:195], v[96:99], v[72:75], v[192:195]
    ds_read_b128 v[84:87], v25 offset:2048
    v_mfma_f32_16x16x32_bf16 v[224:227], v[96:99], v[76:79], v[224:227]
    ds_read_b64_tr_b16 v[96:97], v26 offset:20480
    v_mfma_f32_16x16x32_bf16 v[228:231], v[100:103], v[76:79], v[228:231]
    ds_read_b64_tr_b16 v[98:99], v26 offset:20992
    v_mfma_f32_16x16x32_bf16 v[196:199], v[100:103], v[72:75], v[196:199]
    ds_read_b128 v[88:91], v25 offset:4096
    v_mfma_f32_16x16x32_bf16 v[164:167], v[100:103], v[68:71], v[164:167]
    ds_read_b128 v[92:95], v25 offset:6144
    v_mfma_f32_16x16x32_bf16 v[132:135], v[100:103], v[64:67], v[132:135]
    ds_read_b64_tr_b16 v[100:101], v27 offset:20480
    v_mfma_f32_16x16x32_bf16 v[136:139], v[104:107], v[64:67], v[136:139]
    ds_read_b64_tr_b16 v[102:103], v27 offset:20992
    v_mfma_f32_16x16x32_bf16 v[168:171], v[104:107], v[68:71], v[168:171]
    v_mfma_f32_16x16x32_bf16 v[200:203], v[104:107], v[72:75], v[200:203]
    v_mfma_f32_16x16x32_bf16 v[232:235], v[104:107], v[76:79], v[232:235]
    ds_read_b64_tr_b16 v[104:105], v26 offset:28672
    v_mfma_f32_16x16x32_bf16 v[236:239], v[108:111], v[76:79], v[236:239]
    ds_read_b64_tr_b16 v[106:107], v26 offset:29184
    v_mfma_f32_16x16x32_bf16 v[204:207], v[108:111], v[72:75], v[204:207]
    v_mfma_f32_16x16x32_bf16 v[172:175], v[108:111], v[68:71], v[172:175]
    v_mfma_f32_16x16x32_bf16 v[140:143], v[108:111], v[64:67], v[140:143]
    ds_read_b64_tr_b16 v[108:109], v27 offset:28672
    v_mfma_f32_16x16x32_bf16 v[144:147], v[64:67], v[112:115], v[144:147]
    ds_read_b64_tr_b16 v[110:111], v27 offset:29184
    v_mfma_f32_16x16x32_bf16 v[176:179], v[68:71], v[112:115], v[176:179]
    v_mfma_f32_16x16x32_bf16 v[208:211], v[72:75], v[112:115], v[208:211]
    v_mfma_f32_16x16x32_bf16 v[240:243], v[76:79], v[112:115], v[240:243]
    ds_read_b64_tr_b16 v[112:113], v26 offset:36864
    s_waitcnt lgkmcnt(5)
    v_mfma_f32_16x16x32_bf16 v[244:247], v[76:79], v[116:119], v[244:247]
    ds_read_b64_tr_b16 v[114:115], v26 offset:37376
    v_mfma_f32_16x16x32_bf16 v[212:215], v[72:75], v[116:119], v[212:215]
    v_mfma_f32_16x16x32_bf16 v[180:183], v[68:71], v[116:119], v[180:183]
    v_mfma_f32_16x16x32_bf16 v[148:151], v[64:67], v[116:119], v[148:151]
    ds_read_b64_tr_b16 v[116:117], v27 offset:36864
    v_mfma_f32_16x16x32_bf16 v[152:155], v[120:123], v[64:67], v[152:155]
    ds_read_b64_tr_b16 v[118:119], v27 offset:37376
    v_mfma_f32_16x16x32_bf16 v[184:187], v[120:123], v[68:71], v[184:187]
    v_mfma_f32_16x16x32_bf16 v[216:219], v[120:123], v[72:75], v[216:219]
    v_mfma_f32_16x16x32_bf16 v[248:251], v[120:123], v[76:79], v[248:251]
    ds_read_b64_tr_b16 v[120:121], v26 offset:45056
    v_mfma_f32_16x16x32_bf16 v[252:255], v[124:127], v[76:79], v[252:255]
    ds_read_b64_tr_b16 v[122:123], v26 offset:45568
    v_mfma_f32_16x16x32_bf16 v[220:223], v[124:127], v[72:75], v[220:223]
    v_mfma_f32_16x16x32_bf16 v[188:191], v[124:127], v[68:71], v[188:191]
    v_mfma_f32_16x16x32_bf16 v[156:159], v[124:127], v[64:67], v[156:159]
    ds_read_b64_tr_b16 v[124:125], v27 offset:45056
    v_mfma_f32_16x16x32_bf16 v[128:131], v[96:99], v[80:83], v[128:131]
    ds_read_b64_tr_b16 v[126:127], v27 offset:45568
    v_mfma_f32_16x16x32_bf16 v[160:163], v[96:99], v[84:87], v[160:163]
    v_mfma_f32_16x16x32_bf16 v[192:195], v[96:99], v[88:91], v[192:195]
    v_mfma_f32_16x16x32_bf16 v[224:227], v[96:99], v[92:95], v[224:227]
    v_mfma_f32_16x16x32_bf16 v[228:231], v[100:103], v[92:95], v[228:231]
    v_mfma_f32_16x16x32_bf16 v[196:199], v[100:103], v[88:91], v[196:199]
    v_mfma_f32_16x16x32_bf16 v[164:167], v[100:103], v[84:87], v[164:167]
    v_mfma_f32_16x16x32_bf16 v[132:135], v[100:103], v[80:83], v[132:135]
    s_waitcnt lgkmcnt(0)
    v_mfma_f32_16x16x32_bf16 v[136:139], v[104:107], v[80:83], v[136:139]
    s_barrier
    v_mfma_f32_16x16x32_bf16 v[168:171], v[104:107], v[84:87], v[168:171]
    ds_read_b64_tr_b16 v[96:97], v30 offset:16384
    v_mfma_f32_16x16x32_bf16 v[200:203], v[104:107], v[88:91], v[200:203]
    ds_read_b64_tr_b16 v[98:99], v30 offset:16896
    v_mfma_f32_16x16x32_bf16 v[232:235], v[104:107], v[92:95], v[232:235]
    ds_read_b128 v[64:67], v28 offset:0
    v_mfma_f32_16x16x32_bf16 v[236:239], v[108:111], v[92:95], v[236:239]
    ds_read_b128 v[68:71], v28 offset:2048
    v_mfma_f32_16x16x32_bf16 v[204:207], v[108:111], v[88:91], v[204:207]
    ds_read_b128 v[72:75], v28 offset:4096
    v_mfma_f32_16x16x32_bf16 v[172:175], v[108:111], v[84:87], v[172:175]
    ds_read_b128 v[76:79], v28 offset:6144
    v_mfma_f32_16x16x32_bf16 v[140:143], v[108:111], v[80:83], v[140:143]
    ds_read_b64_tr_b16 v[100:101], v31 offset:16384
    v_mfma_f32_16x16x32_bf16 v[144:147], v[80:83], v[112:115], v[144:147]
    ds_read_b64_tr_b16 v[102:103], v31 offset:16896
    v_mfma_f32_16x16x32_bf16 v[176:179], v[84:87], v[112:115], v[176:179]
    ds_read_b64_tr_b16 v[104:105], v30 offset:24576
    v_mfma_f32_16x16x32_bf16 v[208:211], v[88:91], v[112:115], v[208:211]
    ds_read_b64_tr_b16 v[106:107], v30 offset:25088
    v_mfma_f32_16x16x32_bf16 v[240:243], v[92:95], v[112:115], v[240:243]
    ds_read_b64_tr_b16 v[108:109], v31 offset:24576
    v_mfma_f32_16x16x32_bf16 v[244:247], v[92:95], v[116:119], v[244:247]
    ds_read_b64_tr_b16 v[110:111], v31 offset:25088
    v_mfma_f32_16x16x32_bf16 v[212:215], v[88:91], v[116:119], v[212:215]
    ds_read_b64_tr_b16 v[112:113], v30 offset:32768
    v_mfma_f32_16x16x32_bf16 v[180:183], v[84:87], v[116:119], v[180:183]
    ds_read_b64_tr_b16 v[114:115], v30 offset:33280
    v_mfma_f32_16x16x32_bf16 v[148:151], v[80:83], v[116:119], v[148:151]
    ds_read_b64_tr_b16 v[116:117], v31 offset:32768
    v_mfma_f32_16x16x32_bf16 v[152:155], v[120:123], v[80:83], v[152:155]
    ds_read_b64_tr_b16 v[118:119], v31 offset:33280
    v_mfma_f32_16x16x32_bf16 v[184:187], v[120:123], v[84:87], v[184:187]
    v_mfma_f32_16x16x32_bf16 v[216:219], v[120:123], v[88:91], v[216:219]
    v_mfma_f32_16x16x32_bf16 v[248:251], v[120:123], v[92:95], v[248:251]
    ds_read_b64_tr_b16 v[120:121], v30 offset:40960
    v_mfma_f32_16x16x32_bf16 v[252:255], v[124:127], v[92:95], v[252:255]
    ds_read_b64_tr_b16 v[122:123], v30 offset:41472
    v_mfma_f32_16x16x32_bf16 v[220:223], v[124:127], v[88:91], v[220:223]
    v_mfma_f32_16x16x32_bf16 v[188:191], v[124:127], v[84:87], v[188:191]
    v_mfma_f32_16x16x32_bf16 v[156:159], v[124:127], v[80:83], v[156:159]
    ds_read_b64_tr_b16 v[124:125], v31 offset:40960
C_p1a:
    v_cvt_pk_bf16_f32 v136, v136, v137
    v_cvt_pk_bf16_f32 v137, v138, v139
    v_cvt_pk_bf16_f32 v138, v140, v141
    v_cvt_pk_bf16_f32 v139, v142, v143
    v_cvt_pk_bf16_f32 v168, v168, v169
    v_cvt_pk_bf16_f32 v169, v170, v171
    v_cvt_pk_bf16_f32 v170, v172, v173
    v_cvt_pk_bf16_f32 v171, v174, v175
    v_cvt_pk_bf16_f32 v140, v144, v145
    v_cvt_pk_bf16_f32 v141, v146, v147
    v_cvt_pk_bf16_f32 v142, v176, v177
    v_cvt_pk_bf16_f32 v143, v178, v179
    v_cvt_pk_bf16_f32 v172, v148, v149
    v_cvt_pk_bf16_f32 v173, v150, v151
    v_cvt_pk_bf16_f32 v174, v180, v181
    v_cvt_pk_bf16_f32 v175, v182, v183
    v_cvt_pk_bf16_f32 v200, v200, v201
    v_cvt_pk_bf16_f32 v201, v202, v203
    v_cvt_pk_bf16_f32 v202, v204, v205
    v_cvt_pk_bf16_f32 v203, v206, v207
    v_cvt_pk_bf16_f32 v232, v232, v233
    v_cvt_pk_bf16_f32 v233, v234, v235
    v_cvt_pk_bf16_f32 v234, v236, v237
    v_cvt_pk_bf16_f32 v235, v238, v239
    v_cvt_pk_bf16_f32 v204, v208, v209
    v_cvt_pk_bf16_f32 v205, v210, v211
    v_cvt_pk_bf16_f32 v206, v240, v241
    v_cvt_pk_bf16_f32 v207, v242, v243
    v_cvt_pk_bf16_f32 v236, v212, v213
    v_cvt_pk_bf16_f32 v237, v214, v215
    v_cvt_pk_bf16_f32 v238, v244, v245
    v_cvt_pk_bf16_f32 v239, v246, v247
    v_permlane16_swap_b32 v136, v168
    v_permlane16_swap_b32 v137, v169
    v_permlane16_swap_b32 v138, v170
    v_permlane16_swap_b32 v139, v171
    v_permlane16_swap_b32 v200, v232
    v_permlane16_swap_b32 v201, v233
    v_permlane16_swap_b32 v202, v234
    v_permlane16_swap_b32 v203, v235
    buffer_store_dwordx4 v[136:139], v21, s[4:7], s46 offen offset:0 sc1
    buffer_store_dwordx4 v[168:171], v21, s[4:7], s46 offen offset:1024 sc1
    buffer_store_dwordx4 v[140:143], v22, s[4:7], s46 offen offset:2048 sc1
    buffer_store_dwordx4 v[172:175], v22, s[4:7], s46 offen offset:2176 sc1
    buffer_store_dwordx4 v[200:203], v21, s[4:7], s47 offen offset:0 sc1
    buffer_store_dwordx4 v[232:235], v21, s[4:7], s47 offen offset:1024 sc1
    buffer_store_dwordx4 v[204:207], v22, s[4:7], s47 offen offset:2048 sc1
    buffer_store_dwordx4 v[236:239], v22, s[4:7], s47 offen offset:2176 sc1
C_p1end:
    ds_write_b128 v21, v[136:139] offset:32768
    ds_write_b128 v21, v[168:171] offset:33792
    ds_write_b128 v22, v[140:143] offset:34816
    ds_write_b128 v22, v[172:175] offset:34944
    ds_write_b128 v21, v[200:203] offset:36864
    ds_write_b128 v21, v[232:235] offset:37888
    ds_write_b128 v22, v[204:207] offset:38912
    ds_write_b128 v22, v[236:239] offset:39040
    ds_read_b128 v[24:27], v18 offset:0
    ds_read_b128 v[28:31], v18 offset:256
    ds_read_b128 v[32:35], v18 offset:512
    ds_read_b128 v[36:39], v18 offset:768
    ds_read_b128 v[40:43], v19
    ds_read_b128 v[44:47], v19 offset:64
    ds_read_b32 v20, v20
    v_pk_mul_f32 v[128:129], v[128:129], s[38:39] op_sel_hi:[1,0]
    v_pk_mul_f32 v[130:131], v[130:131], s[38:39] op_sel_hi:[1,0]
    v_pk_mul_f32 v[132:133], v[132:133], s[38:39] op_sel_hi:[1,0]
    v_pk_mul_f32 v[134:135], v[134:135], s[38:39] op_sel_hi:[1,0]
    v_pk_mul_f32 v[160:161], v[160:161], s[38:39] op_sel_hi:[1,0]
    v_pk_mul_f32 v[162:163], v[162:163], s[38:39] op_sel_hi:[1,0]
    v_pk_mul_f32 v[164:165], v[164:165], s[38:39] op_sel_hi:[1,0]
    v_pk_mul_f32 v[166:167], v[166:167], s[38:39] op_sel_hi:[1,0]
    v_pk_mul_f32 v[192:193], v[192:193], s[38:39] op_sel_hi:[1,0]
    v_pk_mul_f32 v[194:195], v[194:195], s[38:39] op_sel_hi:[1,0]
    v_pk_mul_f32 v[196:197], v[196:197], s[38:39] op_sel_hi:[1,0]
    v_pk_mul_f32 v[198:199], v[198:199], s[38:39] op_sel_hi:[1,0]
    v_pk_mul_f32 v[224:225], v[224:225], s[38:39] op_sel_hi:[1,0]
    v_pk_mul_f32 v[226:227], v[226:227], s[38:39] op_sel_hi:[1,0]
    v_pk_mul_f32 v[228:229], v[228:229], s[38:39] op_sel_hi:[1,0]
    v_pk_mul_f32 v[230:231], v[230:231], s[38:39] op_sel_hi:[1,0]
    v_lshlrev_b32 v11, 4, v2
    s_lshl_b32 s3, s18, 12
    s_add_u32 s3, s3, 98304
    v_add_u32 v12, s3, v11
    v_xor_b32 v13, 8192, v12
    s_waitcnt lgkmcnt(0)
    v_readfirstlane_b32 s12, v20
    v_cvt_pk_bf16_f32 v200, v128, v129
    v_cvt_pk_bf16_f32 v201, v130, v131
    v_cvt_pk_bf16_f32 v202, v132, v133
    v_cvt_pk_bf16_f32 v203, v134, v135
    v_cvt_pk_bf16_f32 v204, v160, v161
    v_cvt_pk_bf16_f32 v205, v162, v163
    v_cvt_pk_bf16_f32 v206, v164, v165
    v_cvt_pk_bf16_f32 v207, v166, v167
    v_cvt_pk_bf16_f32 v208, v192, v193
    v_cvt_pk_bf16_f32 v209, v194, v195
    v_cvt_pk_bf16_f32 v210, v196, v197
    v_cvt_pk_bf16_f32 v211, v198, v199
    v_cvt_pk_bf16_f32 v212, v224, v225
    v_cvt_pk_bf16_f32 v213, v226, v227
    v_cvt_pk_bf16_f32 v214, v228, v229
    v_cvt_pk_bf16_f32 v215, v230, v231
    s_getreg_b32 s3, hwreg(HW_REG_IB_STS, 0, 4)
    s_cmp_ge_u32 s3, s49
    s_cbranch_scc1 L_tf_62
    s_waitcnt vmcnt(0)
    s_mov_b32 s49, 0
    v_mov_b32 v1, s12
    s_mov_b64 exec, 1
    buffer_store_dword v1, off, s[4:7], s48 sc1
    s_mov_b64 exec, -1
L_tf_62:
    v_permlane16_swap_b32 v200, v204
    v_permlane16_swap_b32 v201, v205
    v_permlane16_swap_b32 v202, v206
    v_permlane16_swap_b32 v203, v207
    v_permlane16_swap_b32 v208, v212
    v_permlane16_swap_b32 v209, v213
    v_permlane16_swap_b32 v210, v214
    v_permlane16_swap_b32 v211, v215
    ds_write_b128 v12, v[200:203] offset:0
    ds_write_b128 v12, v[204:207] offset:1024
    ds_write_b128 v12, v[208:211] offset:2048
    ds_write_b128 v12, v[212:215] offset:3072
    v_pk_fma_f32 v[248:249], v[40:41], v[36:37], v[248:249] op_sel_hi:[1,0,1] neg_lo:[0,1,0] neg_hi:[0,1,0]
    v_pk_fma_f32 v[250:251], v[42:43], v[36:37], v[250:251] op_sel_hi:[1,0,1] neg_lo:[0,1,0] neg_hi:[0,1,0]
    v_pk_fma_f32 v[252:253], v[44:45], v[36:37], v[252:253] op_sel_hi:[1,0,1] neg_lo:[0,1,0] neg_hi:[0,1,0]
    v_pk_fma_f32 v[254:255], v[46:47], v[36:37], v[254:255] op_sel_hi:[1,0,1] neg_lo:[0,1,0] neg_hi:[0,1,0]
    v_pk_mul_f32 v[48:49], v[248:249], v[248:249]
    v_pk_mul_f32 v[50:51], v[250:251], v[250:251]
    v_pk_mul_f32 v[52:53], v[252:253], v[252:253]
    v_pk_mul_f32 v[54:55], v[254:255], v[254:255]
    v_pk_fma_f32 v[48:49], v[48:49], v[38:39], v[36:37] op_sel:[0,0,1] op_sel_hi:[1,0,1]
    v_pk_fma_f32 v[50:51], v[50:51], v[38:39], v[36:37] op_sel:[0,0,1] op_sel_hi:[1,0,1]
    v_pk_fma_f32 v[52:53], v[52:53], v[38:39], v[36:37] op_sel:[0,0,1] op_sel_hi:[1,0,1]
    v_pk_fma_f32 v[54:55], v[54:55], v[38:39], v[36:37] op_sel:[0,0,1] op_sel_hi:[1,0,1]
    v_pk_mul_f32 v[48:49], v[48:49], v[248:249]
    v_pk_mul_f32 v[50:51], v[50:51], v[250:251]
    v_pk_mul_f32 v[52:53], v[52:53], v[252:253]
    v_pk_mul_f32 v[54:55], v[54:55], v[254:255]
    v_exp_f32 v48, v48
    v_exp_f32 v49, v49
    v_exp_f32 v50, v50
    v_exp_f32 v51, v51
    v_exp_f32 v52, v52
    v_exp_f32 v53, v53
    v_exp_f32 v54, v54
    v_exp_f32 v55, v55
    v_pk_fma_f32 v[48:49], v[48:49], v[38:39], v[38:39] op_sel:[0,1,1] op_sel_hi:[1,1,1]
    v_pk_fma_f32 v[50:51], v[50:51], v[38:39], v[38:39] op_sel:[0,1,1] op_sel_hi:[1,1,1]
    v_pk_fma_f32 v[52:53], v[52:53], v[38:39], v[38:39] op_sel:[0,1,1] op_sel_hi:[1,1,1]
    v_pk_fma_f32 v[54:55], v[54:55], v[38:39], v[38:39] op_sel:[0,1,1] op_sel_hi:[1,1,1]
    v_rcp_f32 v48, v48
    v_rcp_f32 v49, v49
    v_rcp_f32 v50, v50
    v_rcp_f32 v51, v51
    v_rcp_f32 v52, v52
    v_rcp_f32 v53, v53
    v_rcp_f32 v54, v54
    v_rcp_f32 v55, v55
    v_pk_mul_f32 v[248:249], v[248:249], v[48:49]
    v_pk_mul_f32 v[250:251], v[250:251], v[50:51]
    v_pk_mul_f32 v[252:253], v[252:253], v[52:53]
    v_pk_mul_f32 v[254:255], v[254:255], v[54:55]
    v_cvt_pk_bf16_f32 v240, v248, v249
    v_cvt_pk_bf16_f32 v241, v250, v251
    v_cvt_pk_bf16_f32 v242, v252, v253
    v_cvt_pk_bf16_f32 v243, v254, v255
    v_cndmask_b32 v240, 0, v240, s[44:45]
    v_cndmask_b32 v241, 0, v241, s[44:45]
    v_cndmask_b32 v242, 0, v242, s[44:45]
    v_cndmask_b32 v243, 0, v243, s[44:45]
    s_getreg_b32 s3, hwreg(HW_REG_IB_STS, 0, 4)
    s_cmp_ge_u32 s3, s49
    s_cbranch_scc1 L_tf_63
    s_waitcnt vmcnt(0)
    s_mov_b32 s49, 0
    v_mov_b32 v1, s12
    s_mov_b64 exec, 1
    buffer_store_dword v1, off, s[4:7], s48 sc1
    s_mov_b64 exec, -1
L_tf_63:
    s_waitcnt lgkmcnt(0)
    s_barrier
    v_pk_fma_f32 v[152:153], v[40:41], v[24:25], v[152:153] op_sel_hi:[1,0,1] neg_lo:[0,1,0] neg_hi:[0,1,0]
    v_pk_fma_f32 v[154:155], v[42:43], v[24:25], v[154:155] op_sel_hi:[1,0,1] neg_lo:[0,1,0] neg_hi:[0,1,0]
    v_pk_fma_f32 v[156:157], v[44:45], v[24:25], v[156:157] op_sel_hi:[1,0,1] neg_lo:[0,1,0] neg_hi:[0,1,0]
    v_pk_fma_f32 v[158:159], v[46:47], v[24:25], v[158:159] op_sel_hi:[1,0,1] neg_lo:[0,1,0] neg_hi:[0,1,0]
    v_pk_mul_f32 v[48:49], v[152:153], v[152:153]
    v_pk_mul_f32 v[50:51], v[154:155], v[154:155]
    v_pk_mul_f32 v[52:53], v[156:157], v[156:157]
    v_pk_mul_f32 v[54:55], v[158:159], v[158:159]
    v_pk_fma_f32 v[48:49], v[48:49], v[26:27], v[24:25] op_sel:[0,0,1] op_sel_hi:[1,0,1]
    v_pk_fma_f32 v[50:51], v[50:51], v[26:27], v[24:25] op_sel:[0,0,1] op_sel_hi:[1,0,1]
    v_pk_fma_f32 v[52:53], v[52:53], v[26:27], v[24:25] op_sel:[0,0,1] op_sel_hi:[1,0,1]
    v_pk_fma_f32 v[54:55], v[54:55], v[26:27], v[24:25] op_sel:[0,0,1] op_sel_hi:[1,0,1]
    v_pk_mul_f32 v[48:49], v[48:49], v[152:153]
    v_pk_mul_f32 v[50:51], v[50:51], v[154:155]
    v_pk_mul_f32 v[52:53], v[52:53], v[156:157]
    v_pk_mul_f32 v[54:55], v[54:55], v[158:159]
    v_exp_f32 v48, v48
    v_exp_f32 v49, v49
    v_exp_f32 v50, v50
    v_exp_f32 v51, v51
    v_exp_f32 v52, v52
    v_exp_f32 v53, v53
    v_exp_f32 v54, v54
    v_exp_f32 v55, v55
    v_pk_fma_f32 v[48:49], v[48:49], v[26:27], v[26:27] op_sel:[0,1,1] op_sel_hi:[1,1,1]
    v_pk_fma_f32 v[50:51], v[50:51], v[26:27], v[26:27] op_sel:[0,1,1] op_sel_hi:[1,1,1]
    v_pk_fma_f32 v[52:53], v[52:53], v[26:27], v[26:27] op_sel:[0,1,1] op_sel_hi:[1,1,1]
    v_pk_fma_f32 v[54:55], v[54:55], v[26:27], v[26:27] op_sel:[0,1,1] op_sel_hi:[1,1,1]
    v_rcp_f32 v48, v48
    v_rcp_f32 v49, v49
    v_rcp_f32 v50, v50
    v_rcp_f32 v51, v51
    v_rcp_f32 v52, v52
    v_rcp_f32 v53, v53
    v_rcp_f32 v54, v54
    v_rcp_f32 v55, v55
    v_pk_mul_f32 v[152:153], v[152:153], v[48:49]
    v_pk_mul_f32 v[154:155], v[154:155], v[50:51]
    v_pk_mul_f32 v[156:157], v[156:157], v[52:53]
    v_pk_mul_f32 v[158:159], v[158:159], v[54:55]
    v_cvt_pk_bf16_f32 v244, v152, v153
    v_cvt_pk_bf16_f32 v245, v154, v155
    v_cvt_pk_bf16_f32 v246, v156, v157
    v_cvt_pk_bf16_f32 v247, v158, v159
    v_cndmask_b32 v244, 0, v244, s[42:43]
    v_cndmask_b32 v245, 0, v245, s[42:43]
    v_cndmask_b32 v246, 0, v246, s[42:43]
    v_cndmask_b32 v247, 0, v247, s[42:43]
    s_getreg_b32 s3, hwreg(HW_REG_IB_STS, 0, 4)
    s_cmp_ge_u32 s3, s49
    s_cbranch_scc1 L_tf_64
    s_waitcnt vmcnt(0)
    s_mov_b32 s49, 0
    v_mov_b32 v1, s12
    s_mov_b64 exec, 1
    buffer_store_dword v1, off, s[4:7], s48 sc1
    s_mov_b64 exec, -1
L_tf_64:
    v_pk_fma_f32 v[184:185], v[40:41], v[28:29], v[184:185] op_sel_hi:[1,0,1] neg_lo:[0,1,0] neg_hi:[0,1,0]
    v_pk_fma_f32 v[186:187], v[42:43], v[28:29], v[186:187] op_sel_hi:[1,0,1] neg_lo:[0,1,0] neg_hi:[0,1,0]
    v_pk_fma_f32 v[188:189], v[44:45], v[28:29], v[188:189] op_sel_hi:[1,0,1] neg_lo:[0,1,0] neg_hi:[0,1,0]
    v_pk_fma_f32 v[190:191], v[46:47], v[28:29], v[190:191] op_sel_hi:[1,0,1] neg_lo:[0,1,0] neg_hi:[0,1,0]
    v_pk_mul_f32 v[48:49], v[184:185], v[184:185]
    v_pk_mul_f32 v[50:51], v[186:187], v[186:187]
    v_pk_mul_f32 v[52:53], v[188:189], v[188:189]
    v_pk_mul_f32 v[54:55], v[190:191], v[190:191]
    v_pk_fma_f32 v[48:49], v[48:49], v[30:31], v[28:29] op_sel:[0,0,1] op_sel_hi:[1,0,1]
    v_pk_fma_f32 v[50:51], v[50:51], v[30:31], v[28:29] op_sel:[0,0,1] op_sel_hi:[1,0,1]
    v_pk_fma_f32 v[52:53], v[52:53], v[30:31], v[28:29] op_sel:[0,0,1] op_sel_hi:[1,0,1]
    v_pk_fma_f32 v[54:55], v[54:55], v[30:31], v[28:29] op_sel:[0,0,1] op_sel_hi:[1,0,1]
    v_pk_mul_f32 v[48:49], v[48:49], v[184:185]
    v_pk_mul_f32 v[50:51], v[50:51], v[186:187]
    v_pk_mul_f32 v[52:53], v[52:53], v[188:189]
    v_pk_mul_f32 v[54:55], v[54:55], v[190:191]
    v_exp_f32 v48, v48
    v_exp_f32 v49, v49
    v_exp_f32 v50, v50
    v_exp_f32 v51, v51
    v_exp_f32 v52, v52
    v_exp_f32 v53, v53
    v_exp_f32 v54, v54
    v_exp_f32 v55, v55
    v_pk_fma_f32 v[48:49], v[48:49], v[30:31], v[30:31] op_sel:[0,1,1] op_sel_hi:[1,1,1]
    v_pk_fma_f32 v[50:51], v[50:51], v[30:31], v[30:31] op_sel:[0,1,1] op_sel_hi:[1,1,1]
    v_pk_fma_f32 v[52:53], v[52:53], v[30:31], v[30:31] op_sel:[0,1,1] op_sel_hi:[1,1,1]
    v_pk_fma_f32 v[54:55], v[54:55], v[30:31], v[30:31] op_sel:[0,1,1] op_sel_hi:[1,1,1]
    v_rcp_f32 v48, v48
    v_rcp_f32 v49, v49
    v_rcp_f32 v50, v50
    v_rcp_f32 v51, v51
    v_rcp_f32 v52, v52
    v_rcp_f32 v53, v53
    v_rcp_f32 v54, v54
    v_rcp_f32 v55, v55
    v_pk_mul_f32 v[184:185], v[184:185], v[48:49]
    v_pk_mul_f32 v[186:187], v[186:187], v[50:51]
    v_pk_mul_f32 v[188:189], v[188:189], v[52:53]
    v_pk_mul_f32 v[190:191], v[190:191], v[54:55]
    v_cvt_pk_bf16_f32 v248, v184, v185
    v_cvt_pk_bf16_f32 v249, v186, v187
    v_cvt_pk_bf16_f32 v250, v188, v189
    v_cvt_pk_bf16_f32 v251, v190, v191
    s_getreg_b32 s3, hwreg(HW_REG_IB_STS, 0, 4)
    s_cmp_ge_u32 s3, s49
    s_cbranch_scc1 L_tf_65
    s_waitcnt vmcnt(0)
    s_mov_b32 s49, 0
    v_mov_b32 v1, s12
    s_mov_b64 exec, 1
    buffer_store_dword v1, off, s[4:7], s48 sc1
    s_mov_b64 exec, -1
L_tf_65:
    v_pk_fma_f32 v[216:217], v[40:41], v[32:33], v[216:217] op_sel_hi:[1,0,1] neg_lo:[0,1,0] neg_hi:[0,1,0]
    v_pk_fma_f32 v[218:219], v[42:43], v[32:33], v[218:219] op_sel_hi:[1,0,1] neg_lo:[0,1,0] neg_hi:[0,1,0]
    v_pk_fma_f32 v[220:221], v[44:45], v[32:33], v[220:221] op_sel_hi:[1,0,1] neg_lo:[0,1,0] neg_hi:[0,1,0]
    v_pk_fma_f32 v[222:223], v[46:47], v[32:33], v[222:223] op_sel_hi:[1,0,1] neg_lo:[0,1,0] neg_hi:[0,1,0]
    v_pk_mul_f32 v[48:49], v[216:217], v[216:217]
    v_pk_mul_f32 v[50:51], v[218:219], v[218:219]
    v_pk_mul_f32 v[52:53], v[220:221], v[220:221]
    v_pk_mul_f32 v[54:55], v[222:223], v[222:223]
    v_pk_fma_f32 v[48:49], v[48:49], v[34:35], v[32:33] op_sel:[0,0,1] op_sel_hi:[1,0,1]
    v_pk_fma_f32 v[50:51], v[50:51], v[34:35], v[32:33] op_sel:[0,0,1] op_sel_hi:[1,0,1]
    v_pk_fma_f32 v[52:53], v[52:53], v[34:35], v[32:33] op_sel:[0,0,1] op_sel_hi:[1,0,1]
    v_pk_fma_f32 v[54:55], v[54:55], v[34:35], v[32:33] op_sel:[0,0,1] op_sel_hi:[1,0,1]
    v_pk_mul_f32 v[48:49], v[48:49], v[216:217]
    v_pk_mul_f32 v[50:51], v[50:51], v[218:219]
    v_pk_mul_f32 v[52:53], v[52:53], v[220:221]
    v_pk_mul_f32 v[54:55], v[54:55], v[222:223]
    v_exp_f32 v48, v48
    v_exp_f32 v49, v49
    v_exp_f32 v50, v50
    v_exp_f32 v51, v51
    v_exp_f32 v52, v52
    v_exp_f32 v53, v53
    v_exp_f32 v54, v54
    v_exp_f32 v55, v55
    v_pk_fma_f32 v[48:49], v[48:49], v[34:35], v[34:35] op_sel:[0,1,1] op_sel_hi:[1,1,1]
    v_pk_fma_f32 v[50:51], v[50:51], v[34:35], v[34:35] op_sel:[0,1,1] op_sel_hi:[1,1,1]
    v_pk_fma_f32 v[52:53], v[52:53], v[34:35], v[34:35] op_sel:[0,1,1] op_sel_hi:[1,1,1]
    v_pk_fma_f32 v[54:55], v[54:55], v[34:35], v[34:35] op_sel:[0,1,1] op_sel_hi:[1,1,1]
    v_rcp_f32 v48, v48
    v_rcp_f32 v49, v49
    v_rcp_f32 v50, v50
    v_rcp_f32 v51, v51
    v_rcp_f32 v52, v52
    v_rcp_f32 v53, v53
    v_rcp_f32 v54, v54
    v_rcp_f32 v55, v55
    v_pk_mul_f32 v[216:217], v[216:217], v[48:49]
    v_pk_mul_f32 v[218:219], v[218:219], v[50:51]
    v_pk_mul_f32 v[220:221], v[220:221], v[52:53]
    v_pk_mul_f32 v[222:223], v[222:223], v[54:55]
    v_cvt_pk_bf16_f32 v252, v216, v217
    v_cvt_pk_bf16_f32 v253, v218, v219
    v_cvt_pk_bf16_f32 v254, v220, v221
    v_cvt_pk_bf16_f32 v255, v222, v223
    s_getreg_b32 s3, hwreg(HW_REG_IB_STS, 0, 4)
    s_cmp_ge_u32 s3, s49
    s_cbranch_scc1 L_tf_66
    s_waitcnt vmcnt(0)
    s_mov_b32 s49, 0
    v_mov_b32 v1, s12
    s_mov_b64 exec, 1
    buffer_store_dword v1, off, s[4:7], s48 sc1
    s_mov_b64 exec, -1
L_tf_66:
    v_mov_b32 v48, v240
    v_mov_b32 v49, v241
    v_mov_b32 v50, v242
    v_mov_b32 v51, v243
    v_cndmask_b32 v240, v240, v252, s[50:51]
    v_cndmask_b32 v241, v241, v253, s[50:51]
    v_cndmask_b32 v242, v242, v254, s[50:51]
    v_cndmask_b32 v243, v243, v255, s[50:51]
    v_cndmask_b32 v252, v252, v248, s[50:51]
    v_cndmask_b32 v253, v253, v249, s[50:51]
    v_cndmask_b32 v254, v254, v250, s[50:51]
    v_cndmask_b32 v255, v255, v251, s[50:51]
    v_cndmask_b32 v248, v248, v244, s[50:51]
    v_cndmask_b32 v249, v249, v245, s[50:51]
    v_cndmask_b32 v250, v250, v246, s[50:51]
    v_cndmask_b32 v251, v251, v247, s[50:51]
    v_cndmask_b32 v244, v244, v48, s[50:51]
    v_cndmask_b32 v245, v245, v49, s[50:51]
    v_cndmask_b32 v246, v246, v50, s[50:51]
    v_cndmask_b32 v247, v247, v51, s[50:51]
    s_lshl_b32 s3, s20, 14
    s_lshl_b32 s21, s19, 13
    s_add_u32 s3, s3, s21
    v_add_u32 v10, s3, v11
    v_add_u32 v17, 65536, v10
    ds_read_b128 v[216:219], v13 offset:0
    ds_read_b128 v[220:223], v13 offset:1024
    ds_read_b128 v[224:227], v13 offset:2048
    ds_read_b128 v[228:231], v13 offset:3072
    ds_read_b128 v[40:43], v10 offset:34816
    ds_read_b128 v[44:47], v10 offset:35840
    ds_read_b128 v[24:27], v10 offset:32768
    ds_read_b128 v[28:31], v10 offset:33792
    v_and_b32 v5, 7, v2
    v_cmp_eq_u32 vcc, 0, v5
    v_cmp_eq_u32 s[42:43], 4, v5
    v_mov_b32 v5, 0x3f803f80
    v_mov_b32 v19, 0xdddddddd
    v_cndmask_b32 v20, 0, v5, vcc
    v_cndmask_b32 v21, 0, v5, vcc
    v_cndmask_b32 v22, 0, v5, s[42:43]
    v_cndmask_b32 v23, 0, v5, s[42:43]
    v_mov_b64 v[112:113], 0
    v_mov_b64 v[114:115], 0
    v_mov_b64 v[116:117], 0
    v_mov_b64 v[118:119], 0
    v_mov_b64 v[120:121], 0
    v_mov_b64 v[122:123], 0
    v_mov_b64 v[124:125], 0
    v_mov_b64 v[126:127], 0
    v_mov_b64 v[48:49], 0
    v_mov_b64 v[50:51], 0
    v_mov_b64 v[52:53], 0
    v_mov_b64 v[54:55], 0
    s_waitcnt lgkmcnt(0)
    v_mfma_f32_32x32x16_bf16 v[64:79], v[24:27], v[216:219], 0
    v_mfma_f32_32x32x16_bf16 v[64:79], v[28:31], v[220:223], v[64:79]
    v_mov_b64 v[128:129], 0
    v_mov_b64 v[130:131], 0
    v_mov_b64 v[132:133], 0
    v_mov_b64 v[134:135], 0
    v_mov_b64 v[136:137], 0
    v_mov_b64 v[138:139], 0
    v_mov_b64 v[140:141], 0
    v_mov_b64 v[142:143], 0
    v_mov_b64 v[144:145], 0
    v_mov_b64 v[146:147], 0
    v_mov_b64 v[148:149], 0
    v_mov_b64 v[150:151], 0
    v_mov_b64 v[152:153], 0
    v_mov_b64 v[154:155], 0
    v_mov_b64 v[156:157], 0
    v_mov_b64 v[158:159], 0
    v_mov_b64 v[160:161], 0
    v_mov_b64 v[162:163], 0
    v_mov_b64 v[164:165], 0
    v_mov_b64 v[166:167], 0
    v_mov_b64 v[168:169], 0
    v_mov_b64 v[170:171], 0
    v_mov_b64 v[172:173], 0
    v_mov_b64 v[174:175], 0
    v_mov_b64 v[176:177], 0
    v_mov_b64 v[178:179], 0
    v_mov_b64 v[180:181], 0
    v_mov_b64 v[182:183], 0
    v_mov_b64 v[184:185], 0
    v_mov_b64 v[186:187], 0
    v_mov_b64 v[188:189], 0
    v_mov_b64 v[190:191], 0
    v_mov_b64 v[192:193], 0
    v_mov_b64 v[194:195], 0
    v_mov_b64 v[196:197], 0
    v_mov_b64 v[198:199], 0
    v_mov_b64 v[232:233], 0
    v_mov_b64 v[234:235], 0
    v_mov_b64 v[236:237], 0
    v_mov_b64 v[238:239], 0
    s_cmp_eq_u32 s49, 0
    s_cbranch_scc1 L_tf_68
    s_waitcnt vmcnt(0)
    s_mov_b32 s49, 0
    v_mov_b32 v1, s12
    s_mov_b64 exec, 1
    buffer_store_dword v1, off, s[4:7], s48 sc1
    s_mov_b64 exec, -1
L_tf_68:
    v_mfma_f32_32x32x16_bf16 v[80:95], v[24:27], v[224:227], 0
    v_exp_f32 v64, v64
    v_exp_f32 v65, v65
    v_exp_f32 v66, v66
    v_mfma_f32_32x32x16_bf16 v[80:95], v[28:31], v[228:231], v[80:95]
    v_exp_f32 v67, v67
    v_exp_f32 v68, v68
    v_exp_f32 v69, v69
    v_smfmac_f32_32x32x32_bf16 v[144:159], v[48:51], v[112:119], v19
    v_exp_f32 v70, v70
    v_exp_f32 v71, v71
    v_exp_f32 v72, v72
    v_smfmac_f32_16x16x64_bf16 v[196:199], v[20:23], v[112:119], v19
    v_exp_f32 v73, v73
    v_smfmac_f32_32x32x32_bf16 v[144:159], v[52:55], v[120:127], v19
    v_exp_f32 v74, v74
    v_exp_f32 v75, v75
    v_exp_f32 v76, v76
    v_smfmac_f32_16x16x64_bf16 v[196:199], v[20:23], v[120:127], v19
    v_exp_f32 v77, v77
    v_exp_f32 v78, v78
    v_exp_f32 v79, v79
    v_mfma_f32_32x32x16_bf16 v[96:111], v[24:27], v[200:203], 0
    v_exp_f32 v80, v80
    v_exp_f32 v81, v81
    v_exp_f32 v82, v82
    v_mfma_f32_32x32x16_bf16 v[96:111], v[28:31], v[204:207], v[96:111]
    v_exp_f32 v83, v83
    v_exp_f32 v84, v84
    v_exp_f32 v85, v85
    v_smfmac_f32_32x32x32_bf16 v[160:175], v[40:43], v[64:71], v19
    v_exp_f32 v86, v86
    v_exp_f32 v87, v87
    v_exp_f32 v88, v88
    v_smfmac_f32_16x16x64_bf16 v[232:235], v[20:23], v[64:71], v19
    v_exp_f32 v89, v89
    v_smfmac_f32_32x32x32_bf16 v[160:175], v[44:47], v[72:79], v19
    v_exp_f32 v90, v90
    v_exp_f32 v91, v91
    v_exp_f32 v92, v92
    v_smfmac_f32_16x16x64_bf16 v[232:235], v[20:23], v[72:79], v19
    v_exp_f32 v93, v93
    v_exp_f32 v94, v94
    v_exp_f32 v95, v95
    v_mfma_f32_32x32x16_bf16 v[112:127], v[24:27], v[208:211], 0
    buffer_store_dwordx4 v[244:247], v56, s[4:7], s34 offen sc1
    ds_read_b128 v[48:51], v10 offset:38912
    v_exp_f32 v96, v96
    v_exp_f32 v97, v97
    v_exp_f32 v98, v98
    v_mfma_f32_32x32x16_bf16 v[112:127], v[28:31], v[212:215], v[112:127]
    ds_read_b128 v[52:55], v10 offset:39936
    v_exp_f32 v99, v99
    v_exp_f32 v100, v100
    v_exp_f32 v101, v101
    v_smfmac_f32_32x32x32_bf16 v[176:191], v[40:43], v[80:87], v19
    ds_read_b128 v[32:35], v10 offset:36864
    v_exp_f32 v102, v102
    v_exp_f32 v103, v103
    v_exp_f32 v104, v104
    v_smfmac_f32_16x16x64_bf16 v[236:239], v[20:23], v[80:87], v19
    ds_read_b128 v[36:39], v10 offset:37888
    v_exp_f32 v105, v105
    v_smfmac_f32_32x32x32_bf16 v[176:191], v[44:47], v[88:95], v19
    v_exp_f32 v106, v106
    v_exp_f32 v107, v107
    v_exp_f32 v108, v108
    v_smfmac_f32_16x16x64_bf16 v[236:239], v[20:23], v[88:95], v19
    v_exp_f32 v109, v109
    v_exp_f32 v110, v110
    v_exp_f32 v111, v111
    s_waitcnt lgkmcnt(0)
    v_mfma_f32_32x32x16_bf16 v[64:79], v[32:35], v[216:219], 0
    buffer_store_dwordx4 v[248:251], v57, s[4:7], s34 offen sc1
    v_exp_f32 v112, v112
    v_exp_f32 v113, v113
    v_exp_f32 v114, v114
    v_mfma_f32_32x32x16_bf16 v[64:79], v[36:39], v[220:223], v[64:79]
    v_exp_f32 v115, v115
    v_exp_f32 v116, v116
    v_exp_f32 v117, v117
    v_smfmac_f32_32x32x32_bf16 v[128:143], v[40:43], v[96:103], v19
    v_exp_f32 v118, v118
    v_exp_f32 v119, v119
    v_exp_f32 v120, v120
    v_smfmac_f32_16x16x64_bf16 v[192:195], v[20:23], v[96:103], v19
    v_exp_f32 v121, v121
    v_smfmac_f32_32x32x32_bf16 v[128:143], v[44:47], v[104:111], v19
    v_exp_f32 v122, v122
    v_exp_f32 v123, v123
    v_exp_f32 v124, v124
    v_smfmac_f32_16x16x64_bf16 v[192:195], v[20:23], v[104:111], v19
    v_exp_f32 v125, v125
    v_exp_f32 v126, v126
    v_exp_f32 v127, v127
    v_mfma_f32_32x32x16_bf16 v[80:95], v[32:35], v[224:227], 0
    buffer_store_dwordx4 v[252:255], v58, s[4:7], s34 offen sc1
    v_exp_f32 v64, v64
    v_exp_f32 v65, v65
    v_exp_f32 v66, v66
    v_mfma_f32_32x32x16_bf16 v[80:95], v[36:39], v[228:231], v[80:95]
    v_exp_f32 v67, v67
    v_exp_f32 v68, v68
    v_exp_f32 v69, v69
    v_smfmac_f32_32x32x32_bf16 v[144:159], v[40:43], v[112:119], v19
    v_exp_f32 v70, v70
    v_exp_f32 v71, v71
    v_exp_f32 v72, v72
    v_smfmac_f32_16x16x64_bf16 v[196:199], v[20:23], v[112:119], v19
    v_exp_f32 v73, v73
    v_smfmac_f32_32x32x32_bf16 v[144:159], v[44:47], v[120:127], v19
    v_exp_f32 v74, v74
    v_exp_f32 v75, v75
    v_exp_f32 v76, v76
    v_smfmac_f32_16x16x64_bf16 v[196:199], v[20:23], v[120:127], v19
    v_exp_f32 v77, v77
    v_exp_f32 v78, v78
    v_exp_f32 v79, v79
    v_mfma_f32_32x32x16_bf16 v[96:111], v[32:35], v[200:203], 0
    buffer_store_dwordx4 v[240:243], v59, s[4:7], s34 offen sc1
    v_exp_f32 v80, v80
    v_exp_f32 v81, v81
    v_exp_f32 v82, v82
    v_mfma_f32_32x32x16_bf16 v[96:111], v[36:39], v[204:207], v[96:111]
    v_exp_f32 v83, v83
    v_exp_f32 v84, v84
    v_exp_f32 v85, v85
    v_smfmac_f32_32x32x32_bf16 v[160:175], v[48:51], v[64:71], v19
    v_exp_f32 v86, v86
    v_exp_f32 v87, v87
    v_exp_f32 v88, v88
    v_smfmac_f32_16x16x64_bf16 v[232:235], v[20:23], v[64:71], v19
    v_exp_f32 v89, v89
    v_smfmac_f32_32x32x32_bf16 v[160:175], v[52:55], v[72:79], v19
    v_exp_f32 v90, v90
    v_exp_f32 v91, v91
    v_exp_f32 v92, v92
    v_smfmac_f32_16x16x64_bf16 v[232:235], v[20:23], v[72:79], v19
    v_exp_f32 v93, v93
    v_exp_f32 v94, v94
    v_exp_f32 v95, v95
    v_mfma_f32_32x32x16_bf16 v[112:127], v[32:35], v[208:211], 0
    v_and_b32 v5, 31, v2
    s_lshl_b32 s3, s19, 8
    s_add_u32 s3, s3, 158720
    v_lshl_add_u32 v12, v5, 2, s3
    s_mul_i32 s28, s16, 2359296
    s_add_u32 s28, s28, 50331648
    s_lshl_b32 s3, s17, 1
    s_add_u32 s3, s3, s20
    s_add_u32 s3, s3, 112
    s_lshl_b32 s3, s3, 14
    s_add_u32 s29, s28, s3
    s_lshl_b32 s3, s19, 13
    s_add_u32 s29, s29, s3
    s_add_u32 s35, s29, 4096
    v_bfe_u32 v6, v2, 4, 1
    v_lshlrev_b32 v6, 10, v6
    v_lshl_add_u32 v6, v3, 4, v6
    v_lshrrev_b32 v7, 5, v2
    v_lshl_add_u32 v16, v7, 8, v6
    v_and_b32 v6, 0xffffff80, v16
    v_add_u32 v16, v6, v16
    s_lshl_b32 s3, s19, 12
    v_add_u32 v56, s3, v11
    v_mov_b32 v9, v11
    v_lshrrev_b32 v5, 2, v3
    v_and_b32 v6, 3, v3
    v_lshl_add_u32 v7, v4, 2, v5
    v_mul_u32_u24 v7, 448, v7
    v_add_u32 v7, 16384, v7
    v_and_b32 v8, 1, v4
    v_lshl_add_u32 v5, v6, 3, v7
    s_lshl_b32 s3, s20, 8
    v_add_u32 v5, s3, v5
    v_lshl_add_u32 v57, v8, 5, v5
    v_xor_b32 v58, 1, v8
    v_lshl_add_u32 v58, v58, 5, v5
    v_and_b32 v5, 1, v6
    v_xor_b32 v5, v5, v8
    v_lshl_add_u32 v7, v5, 5, v7
    v_lshrrev_b32 v5, 1, v6
    v_lshl_add_u32 v7, v5, 3, v7
    s_lshl_b32 s3, s20, 4
    s_add_u32 s3, s3, 192
    v_add_u32 v59, s3, v7
    s_lshr_b32 s22, s17, 3
    s_lshl_b32 s3, s19, 6
    s_lshl_b32 s42, s22, 5
    s_add_u32 s42, s42, s3
    s_lshl_b32 s30, s16, 18
    s_and_b32 s3, s17, 7
    s_lshl_b32 s3, s3, 15
    s_add_u32 s30, s30, s3
    s_lshl_b32 s3, s20, 14
    s_add_u32 s30, s30, s3
    s_lshl_b32 s3, s42, 6
    s_add_u32 s30, s30, s3
    s_add_u32 s30, s30, 16777216
    s_add_u32 s31, s30, 8192
    v_xor_b32 v18, 8192, v10
    s_barrier
    ds_read_b128 v[40:43], v17 offset:2048
    v_exp_f32 v96, v96
    v_exp_f32 v97, v97
    v_exp_f32 v98, v98
    v_mfma_f32_32x32x16_bf16 v[112:127], v[36:39], v[212:215], v[112:127]
    ds_read_b128 v[44:47], v17 offset:3072
    v_exp_f32 v99, v99
    v_exp_f32 v100, v100
    v_exp_f32 v101, v101
    v_smfmac_f32_32x32x32_bf16 v[176:191], v[48:51], v[80:87], v19
    ds_read_b128 v[24:27], v17 offset:0
    v_exp_f32 v102, v102
    v_exp_f32 v103, v103
    v_exp_f32 v104, v104
    v_smfmac_f32_16x16x64_bf16 v[236:239], v[20:23], v[80:87], v19
    ds_read_b128 v[28:31], v17 offset:1024
    v_exp_f32 v105, v105
    v_smfmac_f32_32x32x32_bf16 v[176:191], v[52:55], v[88:95], v19
    v_exp_f32 v106, v106
    v_exp_f32 v107, v107
    v_exp_f32 v108, v108
    v_smfmac_f32_16x16x64_bf16 v[236:239], v[20:23], v[88:95], v19
    v_exp_f32 v109, v109
    v_exp_f32 v110, v110
    v_exp_f32 v111, v111
    s_waitcnt lgkmcnt(0)
    v_mfma_f32_32x32x16_bf16 v[64:79], v[24:27], v[216:219], 0
    v_exp_f32 v112, v112
    v_exp_f32 v113, v113
    v_exp_f32 v114, v114
    v_mfma_f32_32x32x16_bf16 v[64:79], v[28:31], v[220:223], v[64:79]
    v_exp_f32 v115, v115
    v_exp_f32 v116, v116
    v_exp_f32 v117, v117
    v_smfmac_f32_32x32x32_bf16 v[128:143], v[48:51], v[96:103], v19
    v_exp_f32 v118, v118
    v_exp_f32 v119, v119
    v_exp_f32 v120, v120
    v_smfmac_f32_16x16x64_bf16 v[192:195], v[20:23], v[96:103], v19
    v_exp_f32 v121, v121
    v_smfmac_f32_32x32x32_bf16 v[128:143], v[52:55], v[104:111], v19
    v_exp_f32 v122, v122
    v_exp_f32 v123, v123
    v_exp_f32 v124, v124
    v_smfmac_f32_16x16x64_bf16 v[192:195], v[20:23], v[104:111], v19
    v_exp_f32 v125, v125
    v_exp_f32 v126, v126
    v_exp_f32 v127, v127
    s_add_u32 s48, s23, 46530560
    s_mov_b32 s49, 1
    s_cmp_eq_u32 s49, 0
    s_cbranch_scc1 L_tf_69
    s_waitcnt vmcnt(0)
    s_mov_b32 s49, 0
    v_mov_b32 v1, s12
    s_mov_b64 exec, 1
    buffer_store_dword v1, off, s[4:7], s48 sc1
    s_mov_b64 exec, -1
L_tf_69:
    s_setprio 1
    s_mov_b32 s40, 2
    s_mov_b32 s41, 3
L_aloop_70:
    v_mfma_f32_32x32x16_bf16 v[80:95], v[24:27], v[224:227], 0
    v_exp_f32 v64, v64
    v_exp_f32 v65, v65
    v_exp_f32 v66, v66
    v_mfma_f32_32x32x16_bf16 v[80:95], v[28:31], v[228:231], v[80:95]
    v_exp_f32 v67, v67
    v_exp_f32 v68, v68
    v_exp_f32 v69, v69
    v_smfmac_f32_32x32x32_bf16 v[144:159], v[48:51], v[112:119], v19
    v_exp_f32 v70, v70
    v_exp_f32 v71, v71
    v_exp_f32 v72, v72
    v_smfmac_f32_16x16x64_bf16 v[196:199], v[20:23], v[112:119], v19
    v_exp_f32 v73, v73
    v_smfmac_f32_32x32x32_bf16 v[144:159], v[52:55], v[120:127], v19
    v_exp_f32 v74, v74
    v_exp_f32 v75, v75
    v_exp_f32 v76, v76
    v_smfmac_f32_16x16x64_bf16 v[196:199], v[20:23], v[120:127], v19
    v_exp_f32 v77, v77
    v_exp_f32 v78, v78
    v_exp_f32 v79, v79
    v_mfma_f32_32x32x16_bf16 v[96:111], v[24:27], v[200:203], 0
    v_exp_f32 v80, v80
    v_exp_f32 v81, v81
    v_exp_f32 v82, v82
    v_mfma_f32_32x32x16_bf16 v[96:111], v[28:31], v[204:207], v[96:111]
    v_exp_f32 v83, v83
    v_exp_f32 v84, v84
    v_exp_f32 v85, v85
    v_smfmac_f32_32x32x32_bf16 v[160:175], v[40:43], v[64:71], v19
    v_exp_f32 v86, v86
    v_exp_f32 v87, v87
    v_exp_f32 v88, v88
    v_smfmac_f32_16x16x64_bf16 v[232:235], v[20:23], v[64:71], v19
    v_exp_f32 v89, v89
    v_smfmac_f32_32x32x32_bf16 v[160:175], v[44:47], v[72:79], v19
    v_exp_f32 v90, v90
    v_exp_f32 v91, v91
    v_exp_f32 v92, v92
    v_smfmac_f32_16x16x64_bf16 v[232:235], v[20:23], v[72:79], v19
    v_exp_f32 v93, v93
    v_exp_f32 v94, v94
    v_exp_f32 v95, v95
    v_mfma_f32_32x32x16_bf16 v[112:127], v[24:27], v[208:211], 0
    ds_read_b128 v[48:51], v17 offset:6144
    v_exp_f32 v96, v96
    v_exp_f32 v97, v97
    v_exp_f32 v98, v98
    v_mfma_f32_32x32x16_bf16 v[112:127], v[28:31], v[212:215], v[112:127]
    ds_read_b128 v[52:55], v17 offset:7168
    v_exp_f32 v99, v99
    v_exp_f32 v100, v100
    v_exp_f32 v101, v101
    v_smfmac_f32_32x32x32_bf16 v[176:191], v[40:43], v[80:87], v19
    ds_read_b128 v[32:35], v17 offset:4096
    v_exp_f32 v102, v102
    v_exp_f32 v103, v103
    v_exp_f32 v104, v104
    v_smfmac_f32_16x16x64_bf16 v[236:239], v[20:23], v[80:87], v19
    ds_read_b128 v[36:39], v17 offset:5120
    v_exp_f32 v105, v105
    v_smfmac_f32_32x32x32_bf16 v[176:191], v[44:47], v[88:95], v19
    v_exp_f32 v106, v106
    v_exp_f32 v107, v107
    v_exp_f32 v108, v108
    v_smfmac_f32_16x16x64_bf16 v[236:239], v[20:23], v[88:95], v19
    v_exp_f32 v109, v109
    v_exp_f32 v110, v110
    v_exp_f32 v111, v111
    s_waitcnt lgkmcnt(0)
    v_mfma_f32_32x32x16_bf16 v[64:79], v[32:35], v[216:219], 0
    v_exp_f32 v112, v112
    v_exp_f32 v113, v113
    v_exp_f32 v114, v114
    v_mfma_f32_32x32x16_bf16 v[64:79], v[36:39], v[220:223], v[64:79]
    v_exp_f32 v115, v115
    v_exp_f32 v116, v116
    v_exp_f32 v117, v117
    v_smfmac_f32_32x32x32_bf16 v[128:143], v[40:43], v[96:103], v19
    v_exp_f32 v118, v118
    v_exp_f32 v119, v119
    v_exp_f32 v120, v120
    v_smfmac_f32_16x16x64_bf16 v[192:195], v[20:23], v[96:103], v19
    v_exp_f32 v121, v121
    v_smfmac_f32_32x32x32_bf16 v[128:143], v[44:47], v[104:111], v19
    v_exp_f32 v122, v122
    v_exp_f32 v123, v123
    v_exp_f32 v124, v124
    v_smfmac_f32_16x16x64_bf16 v[192:195], v[20:23], v[104:111], v19
    v_exp_f32 v125, v125
    v_exp_f32 v126, v126
    v_exp_f32 v127, v127
    v_mfma_f32_32x32x16_bf16 v[80:95], v[32:35], v[224:227], 0
    v_exp_f32 v64, v64
    v_exp_f32 v65, v65
    v_exp_f32 v66, v66
    v_mfma_f32_32x32x16_bf16 v[80:95], v[36:39], v[228:231], v[80:95]
    v_exp_f32 v67, v67
    v_exp_f32 v68, v68
    v_exp_f32 v69, v69
    v_smfmac_f32_32x32x32_bf16 v[144:159], v[40:43], v[112:119], v19
    v_exp_f32 v70, v70
    v_exp_f32 v71, v71
    v_exp_f32 v72, v72
    v_smfmac_f32_16x16x64_bf16 v[196:199], v[20:23], v[112:119], v19
    v_exp_f32 v73, v73
    v_smfmac_f32_32x32x32_bf16 v[144:159], v[44:47], v[120:127], v19
    v_exp_f32 v74, v74
    v_exp_f32 v75, v75
    v_exp_f32 v76, v76
    v_smfmac_f32_16x16x64_bf16 v[196:199], v[20:23], v[120:127], v19
    v_exp_f32 v77, v77
    v_exp_f32 v78, v78
    v_exp_f32 v79, v79
    v_mfma_f32_32x32x16_bf16 v[96:111], v[32:35], v[200:203], 0
    v_exp_f32 v80, v80
    v_exp_f32 v81, v81
    v_exp_f32 v82, v82
    v_mfma_f32_32x32x16_bf16 v[96:111], v[36:39], v[204:207], v[96:111]
    v_exp_f32 v83, v83
    v_exp_f32 v84, v84
    v_exp_f32 v85, v85
    v_smfmac_f32_32x32x32_bf16 v[160:175], v[48:51], v[64:71], v19
    v_exp_f32 v86, v86
    v_exp_f32 v87, v87
    v_exp_f32 v88, v88
    v_smfmac_f32_16x16x64_bf16 v[232:235], v[20:23], v[64:71], v19
    v_exp_f32 v89, v89
    v_smfmac_f32_32x32x32_bf16 v[160:175], v[52:55], v[72:79], v19
    v_exp_f32 v90, v90
    v_exp_f32 v91, v91
    v_exp_f32 v92, v92
    v_smfmac_f32_16x16x64_bf16 v[232:235], v[20:23], v[72:79], v19
    v_exp_f32 v93, v93
    v_exp_f32 v94, v94
    v_exp_f32 v95, v95
    v_mfma_f32_32x32x16_bf16 v[112:127], v[32:35], v[208:211], 0
    s_barrier
    ds_read_b128 v[40:43], v10 offset:2048
    v_exp_f32 v96, v96
    v_exp_f32 v97, v97
    v_exp_f32 v98, v98
    v_mfma_f32_32x32x16_bf16 v[112:127], v[36:39], v[212:215], v[112:127]
    ds_read_b128 v[44:47], v10 offset:3072
    v_exp_f32 v99, v99
    v_exp_f32 v100, v100
    v_exp_f32 v101, v101
    v_smfmac_f32_32x32x32_bf16 v[176:191], v[48:51], v[80:87], v19
    ds_read_b128 v[24:27], v10 offset:0
    v_exp_f32 v102, v102
    v_exp_f32 v103, v103
    v_exp_f32 v104, v104
    v_smfmac_f32_16x16x64_bf16 v[236:239], v[20:23], v[80:87], v19
    ds_read_b128 v[28:31], v10 offset:1024
    v_exp_f32 v105, v105
    v_smfmac_f32_32x32x32_bf16 v[176:191], v[52:55], v[88:95], v19
    v_exp_f32 v106, v106
    v_exp_f32 v107, v107
    v_exp_f32 v108, v108
    v_smfmac_f32_16x16x64_bf16 v[236:239], v[20:23], v[88:95], v19
    v_exp_f32 v109, v109
    v_exp_f32 v110, v110
    v_exp_f32 v111, v111
    s_waitcnt lgkmcnt(0)
    v_mfma_f32_32x32x16_bf16 v[64:79], v[24:27], v[216:219], 0
    v_exp_f32 v112, v112
    v_exp_f32 v113, v113
    v_exp_f32 v114, v114
    v_mfma_f32_32x32x16_bf16 v[64:79], v[28:31], v[220:223], v[64:79]
    v_exp_f32 v115, v115
    v_exp_f32 v116, v116
    v_exp_f32 v117, v117
    v_smfmac_f32_32x32x32_bf16 v[128:143], v[48:51], v[96:103], v19
    v_exp_f32 v118, v118
    v_exp_f32 v119, v119
    v_exp_f32 v120, v120
    v_smfmac_f32_16x16x64_bf16 v[192:195], v[20:23], v[96:103], v19
    v_exp_f32 v121, v121
    v_smfmac_f32_32x32x32_bf16 v[128:143], v[52:55], v[104:111], v19
    v_exp_f32 v122, v122
    v_exp_f32 v123, v123
    v_exp_f32 v124, v124
    v_smfmac_f32_16x16x64_bf16 v[192:195], v[20:23], v[104:111], v19
    v_exp_f32 v125, v125
    v_exp_f32 v126, v126
    v_exp_f32 v127, v127
    v_mfma_f32_32x32x16_bf16 v[80:95], v[24:27], v[224:227], 0
    v_exp_f32 v64, v64
    v_exp_f32 v65, v65
    v_exp_f32 v66, v66
    v_mfma_f32_32x32x16_bf16 v[80:95], v[28:31], v[228:231], v[80:95]
    v_exp_f32 v67, v67
    v_exp_f32 v68, v68
    v_exp_f32 v69, v69
    v_smfmac_f32_32x32x32_bf16 v[144:159], v[48:51], v[112:119], v19
    v_exp_f32 v70, v70
    v_exp_f32 v71, v71
    v_exp_f32 v72, v72
    v_smfmac_f32_16x16x64_bf16 v[196:199], v[20:23], v[112:119], v19
    v_exp_f32 v73, v73
    v_smfmac_f32_32x32x32_bf16 v[144:159], v[52:55], v[120:127], v19
    v_exp_f32 v74, v74
    v_exp_f32 v75, v75
    v_exp_f32 v76, v76
    v_smfmac_f32_16x16x64_bf16 v[196:199], v[20:23], v[120:127], v19
    v_exp_f32 v77, v77
    v_exp_f32 v78, v78
    v_exp_f32 v79, v79
    v_mfma_f32_32x32x16_bf16 v[96:111], v[24:27], v[200:203], 0
    v_exp_f32 v80, v80
    v_exp_f32 v81, v81
    v_exp_f32 v82, v82
    v_mfma_f32_32x32x16_bf16 v[96:111], v[28:31], v[204:207], v[96:111]
    v_exp_f32 v83, v83
    v_exp_f32 v84, v84
    v_exp_f32 v85, v85
    v_smfmac_f32_32x32x32_bf16 v[160:175], v[40:43], v[64:71], v19
    v_exp_f32 v86, v86
    v_exp_f32 v87, v87
    v_exp_f32 v88, v88
    v_smfmac_f32_16x16x64_bf16 v[232:235], v[20:23], v[64:71], v19
    v_exp_f32 v89, v89
    v_smfmac_f32_32x32x32_bf16 v[160:175], v[44:47], v[72:79], v19
    v_exp_f32 v90, v90
    v_exp_f32 v91, v91
    v_exp_f32 v92, v92
    v_smfmac_f32_16x16x64_bf16 v[232:235], v[20:23], v[72:79], v19
    v_exp_f32 v93, v93
    v_exp_f32 v94, v94
    v_exp_f32 v95, v95
    v_mfma_f32_32x32x16_bf16 v[112:127], v[24:27], v[208:211], 0
    ds_read_b128 v[48:51], v10 offset:6144
    v_exp_f32 v96, v96
    v_exp_f32 v97, v97
    v_exp_f32 v98, v98
    v_mfma_f32_32x32x16_bf16 v[112:127], v[28:31], v[212:215], v[112:127]
    ds_read_b128 v[52:55], v10 offset:7168
    v_exp_f32 v99, v99
    v_exp_f32 v100, v100
    v_exp_f32 v101, v101
    v_smfmac_f32_32x32x32_bf16 v[176:191], v[40:43], v[80:87], v19
    ds_read_b128 v[32:35], v10 offset:4096
    v_exp_f32 v102, v102
    v_exp_f32 v103, v103
    v_exp_f32 v104, v104
    v_smfmac_f32_16x16x64_bf16 v[236:239], v[20:23], v[80:87], v19
    ds_read_b128 v[36:39], v10 offset:5120
    v_exp_f32 v105, v105
    v_smfmac_f32_32x32x32_bf16 v[176:191], v[44:47], v[88:95], v19
    v_exp_f32 v106, v106
    v_exp_f32 v107, v107
    v_exp_f32 v108, v108
    v_smfmac_f32_16x16x64_bf16 v[236:239], v[20:23], v[88:95], v19
    v_exp_f32 v109, v109
    v_exp_f32 v110, v110
    v_exp_f32 v111, v111
    s_waitcnt lgkmcnt(0)
    v_mfma_f32_32x32x16_bf16 v[64:79], v[32:35], v[216:219], 0
    v_exp_f32 v112, v112
    v_exp_f32 v113, v113
    v_exp_f32 v114, v114
    v_mfma_f32_32x32x16_bf16 v[64:79], v[36:39], v[220:223], v[64:79]
    v_exp_f32 v115, v115
    v_exp_f32 v116, v116
    v_exp_f32 v117, v117
    v_smfmac_f32_32x32x32_bf16 v[128:143], v[40:43], v[96:103], v19
    v_exp_f32 v118, v118
    v_exp_f32 v119, v119
    v_exp_f32 v120, v120
    v_smfmac_f32_16x16x64_bf16 v[192:195], v[20:23], v[96:103], v19
    v_exp_f32 v121, v121
    v_smfmac_f32_32x32x32_bf16 v[128:143], v[44:47], v[104:111], v19
    v_exp_f32 v122, v122
    v_exp_f32 v123, v123
    v_exp_f32 v124, v124
    v_smfmac_f32_16x16x64_bf16 v[192:195], v[20:23], v[104:111], v19
    v_exp_f32 v125, v125
    v_exp_f32 v126, v126
    v_exp_f32 v127, v127
    v_mfma_f32_32x32x16_bf16 v[80:95], v[32:35], v[224:227], 0
    v_exp_f32 v64, v64
    v_exp_f32 v65, v65
    v_exp_f32 v66, v66
    v_mfma_f32_32x32x16_bf16 v[80:95], v[36:39], v[228:231], v[80:95]
    v_exp_f32 v67, v67
    v_exp_f32 v68, v68
    v_exp_f32 v69, v69
    v_smfmac_f32_32x32x32_bf16 v[144:159], v[40:43], v[112:119], v19
    v_exp_f32 v70, v70
    v_exp_f32 v71, v71
    v_exp_f32 v72, v72
    v_smfmac_f32_16x16x64_bf16 v[196:199], v[20:23], v[112:119], v19
    v_exp_f32 v73, v73
    v_smfmac_f32_32x32x32_bf16 v[144:159], v[44:47], v[120:127], v19
    v_exp_f32 v74, v74
    v_exp_f32 v75, v75
    v_exp_f32 v76, v76
    v_smfmac_f32_16x16x64_bf16 v[196:199], v[20:23], v[120:127], v19
    v_exp_f32 v77, v77
    v_exp_f32 v78, v78
    v_exp_f32 v79, v79
    v_mfma_f32_32x32x16_bf16 v[96:111], v[32:35], v[200:203], 0
    v_exp_f32 v80, v80
    v_exp_f32 v81, v81
    v_exp_f32 v82, v82
    v_mfma_f32_32x32x16_bf16 v[96:111], v[36:39], v[204:207], v[96:111]
    v_exp_f32 v83, v83
    v_exp_f32 v84, v84
    v_exp_f32 v85, v85
    v_smfmac_f32_32x32x32_bf16 v[160:175], v[48:51], v[64:71], v19
    v_exp_f32 v86, v86
    v_exp_f32 v87, v87
    v_exp_f32 v88, v88
    v_smfmac_f32_16x16x64_bf16 v[232:235], v[20:23], v[64:71], v19
    v_exp_f32 v89, v89
    v_smfmac_f32_32x32x32_bf16 v[160:175], v[52:55], v[72:79], v19
    v_exp_f32 v90, v90
    v_exp_f32 v91, v91
    v_exp_f32 v92, v92
    v_smfmac_f32_16x16x64_bf16 v[232:235], v[20:23], v[72:79], v19
    v_exp_f32 v93, v93
    v_exp_f32 v94, v94
    v_exp_f32 v95, v95
    v_mfma_f32_32x32x16_bf16 v[112:127], v[32:35], v[208:211], 0
    s_barrier
    ds_read_b128 v[40:43], v10 offset:34816
    v_exp_f32 v96, v96
    v_exp_f32 v97, v97
    v_exp_f32 v98, v98
    v_mfma_f32_32x32x16_bf16 v[112:127], v[36:39], v[212:215], v[112:127]
    ds_read_b128 v[44:47], v10 offset:35840
    v_exp_f32 v99, v99
    v_exp_f32 v100, v100
    v_exp_f32 v101, v101
    v_smfmac_f32_32x32x32_bf16 v[176:191], v[48:51], v[80:87], v19
    ds_read_b128 v[24:27], v10 offset:32768
    v_exp_f32 v102, v102
    v_exp_f32 v103, v103
    v_exp_f32 v104, v104
    v_smfmac_f32_16x16x64_bf16 v[236:239], v[20:23], v[80:87], v19
    ds_read_b128 v[28:31], v10 offset:33792
    v_exp_f32 v105, v105
    v_smfmac_f32_32x32x32_bf16 v[176:191], v[52:55], v[88:95], v19
    v_exp_f32 v106, v106
    v_exp_f32 v107, v107
    v_exp_f32 v108, v108
    v_smfmac_f32_16x16x64_bf16 v[236:239], v[20:23], v[88:95], v19
    v_exp_f32 v109, v109
    v_exp_f32 v110, v110
    v_exp_f32 v111, v111
    s_waitcnt lgkmcnt(0)
    v_mfma_f32_32x32x16_bf16 v[64:79], v[24:27], v[216:219], 0
    v_exp_f32 v112, v112
    v_exp_f32 v113, v113
    v_exp_f32 v114, v114
    v_mfma_f32_32x32x16_bf16 v[64:79], v[28:31], v[220:223], v[64:79]
    v_exp_f32 v115, v115
    v_exp_f32 v116, v116
    v_exp_f32 v117, v117
    v_smfmac_f32_32x32x32_bf16 v[128:143], v[48:51], v[96:103], v19
    v_exp_f32 v118, v118
    v_exp_f32 v119, v119
    v_exp_f32 v120, v120
    v_smfmac_f32_16x16x64_bf16 v[192:195], v[20:23], v[96:103], v19
    v_exp_f32 v121, v121
    v_smfmac_f32_32x32x32_bf16 v[128:143], v[52:55], v[104:111], v19
    v_exp_f32 v122, v122
    v_exp_f32 v123, v123
    v_exp_f32 v124, v124
    v_smfmac_f32_16x16x64_bf16 v[192:195], v[20:23], v[104:111], v19
    v_exp_f32 v125, v125
    v_exp_f32 v126, v126
    v_exp_f32 v127, v127
    v_mfma_f32_32x32x16_bf16 v[80:95], v[24:27], v[224:227], 0
    v_exp_f32 v64, v64
    v_exp_f32 v65, v65
    v_exp_f32 v66, v66
    v_mfma_f32_32x32x16_bf16 v[80:95], v[28:31], v[228:231], v[80:95]
    v_exp_f32 v67, v67
    v_exp_f32 v68, v68
    v_exp_f32 v69, v69
    v_smfmac_f32_32x32x32_bf16 v[144:159], v[48:51], v[112:119], v19
    v_exp_f32 v70, v70
    v_exp_f32 v71, v71
    v_exp_f32 v72, v72
    v_smfmac_f32_16x16x64_bf16 v[196:199], v[20:23], v[112:119], v19
    v_exp_f32 v73, v73
    v_smfmac_f32_32x32x32_bf16 v[144:159], v[52:55], v[120:127], v19
    v_exp_f32 v74, v74
    v_exp_f32 v75, v75
    v_exp_f32 v76, v76
    v_smfmac_f32_16x16x64_bf16 v[196:199], v[20:23], v[120:127], v19
    v_exp_f32 v77, v77
    v_exp_f32 v78, v78
    v_exp_f32 v79, v79
    v_mfma_f32_32x32x16_bf16 v[96:111], v[24:27], v[200:203], 0
    v_exp_f32 v80, v80
    v_exp_f32 v81, v81
    v_exp_f32 v82, v82
    v_mfma_f32_32x32x16_bf16 v[96:111], v[28:31], v[204:207], v[96:111]
    v_exp_f32 v83, v83
    v_exp_f32 v84, v84
    v_exp_f32 v85, v85
    v_smfmac_f32_32x32x32_bf16 v[160:175], v[40:43], v[64:71], v19
    v_exp_f32 v86, v86
    v_exp_f32 v87, v87
    v_exp_f32 v88, v88
    v_smfmac_f32_16x16x64_bf16 v[232:235], v[20:23], v[64:71], v19
    v_exp_f32 v89, v89
    v_smfmac_f32_32x32x32_bf16 v[160:175], v[44:47], v[72:79], v19
    v_exp_f32 v90, v90
    v_exp_f32 v91, v91
    v_exp_f32 v92, v92
    v_smfmac_f32_16x16x64_bf16 v[232:235], v[20:23], v[72:79], v19
    v_exp_f32 v93, v93
    v_exp_f32 v94, v94
    v_exp_f32 v95, v95
    v_mfma_f32_32x32x16_bf16 v[112:127], v[24:27], v[208:211], 0
    ds_read_b128 v[48:51], v10 offset:38912
    v_exp_f32 v96, v96
    v_exp_f32 v97, v97
    v_exp_f32 v98, v98
    v_mfma_f32_32x32x16_bf16 v[112:127], v[28:31], v[212:215], v[112:127]
    ds_read_b128 v[52:55], v10 offset:39936
    v_exp_f32 v99, v99
    v_exp_f32 v100, v100
    v_exp_f32 v101, v101
    v_smfmac_f32_32x32x32_bf16 v[176:191], v[40:43], v[80:87], v19
    ds_read_b128 v[32:35], v10 offset:36864
    v_exp_f32 v102, v102
    v_exp_f32 v103, v103
    v_exp_f32 v104, v104
    v_smfmac_f32_16x16x64_bf16 v[236:239], v[20:23], v[80:87], v19
    ds_read_b128 v[36:39], v10 offset:37888
    v_exp_f32 v105, v105
    v_smfmac_f32_32x32x32_bf16 v[176:191], v[44:47], v[88:95], v19
    v_exp_f32 v106, v106
    v_exp_f32 v107, v107
    v_exp_f32 v108, v108
    v_smfmac_f32_16x16x64_bf16 v[236:239], v[20:23], v[88:95], v19
    v_exp_f32 v109, v109
    v_exp_f32 v110, v110
    v_exp_f32 v111, v111
    s_waitcnt lgkmcnt(0)
    v_mfma_f32_32x32x16_bf16 v[64:79], v[32:35], v[216:219], 0
    v_exp_f32 v112, v112
    v_exp_f32 v113, v113
    v_exp_f32 v114, v114
    v_mfma_f32_32x32x16_bf16 v[64:79], v[36:39], v[220:223], v[64:79]
    v_exp_f32 v115, v115
    v_exp_f32 v116, v116
    v_exp_f32 v117, v117
    v_smfmac_f32_32x32x32_bf16 v[128:143], v[40:43], v[96:103], v19
    v_exp_f32 v118, v118
    v_exp_f32 v119, v119
    v_exp_f32 v120, v120
    v_smfmac_f32_16x16x64_bf16 v[192:195], v[20:23], v[96:103], v19
    v_exp_f32 v121, v121
    v_smfmac_f32_32x32x32_bf16 v[128:143], v[44:47], v[104:111], v19
    v_exp_f32 v122, v122
    v_exp_f32 v123, v123
    v_exp_f32 v124, v124
    v_smfmac_f32_16x16x64_bf16 v[192:195], v[20:23], v[104:111], v19
    v_exp_f32 v125, v125
    v_exp_f32 v126, v126
    v_exp_f32 v127, v127
    v_mfma_f32_32x32x16_bf16 v[80:95], v[32:35], v[224:227], 0
    v_exp_f32 v64, v64
    v_exp_f32 v65, v65
    v_exp_f32 v66, v66
    v_mfma_f32_32x32x16_bf16 v[80:95], v[36:39], v[228:231], v[80:95]
    v_exp_f32 v67, v67
    v_exp_f32 v68, v68
    v_exp_f32 v69, v69
    v_smfmac_f32_32x32x32_bf16 v[144:159], v[40:43], v[112:119], v19
    v_exp_f32 v70, v70
    v_exp_f32 v71, v71
    v_exp_f32 v72, v72
    v_smfmac_f32_16x16x64_bf16 v[196:199], v[20:23], v[112:119], v19
    v_exp_f32 v73, v73
    v_smfmac_f32_32x32x32_bf16 v[144:159], v[44:47], v[120:127], v19
    v_exp_f32 v74, v74
    v_exp_f32 v75, v75
    v_exp_f32 v76, v76
    v_smfmac_f32_16x16x64_bf16 v[196:199], v[20:23], v[120:127], v19
    v_exp_f32 v77, v77
    v_exp_f32 v78, v78
    v_exp_f32 v79, v79
    v_mfma_f32_32x32x16_bf16 v[96:111], v[32:35], v[200:203], 0
    s_sub_u32 s40, s40, 1
    v_exp_f32 v80, v80
    v_exp_f32 v81, v81
    v_exp_f32 v82, v82
    v_mfma_f32_32x32x16_bf16 v[96:111], v[36:39], v[204:207], v[96:111]
    s_cmp_eq_u32 s40, 0
    v_exp_f32 v83, v83
    v_exp_f32 v84, v84
    v_exp_f32 v85, v85
    v_smfmac_f32_32x32x32_bf16 v[160:175], v[48:51], v[64:71], v19
    v_exp_f32 v86, v86
    v_exp_f32 v87, v87
    v_exp_f32 v88, v88
    v_smfmac_f32_16x16x64_bf16 v[232:235], v[20:23], v[64:71], v19
    v_exp_f32 v89, v89
    v_smfmac_f32_32x32x32_bf16 v[160:175], v[52:55], v[72:79], v19
    v_exp_f32 v90, v90
    v_exp_f32 v91, v91
    v_exp_f32 v92, v92
    v_smfmac_f32_16x16x64_bf16 v[232:235], v[20:23], v[72:79], v19
    v_exp_f32 v93, v93
    v_exp_f32 v94, v94
    v_exp_f32 v95, v95
    v_mfma_f32_32x32x16_bf16 v[112:127], v[32:35], v[208:211], 0
    s_cbranch_scc1 L_nobar_67
    s_barrier
    ds_read_b128 v[40:43], v17 offset:2048
    v_exp_f32 v96, v96
    v_exp_f32 v97, v97
    v_exp_f32 v98, v98
    v_mfma_f32_32x32x16_bf16 v[112:127], v[36:39], v[212:215], v[112:127]
    ds_read_b128 v[44:47], v17 offset:3072
    v_exp_f32 v99, v99
    v_exp_f32 v100, v100
    v_exp_f32 v101, v101
    v_smfmac_f32_32x32x32_bf16 v[176:191], v[48:51], v[80:87], v19
    ds_read_b128 v[24:27], v17 offset:0
    v_exp_f32 v102, v102
    v_exp_f32 v103, v103
    v_smfmac_f32_16x16x64_bf16 v[236:239], v[20:23], v[80:87], v19
    ds_read_b128 v[28:31], v17 offset:1024
    v_exp_f32 v104, v104
    v_smfmac_f32_32x32x32_bf16 v[176:191], v[52:55], v[88:95], v19
    v_exp_f32 v105, v105
    v_exp_f32 v106, v106
    v_smfmac_f32_16x16x64_bf16 v[236:239], v[20:23], v[88:95], v19
    v_exp_f32 v107, v107
    s_nop 0
    v_exp_f32 v108, v108
    s_nop 0
    v_exp_f32 v109, v109
    s_nop 0
    v_exp_f32 v110, v110
    s_nop 0
    v_exp_f32 v111, v111
    s_waitcnt lgkmcnt(0)
    v_mfma_f32_32x32x16_bf16 v[64:79], v[24:27], v[216:219], 0
    v_exp_f32 v112, v112
    v_exp_f32 v113, v113
    v_exp_f32 v114, v114
    v_mfma_f32_32x32x16_bf16 v[64:79], v[28:31], v[220:223], v[64:79]
    v_exp_f32 v115, v115
    v_exp_f32 v116, v116
    v_exp_f32 v117, v117
    v_smfmac_f32_32x32x32_bf16 v[128:143], v[48:51], v[96:103], v19
    v_exp_f32 v118, v118
    v_exp_f32 v119, v119
    v_smfmac_f32_16x16x64_bf16 v[192:195], v[20:23], v[96:103], v19
    v_exp_f32 v120, v120
    v_smfmac_f32_32x32x32_bf16 v[128:143], v[52:55], v[104:111], v19
    v_exp_f32 v121, v121
    v_exp_f32 v122, v122
    v_smfmac_f32_16x16x64_bf16 v[192:195], v[20:23], v[104:111], v19
    v_exp_f32 v123, v123
    s_nop 0
    v_exp_f32 v124, v124
    s_nop 0
    v_exp_f32 v125, v125
    s_nop 0
    v_exp_f32 v126, v126
    s_nop 0
    v_exp_f32 v127, v127
L_bloop_71:
    v_mfma_f32_32x32x16_bf16 v[80:95], v[24:27], v[224:227], 0
    v_exp_f32 v64, v64
    v_exp_f32 v65, v65
    v_exp_f32 v66, v66
    v_mfma_f32_32x32x16_bf16 v[80:95], v[28:31], v[228:231], v[80:95]
    v_exp_f32 v67, v67
    v_exp_f32 v68, v68
    v_exp_f32 v69, v69
    v_smfmac_f32_32x32x32_bf16 v[144:159], v[48:51], v[112:119], v19
    v_exp_f32 v70, v70
    v_exp_f32 v71, v71
    v_smfmac_f32_16x16x64_bf16 v[196:199], v[20:23], v[112:119], v19
    v_exp_f32 v72, v72
    v_smfmac_f32_32x32x32_bf16 v[144:159], v[52:55], v[120:127], v19
    v_exp_f32 v73, v73
    v_exp_f32 v74, v74
    v_smfmac_f32_16x16x64_bf16 v[196:199], v[20:23], v[120:127], v19
    v_exp_f32 v75, v75
    s_nop 0
    v_exp_f32 v76, v76
    s_nop 0
    v_exp_f32 v77, v77
    s_nop 0
    v_exp_f32 v78, v78
    s_nop 0
    v_exp_f32 v79, v79
    v_mfma_f32_32x32x16_bf16 v[96:111], v[24:27], v[200:203], 0
    v_exp_f32 v80, v80
    v_exp_f32 v81, v81
    v_exp_f32 v82, v82
    v_mfma_f32_32x32x16_bf16 v[96:111], v[28:31], v[204:207], v[96:111]
    v_exp_f32 v83, v83
    v_exp_f32 v84, v84
    v_exp_f32 v85, v85
    v_smfmac_f32_32x32x32_bf16 v[160:175], v[40:43], v[64:71], v19
    v_exp_f32 v86, v86
    v_exp_f32 v87, v87
    v_smfmac_f32_16x16x64_bf16 v[232:235], v[20:23], v[64:71], v19
    v_exp_f32 v88, v88
    v_smfmac_f32_32x32x32_bf16 v[160:175], v[44:47], v[72:79], v19
    v_exp_f32 v89, v89
    v_exp_f32 v90, v90
    v_smfmac_f32_16x16x64_bf16 v[232:235], v[20:23], v[72:79], v19
    v_exp_f32 v91, v91
    s_nop 0
    v_exp_f32 v92, v92
    s_nop 0
    v_exp_f32 v93, v93
    s_nop 0
    v_exp_f32 v94, v94
    s_nop 0
    v_exp_f32 v95, v95
    v_mfma_f32_32x32x16_bf16 v[112:127], v[24:27], v[208:211], 0
    ds_read_b128 v[48:51], v17 offset:6144
    v_exp_f32 v96, v96
    v_exp_f32 v97, v97
    v_exp_f32 v98, v98
    v_mfma_f32_32x32x16_bf16 v[112:127], v[28:31], v[212:215], v[112:127]
    ds_read_b128 v[52:55], v17 offset:7168
    v_exp_f32 v99, v99
    v_exp_f32 v100, v100
    v_exp_f32 v101, v101
    v_smfmac_f32_32x32x32_bf16 v[176:191], v[40:43], v[80:87], v19
    ds_read_b128 v[32:35], v17 offset:4096
    v_exp_f32 v102, v102
    v_exp_f32 v103, v103
    v_smfmac_f32_16x16x64_bf16 v[236:239], v[20:23], v[80:87], v19
    ds_read_b128 v[36:39], v17 offset:5120
    v_exp_f32 v104, v104
    v_smfmac_f32_32x32x32_bf16 v[176:191], v[44:47], v[88:95], v19
    v_exp_f32 v105, v105
    v_exp_f32 v106, v106
    v_smfmac_f32_16x16x64_bf16 v[236:239], v[20:23], v[88:95], v19
    v_exp_f32 v107, v107
    s_nop 0
    v_exp_f32 v108, v108
    s_nop 0
    v_exp_f32 v109, v109
    s_nop 0
    v_exp_f32 v110, v110
    s_nop 0
    v_exp_f32 v111, v111
    s_waitcnt lgkmcnt(0)
    v_mfma_f32_32x32x16_bf16 v[64:79], v[32:35], v[216:219], 0
    v_exp_f32 v112, v112
    v_exp_f32 v113, v113
    v_exp_f32 v114, v114
    v_mfma_f32_32x32x16_bf16 v[64:79], v[36:39], v[220:223], v[64:79]
    v_exp_f32 v115, v115
    v_exp_f32 v116, v116
    v_exp_f32 v117, v117
    v_smfmac_f32_32x32x32_bf16 v[128:143], v[40:43], v[96:103], v19
    v_exp_f32 v118, v118
    v_exp_f32 v119, v119
    v_smfmac_f32_16x16x64_bf16 v[192:195], v[20:23], v[96:103], v19
    v_exp_f32 v120, v120
    v_smfmac_f32_32x32x32_bf16 v[128:143], v[44:47], v[104:111], v19
    v_exp_f32 v121, v121
    v_exp_f32 v122, v122
    v_smfmac_f32_16x16x64_bf16 v[192:195], v[20:23], v[104:111], v19
    v_exp_f32 v123, v123
    s_nop 0
    v_exp_f32 v124, v124
    s_nop 0
    v_exp_f32 v125, v125
    s_nop 0
    v_exp_f32 v126, v126
    s_nop 0
    v_exp_f32 v127, v127
    v_mfma_f32_32x32x16_bf16 v[80:95], v[32:35], v[224:227], 0
    v_exp_f32 v64, v64
    v_exp_f32 v65, v65
    v_exp_f32 v66, v66
    v_mfma_f32_32x32x16_bf16 v[80:95], v[36:39], v[228:231], v[80:95]
    v_exp_f32 v67, v67
    v_exp_f32 v68, v68
    v_exp_f32 v69, v69
    v_smfmac_f32_32x32x32_bf16 v[144:159], v[40:43], v[112:119], v19
    v_exp_f32 v70, v70
    v_exp_f32 v71, v71
    v_smfmac_f32_16x16x64_bf16 v[196:199], v[20:23], v[112:119], v19
    v_exp_f32 v72, v72
    v_smfmac_f32_32x32x32_bf16 v[144:159], v[44:47], v[120:127], v19
    v_exp_f32 v73, v73
    v_exp_f32 v74, v74
    v_smfmac_f32_16x16x64_bf16 v[196:199], v[20:23], v[120:127], v19
    v_exp_f32 v75, v75
    s_nop 0
    v_exp_f32 v76, v76
    s_nop 0
    v_exp_f32 v77, v77
    s_nop 0
    v_exp_f32 v78, v78
    s_nop 0
    v_exp_f32 v79, v79
    v_mfma_f32_32x32x16_bf16 v[96:111], v[32:35], v[200:203], 0
    v_exp_f32 v80, v80
    v_exp_f32 v81, v81
    v_exp_f32 v82, v82
    v_mfma_f32_32x32x16_bf16 v[96:111], v[36:39], v[204:207], v[96:111]
    v_exp_f32 v83, v83
    v_exp_f32 v84, v84
    v_exp_f32 v85, v85
    v_smfmac_f32_32x32x32_bf16 v[160:175], v[48:51], v[64:71], v19
    v_exp_f32 v86, v86
    v_exp_f32 v87, v87
    v_smfmac_f32_16x16x64_bf16 v[232:235], v[20:23], v[64:71], v19
    v_exp_f32 v88, v88
    v_smfmac_f32_32x32x32_bf16 v[160:175], v[52:55], v[72:79], v19
    v_exp_f32 v89, v89
    v_exp_f32 v90, v90
    v_smfmac_f32_16x16x64_bf16 v[232:235], v[20:23], v[72:79], v19
    v_exp_f32 v91, v91
    s_nop 0
    v_exp_f32 v92, v92
    s_nop 0
    v_exp_f32 v93, v93
    s_nop 0
    v_exp_f32 v94, v94
    s_nop 0
    v_exp_f32 v95, v95
    v_mfma_f32_32x32x16_bf16 v[112:127], v[32:35], v[208:211], 0
    s_barrier
    ds_read_b128 v[40:43], v10 offset:2048
    v_exp_f32 v96, v96
    v_exp_f32 v97, v97
    v_exp_f32 v98, v98
    v_mfma_f32_32x32x16_bf16 v[112:127], v[36:39], v[212:215], v[112:127]
    ds_read_b128 v[44:47], v10 offset:3072
    v_exp_f32 v99, v99
    v_exp_f32 v100, v100
    v_exp_f32 v101, v101
    v_smfmac_f32_32x32x32_bf16 v[176:191], v[48:51], v[80:87], v19
    ds_read_b128 v[24:27], v10 offset:0
    v_exp_f32 v102, v102
    v_exp_f32 v103, v103
    v_smfmac_f32_16x16x64_bf16 v[236:239], v[20:23], v[80:87], v19
    ds_read_b128 v[28:31], v10 offset:1024
    v_exp_f32 v104, v104
    v_smfmac_f32_32x32x32_bf16 v[176:191], v[52:55], v[88:95], v19
    v_exp_f32 v105, v105
    v_exp_f32 v106, v106
    v_smfmac_f32_16x16x64_bf16 v[236:239], v[20:23], v[88:95], v19
    v_exp_f32 v107, v107
    s_nop 0
    v_exp_f32 v108, v108
    s_nop 0
    v_exp_f32 v109, v109
    s_nop 0
    v_exp_f32 v110, v110
    s_nop 0
    v_exp_f32 v111, v111
    s_waitcnt lgkmcnt(0)
    v_mfma_f32_32x32x16_bf16 v[64:79], v[24:27], v[216:219], 0
    v_exp_f32 v112, v112
    v_exp_f32 v113, v113
    v_exp_f32 v114, v114
    v_mfma_f32_32x32x16_bf16 v[64:79], v[28:31], v[220:223], v[64:79]
    v_exp_f32 v115, v115
    v_exp_f32 v116, v116
    v_exp_f32 v117, v117
    v_smfmac_f32_32x32x32_bf16 v[128:143], v[48:51], v[96:103], v19
    v_exp_f32 v118, v118
    v_exp_f32 v119, v119
    v_smfmac_f32_16x16x64_bf16 v[192:195], v[20:23], v[96:103], v19
    v_exp_f32 v120, v120
    v_smfmac_f32_32x32x32_bf16 v[128:143], v[52:55], v[104:111], v19
    v_exp_f32 v121, v121
    v_exp_f32 v122, v122
    v_smfmac_f32_16x16x64_bf16 v[192:195], v[20:23], v[104:111], v19
    v_exp_f32 v123, v123
    s_nop 0
    v_exp_f32 v124, v124
    s_nop 0
    v_exp_f32 v125, v125
    s_nop 0
    v_exp_f32 v126, v126
    s_nop 0
    v_exp_f32 v127, v127
    v_mfma_f32_32x32x16_bf16 v[80:95], v[24:27], v[224:227], 0
    v_exp_f32 v64, v64
    v_exp_f32 v65, v65
    v_exp_f32 v66, v66
    v_mfma_f32_32x32x16_bf16 v[80:95], v[28:31], v[228:231], v[80:95]
    v_exp_f32 v67, v67
    v_exp_f32 v68, v68
    v_exp_f32 v69, v69
    v_smfmac_f32_32x32x32_bf16 v[144:159], v[48:51], v[112:119], v19
    v_exp_f32 v70, v70
    v_exp_f32 v71, v71
    v_smfmac_f32_16x16x64_bf16 v[196:199], v[20:23], v[112:119], v19
    v_exp_f32 v72, v72
    v_smfmac_f32_32x32x32_bf16 v[144:159], v[52:55], v[120:127], v19
    v_exp_f32 v73, v73
    v_exp_f32 v74, v74
    v_smfmac_f32_16x16x64_bf16 v[196:199], v[20:23], v[120:127], v19
    v_exp_f32 v75, v75
    s_nop 0
    v_exp_f32 v76, v76
    s_nop 0
    v_exp_f32 v77, v77
    s_nop 0
    v_exp_f32 v78, v78
    s_nop 0
    v_exp_f32 v79, v79
    v_mfma_f32_32x32x16_bf16 v[96:111], v[24:27], v[200:203], 0
    v_exp_f32 v80, v80
    v_exp_f32 v81, v81
    v_exp_f32 v82, v82
    v_mfma_f32_32x32x16_bf16 v[96:111], v[28:31], v[204:207], v[96:111]
    v_exp_f32 v83, v83
    v_exp_f32 v84, v84
    v_exp_f32 v85, v85
    v_smfmac_f32_32x32x32_bf16 v[160:175], v[40:43], v[64:71], v19
    v_exp_f32 v86, v86
    v_exp_f32 v87, v87
    v_smfmac_f32_16x16x64_bf16 v[232:235], v[20:23], v[64:71], v19
    v_exp_f32 v88, v88
    v_smfmac_f32_32x32x32_bf16 v[160:175], v[44:47], v[72:79], v19
    v_exp_f32 v89, v89
    v_exp_f32 v90, v90
    v_smfmac_f32_16x16x64_bf16 v[232:235], v[20:23], v[72:79], v19
    v_exp_f32 v91, v91
    s_nop 0
    v_exp_f32 v92, v92
    s_nop 0
    v_exp_f32 v93, v93
    s_nop 0
    v_exp_f32 v94, v94
    s_nop 0
    v_exp_f32 v95, v95
    v_mfma_f32_32x32x16_bf16 v[112:127], v[24:27], v[208:211], 0
    ds_read_b128 v[48:51], v10 offset:6144
    v_exp_f32 v96, v96
    v_exp_f32 v97, v97
    v_exp_f32 v98, v98
    v_mfma_f32_32x32x16_bf16 v[112:127], v[28:31], v[212:215], v[112:127]
    ds_read_b128 v[52:55], v10 offset:7168
    v_exp_f32 v99, v99
    v_exp_f32 v100, v100
    v_exp_f32 v101, v101
    v_smfmac_f32_32x32x32_bf16 v[176:191], v[40:43], v[80:87], v19
    ds_read_b128 v[32:35], v10 offset:4096
    v_exp_f32 v102, v102
    v_exp_f32 v103, v103
    v_smfmac_f32_16x16x64_bf16 v[236:239], v[20:23], v[80:87], v19
    ds_read_b128 v[36:39], v10 offset:5120
    v_exp_f32 v104, v104
    v_smfmac_f32_32x32x32_bf16 v[176:191], v[44:47], v[88:95], v19
    v_exp_f32 v105, v105
    v_exp_f32 v106, v106
    v_smfmac_f32_16x16x64_bf16 v[236:239], v[20:23], v[88:95], v19
    v_exp_f32 v107, v107
    s_nop 0
    v_exp_f32 v108, v108
    s_nop 0
    v_exp_f32 v109, v109
    s_nop 0
    v_exp_f32 v110, v110
    s_nop 0
    v_exp_f32 v111, v111
    s_waitcnt lgkmcnt(0)
    v_mfma_f32_32x32x16_bf16 v[64:79], v[32:35], v[216:219], 0
    v_exp_f32 v112, v112
    v_exp_f32 v113, v113
    v_exp_f32 v114, v114
    v_mfma_f32_32x32x16_bf16 v[64:79], v[36:39], v[220:223], v[64:79]
    v_exp_f32 v115, v115
    v_exp_f32 v116, v116
    v_exp_f32 v117, v117
    v_smfmac_f32_32x32x32_bf16 v[128:143], v[40:43], v[96:103], v19
    v_exp_f32 v118, v118
    v_exp_f32 v119, v119
    v_smfmac_f32_16x16x64_bf16 v[192:195], v[20:23], v[96:103], v19
    v_exp_f32 v120, v120
    v_smfmac_f32_32x32x32_bf16 v[128:143], v[44:47], v[104:111], v19
    v_exp_f32 v121, v121
    v_exp_f32 v122, v122
    v_smfmac_f32_16x16x64_bf16 v[192:195], v[20:23], v[104:111], v19
    v_exp_f32 v123, v123
    s_nop 0
    v_exp_f32 v124, v124
    s_nop 0
    v_exp_f32 v125, v125
    s_nop 0
    v_exp_f32 v126, v126
    s_nop 0
    v_exp_f32 v127, v127
    v_mfma_f32_32x32x16_bf16 v[80:95], v[32:35], v[224:227], 0
    v_exp_f32 v64, v64
    v_exp_f32 v65, v65
    v_exp_f32 v66, v66
    v_mfma_f32_32x32x16_bf16 v[80:95], v[36:39], v[228:231], v[80:95]
    v_exp_f32 v67, v67
    v_exp_f32 v68, v68
    v_exp_f32 v69, v69
    v_smfmac_f32_32x32x32_bf16 v[144:159], v[40:43], v[112:119], v19
    v_exp_f32 v70, v70
    v_exp_f32 v71, v71
    v_smfmac_f32_16x16x64_bf16 v[196:199], v[20:23], v[112:119], v19
    v_exp_f32 v72, v72
    v_smfmac_f32_32x32x32_bf16 v[144:159], v[44:47], v[120:127], v19
    v_exp_f32 v73, v73
    v_exp_f32 v74, v74
    v_smfmac_f32_16x16x64_bf16 v[196:199], v[20:23], v[120:127], v19
    v_exp_f32 v75, v75
    s_nop 0
    v_exp_f32 v76, v76
    s_nop 0
    v_exp_f32 v77, v77
    s_nop 0
    v_exp_f32 v78, v78
    s_nop 0
    v_exp_f32 v79, v79
    v_mfma_f32_32x32x16_bf16 v[96:111], v[32:35], v[200:203], 0
    v_exp_f32 v80, v80
    v_exp_f32 v81, v81
    v_exp_f32 v82, v82
    v_mfma_f32_32x32x16_bf16 v[96:111], v[36:39], v[204:207], v[96:111]
    v_exp_f32 v83, v83
    v_exp_f32 v84, v84
    v_exp_f32 v85, v85
    v_smfmac_f32_32x32x32_bf16 v[160:175], v[48:51], v[64:71], v19
    v_exp_f32 v86, v86
    v_exp_f32 v87, v87
    v_smfmac_f32_16x16x64_bf16 v[232:235], v[20:23], v[64:71], v19
    v_exp_f32 v88, v88
    v_smfmac_f32_32x32x32_bf16 v[160:175], v[52:55], v[72:79], v19
    v_exp_f32 v89, v89
    v_exp_f32 v90, v90
    v_smfmac_f32_16x16x64_bf16 v[232:235], v[20:23], v[72:79], v19
    v_exp_f32 v91, v91
    s_nop 0
    v_exp_f32 v92, v92
    s_nop 0
    v_exp_f32 v93, v93
    s_nop 0
    v_exp_f32 v94, v94
    s_nop 0
    v_exp_f32 v95, v95
    v_mfma_f32_32x32x16_bf16 v[112:127], v[32:35], v[208:211], 0
    s_barrier
    ds_read_b128 v[40:43], v10 offset:34816
    v_exp_f32 v96, v96
    v_exp_f32 v97, v97
    v_exp_f32 v98, v98
    v_mfma_f32_32x32x16_bf16 v[112:127], v[36:39], v[212:215], v[112:127]
    ds_read_b128 v[44:47], v10 offset:35840
    v_exp_f32 v99, v99
    v_exp_f32 v100, v100
    v_exp_f32 v101, v101
    v_smfmac_f32_32x32x32_bf16 v[176:191], v[48:51], v[80:87], v19
    ds_read_b128 v[24:27], v10 offset:32768
    v_exp_f32 v102, v102
    v_exp_f32 v103, v103
    v_smfmac_f32_16x16x64_bf16 v[236:239], v[20:23], v[80:87], v19
    ds_read_b128 v[28:31], v10 offset:33792
    v_exp_f32 v104, v104
    v_smfmac_f32_32x32x32_bf16 v[176:191], v[52:55], v[88:95], v19
    v_exp_f32 v105, v105
    v_exp_f32 v106, v106
    v_smfmac_f32_16x16x64_bf16 v[236:239], v[20:23], v[88:95], v19
    v_exp_f32 v107, v107
    s_nop 0
    v_exp_f32 v108, v108
    s_nop 0
    v_exp_f32 v109, v109
    s_nop 0
    v_exp_f32 v110, v110
    s_nop 0
    v_exp_f32 v111, v111
    s_waitcnt lgkmcnt(0)
    v_mfma_f32_32x32x16_bf16 v[64:79], v[24:27], v[216:219], 0
    v_exp_f32 v112, v112
    v_exp_f32 v113, v113
    v_exp_f32 v114, v114
    v_mfma_f32_32x32x16_bf16 v[64:79], v[28:31], v[220:223], v[64:79]
    v_exp_f32 v115, v115
    v_exp_f32 v116, v116
    v_exp_f32 v117, v117
    v_smfmac_f32_32x32x32_bf16 v[128:143], v[48:51], v[96:103], v19
    v_exp_f32 v118, v118
    v_exp_f32 v119, v119
    v_smfmac_f32_16x16x64_bf16 v[192:195], v[20:23], v[96:103], v19
    v_exp_f32 v120, v120
    v_smfmac_f32_32x32x32_bf16 v[128:143], v[52:55], v[104:111], v19
    v_exp_f32 v121, v121
    v_exp_f32 v122, v122
    v_smfmac_f32_16x16x64_bf16 v[192:195], v[20:23], v[104:111], v19
    v_exp_f32 v123, v123
    s_nop 0
    v_exp_f32 v124, v124
    s_nop 0
    v_exp_f32 v125, v125
    s_nop 0
    v_exp_f32 v126, v126
    s_nop 0
    v_exp_f32 v127, v127
    v_mfma_f32_32x32x16_bf16 v[80:95], v[24:27], v[224:227], 0
    v_exp_f32 v64, v64
    v_exp_f32 v65, v65
    v_exp_f32 v66, v66
    v_mfma_f32_32x32x16_bf16 v[80:95], v[28:31], v[228:231], v[80:95]
    v_exp_f32 v67, v67
    v_exp_f32 v68, v68
    v_exp_f32 v69, v69
    v_smfmac_f32_32x32x32_bf16 v[144:159], v[48:51], v[112:119], v19
    v_exp_f32 v70, v70
    v_exp_f32 v71, v71
    v_smfmac_f32_16x16x64_bf16 v[196:199], v[20:23], v[112:119], v19
    v_exp_f32 v72, v72
    v_smfmac_f32_32x32x32_bf16 v[144:159], v[52:55], v[120:127], v19
    v_exp_f32 v73, v73
    v_exp_f32 v74, v74
    v_smfmac_f32_16x16x64_bf16 v[196:199], v[20:23], v[120:127], v19
    v_exp_f32 v75, v75
    s_nop 0
    v_exp_f32 v76, v76
    s_nop 0
    v_exp_f32 v77, v77
    s_nop 0
    v_exp_f32 v78, v78
    s_nop 0
    v_exp_f32 v79, v79
    v_mfma_f32_32x32x16_bf16 v[96:111], v[24:27], v[200:203], 0
    v_exp_f32 v80, v80
    v_exp_f32 v81, v81
    v_exp_f32 v82, v82
    v_mfma_f32_32x32x16_bf16 v[96:111], v[28:31], v[204:207], v[96:111]
    v_exp_f32 v83, v83
    v_exp_f32 v84, v84
    v_exp_f32 v85, v85
    v_smfmac_f32_32x32x32_bf16 v[160:175], v[40:43], v[64:71], v19
    v_exp_f32 v86, v86
    v_exp_f32 v87, v87
    v_smfmac_f32_16x16x64_bf16 v[232:235], v[20:23], v[64:71], v19
    v_exp_f32 v88, v88
    v_smfmac_f32_32x32x32_bf16 v[160:175], v[44:47], v[72:79], v19
    v_exp_f32 v89, v89
    v_exp_f32 v90, v90
    v_smfmac_f32_16x16x64_bf16 v[232:235], v[20:23], v[72:79], v19
    v_exp_f32 v91, v91
    s_nop 0
    v_exp_f32 v92, v92
    s_nop 0
    v_exp_f32 v93, v93
    s_nop 0
    v_exp_f32 v94, v94
    s_nop 0
    v_exp_f32 v95, v95
    v_mfma_f32_32x32x16_bf16 v[112:127], v[24:27], v[208:211], 0
    ds_read_b128 v[48:51], v10 offset:38912
    v_exp_f32 v96, v96
    v_exp_f32 v97, v97
    v_exp_f32 v98, v98
    v_mfma_f32_32x32x16_bf16 v[112:127], v[28:31], v[212:215], v[112:127]
    ds_read_b128 v[52:55], v10 offset:39936
    v_exp_f32 v99, v99
    v_exp_f32 v100, v100
    v_exp_f32 v101, v101
    v_smfmac_f32_32x32x32_bf16 v[176:191], v[40:43], v[80:87], v19
    ds_read_b128 v[32:35], v10 offset:36864
    v_exp_f32 v102, v102
    v_exp_f32 v103, v103
    v_smfmac_f32_16x16x64_bf16 v[236:239], v[20:23], v[80:87], v19
    ds_read_b128 v[36:39], v10 offset:37888
    v_exp_f32 v104, v104
    v_smfmac_f32_32x32x32_bf16 v[176:191], v[44:47], v[88:95], v19
    v_exp_f32 v105, v105
    v_exp_f32 v106, v106
    v_smfmac_f32_16x16x64_bf16 v[236:239], v[20:23], v[88:95], v19
    v_exp_f32 v107, v107
    s_nop 0
    v_exp_f32 v108, v108
    s_nop 0
    v_exp_f32 v109, v109
    s_nop 0
    v_exp_f32 v110, v110
    s_nop 0
    v_exp_f32 v111, v111
    s_waitcnt lgkmcnt(0)
    v_mfma_f32_32x32x16_bf16 v[64:79], v[32:35], v[216:219], 0
    v_exp_f32 v112, v112
    v_exp_f32 v113, v113
    v_exp_f32 v114, v114
    v_mfma_f32_32x32x16_bf16 v[64:79], v[36:39], v[220:223], v[64:79]
    v_exp_f32 v115, v115
    v_exp_f32 v116, v116
    v_exp_f32 v117, v117
    v_smfmac_f32_32x32x32_bf16 v[128:143], v[40:43], v[96:103], v19
    v_exp_f32 v118, v118
    v_exp_f32 v119, v119
    v_smfmac_f32_16x16x64_bf16 v[192:195], v[20:23], v[96:103], v19
    v_exp_f32 v120, v120
    v_smfmac_f32_32x32x32_bf16 v[128:143], v[44:47], v[104:111], v19
    v_exp_f32 v121, v121
    v_exp_f32 v122, v122
    v_smfmac_f32_16x16x64_bf16 v[192:195], v[20:23], v[104:111], v19
    v_exp_f32 v123, v123
    s_nop 0
    v_exp_f32 v124, v124
    s_nop 0
    v_exp_f32 v125, v125
    s_nop 0
    v_exp_f32 v126, v126
    s_nop 0
    v_exp_f32 v127, v127
    v_mfma_f32_32x32x16_bf16 v[80:95], v[32:35], v[224:227], 0
    v_exp_f32 v64, v64
    v_exp_f32 v65, v65
    v_exp_f32 v66, v66
    v_mfma_f32_32x32x16_bf16 v[80:95], v[36:39], v[228:231], v[80:95]
    v_exp_f32 v67, v67
    v_exp_f32 v68, v68
    v_exp_f32 v69, v69
    v_smfmac_f32_32x32x32_bf16 v[144:159], v[40:43], v[112:119], v19
    v_exp_f32 v70, v70
    v_exp_f32 v71, v71
    v_smfmac_f32_16x16x64_bf16 v[196:199], v[20:23], v[112:119], v19
    v_exp_f32 v72, v72
    v_smfmac_f32_32x32x32_bf16 v[144:159], v[44:47], v[120:127], v19
    v_exp_f32 v73, v73
    v_exp_f32 v74, v74
    v_smfmac_f32_16x16x64_bf16 v[196:199], v[20:23], v[120:127], v19
    v_exp_f32 v75, v75
    s_nop 0
    v_exp_f32 v76, v76
    s_nop 0
    v_exp_f32 v77, v77
    s_nop 0
    v_exp_f32 v78, v78
    s_nop 0
    v_exp_f32 v79, v79
    v_mfma_f32_32x32x16_bf16 v[96:111], v[32:35], v[200:203], 0
    v_exp_f32 v80, v80
    v_exp_f32 v81, v81
    v_exp_f32 v82, v82
    v_mfma_f32_32x32x16_bf16 v[96:111], v[36:39], v[204:207], v[96:111]
    v_exp_f32 v83, v83
    v_exp_f32 v84, v84
    v_exp_f32 v85, v85
    v_smfmac_f32_32x32x32_bf16 v[160:175], v[48:51], v[64:71], v19
    v_exp_f32 v86, v86
    v_exp_f32 v87, v87
    v_smfmac_f32_16x16x64_bf16 v[232:235], v[20:23], v[64:71], v19
    v_exp_f32 v88, v88
    v_smfmac_f32_32x32x32_bf16 v[160:175], v[52:55], v[72:79], v19
    v_exp_f32 v89, v89
    v_exp_f32 v90, v90
    v_smfmac_f32_16x16x64_bf16 v[232:235], v[20:23], v[72:79], v19
    v_exp_f32 v91, v91
    s_nop 0
    v_exp_f32 v92, v92
    s_nop 0
    v_exp_f32 v93, v93
    s_nop 0
    v_exp_f32 v94, v94
    s_nop 0
    v_exp_f32 v95, v95
    v_mfma_f32_32x32x16_bf16 v[112:127], v[32:35], v[208:211], 0
    s_barrier
    ds_read_b128 v[40:43], v17 offset:2048
    v_exp_f32 v96, v96
    v_exp_f32 v97, v97
    v_exp_f32 v98, v98
    v_mfma_f32_32x32x16_bf16 v[112:127], v[36:39], v[212:215], v[112:127]
    ds_read_b128 v[44:47], v17 offset:3072
    v_exp_f32 v99, v99
    v_exp_f32 v100, v100
    v_exp_f32 v101, v101
    v_smfmac_f32_32x32x32_bf16 v[176:191], v[48:51], v[80:87], v19
    ds_read_b128 v[24:27], v17 offset:0
    v_exp_f32 v102, v102
    v_exp_f32 v103, v103
    v_smfmac_f32_16x16x64_bf16 v[236:239], v[20:23], v[80:87], v19
    ds_read_b128 v[28:31], v17 offset:1024
    v_exp_f32 v104, v104
    v_smfmac_f32_32x32x32_bf16 v[176:191], v[52:55], v[88:95], v19
    v_exp_f32 v105, v105
    v_exp_f32 v106, v106
    v_smfmac_f32_16x16x64_bf16 v[236:239], v[20:23], v[88:95], v19
    v_exp_f32 v107, v107
    s_nop 0
    v_exp_f32 v108, v108
    s_nop 0
    v_exp_f32 v109, v109
    s_nop 0
    v_exp_f32 v110, v110
    s_nop 0
    v_exp_f32 v111, v111
    s_waitcnt lgkmcnt(0)
    v_mfma_f32_32x32x16_bf16 v[64:79], v[24:27], v[216:219], 0
    s_sub_u32 s41, s41, 1
    v_exp_f32 v112, v112
    v_exp_f32 v113, v113
    v_exp_f32 v114, v114
    v_mfma_f32_32x32x16_bf16 v[64:79], v[28:31], v[220:223], v[64:79]
    s_cmp_lg_u32 s41, 0
    v_exp_f32 v115, v115
    v_exp_f32 v116, v116
    v_exp_f32 v117, v117
    v_smfmac_f32_32x32x32_bf16 v[128:143], v[48:51], v[96:103], v19
    v_exp_f32 v118, v118
    v_exp_f32 v119, v119
    v_smfmac_f32_16x16x64_bf16 v[192:195], v[20:23], v[96:103], v19
    v_exp_f32 v120, v120
    v_smfmac_f32_32x32x32_bf16 v[128:143], v[52:55], v[104:111], v19
    v_exp_f32 v121, v121
    v_exp_f32 v122, v122
    v_smfmac_f32_16x16x64_bf16 v[192:195], v[20:23], v[104:111], v19
    v_exp_f32 v123, v123
    s_nop 0
    v_exp_f32 v124, v124
    s_nop 0
    v_exp_f32 v125, v125
    s_nop 0
    v_exp_f32 v126, v126
    s_nop 0
    v_exp_f32 v127, v127
    s_cbranch_scc1 L_bloop_71
    s_branch L_aloop_70
C_attend:
L_nobar_67:
    v_exp_f32 v96, v96
    v_exp_f32 v97, v97
    v_exp_f32 v98, v98
    v_mfma_f32_32x32x16_bf16 v[112:127], v[36:39], v[212:215], v[112:127]
    ds_write_b128 v10, v[160:163] offset:0
    v_exp_f32 v99, v99
    v_exp_f32 v100, v100
    v_exp_f32 v101, v101
    v_smfmac_f32_32x32x32_bf16 v[176:191], v[48:51], v[80:87], v19
    ds_write_b128 v10, v[164:167] offset:1024
    v_exp_f32 v102, v102
    v_exp_f32 v103, v103
    v_exp_f32 v104, v104
    v_smfmac_f32_16x16x64_bf16 v[236:239], v[20:23], v[80:87], v19
    ds_write_b128 v10, v[168:171] offset:2048
    v_exp_f32 v105, v105
    v_smfmac_f32_32x32x32_bf16 v[176:191], v[52:55], v[88:95], v19
    ds_write_b128 v10, v[172:175] offset:3072
    v_exp_f32 v106, v106
    v_exp_f32 v107, v107
    v_exp_f32 v108, v108
    v_smfmac_f32_16x16x64_bf16 v[236:239], v[20:23], v[88:95], v19
    ds_write_b32 v10, v232 offset:32768
    v_exp_f32 v109, v109
    v_exp_f32 v110, v110
    v_exp_f32 v111, v111
    v_exp_f32 v112, v112
    v_exp_f32 v113, v113
    v_exp_f32 v114, v114
    v_exp_f32 v115, v115
    v_exp_f32 v116, v116
    v_smfmac_f32_32x32x32_bf16 v[128:143], v[48:51], v[96:103], v19
    ds_write_b128 v10, v[176:179] offset:4096
    v_exp_f32 v117, v117
    v_exp_f32 v118, v118
    v_exp_f32 v119, v119
    v_smfmac_f32_16x16x64_bf16 v[192:195], v[20:23], v[96:103], v19
    ds_write_b128 v10, v[180:183] offset:5120
    v_exp_f32 v120, v120
    v_exp_f32 v121, v121
    v_smfmac_f32_32x32x32_bf16 v[128:143], v[52:55], v[104:111], v19
    ds_write_b128 v10, v[184:187] offset:6144
    v_exp_f32 v122, v122
    v_exp_f32 v123, v123
    v_exp_f32 v124, v124
    v_smfmac_f32_16x16x64_bf16 v[192:195], v[20:23], v[104:111], v19
    ds_write_b128 v10, v[188:191] offset:7168
    ds_write_b32 v10, v236 offset:32772
    v_exp_f32 v125, v125
    v_exp_f32 v126, v126
    v_exp_f32 v127, v127
    s_nop 1
    v_smfmac_f32_32x32x32_bf16 v[144:159], v[48:51], v[112:119], v19
    v_smfmac_f32_16x16x64_bf16 v[196:199], v[20:23], v[112:119], v19
    v_smfmac_f32_32x32x32_bf16 v[144:159], v[52:55], v[120:127], v19
    v_smfmac_f32_16x16x64_bf16 v[196:199], v[20:23], v[120:127], v19
    ds_read_b32 v13, v12 offset:128
    ds_read_b32 v12, v12
    s_waitcnt lgkmcnt(0)
    s_barrier
    ds_read_b64 v[14:15], v18 offset:32768
    ds_read_b128 v[64:67], v18 offset:0
    ds_read_b128 v[68:71], v18 offset:1024
    ds_read_b128 v[72:75], v18 offset:2048
    ds_read_b128 v[76:79], v18 offset:3072
    ds_read_b128 v[80:83], v18 offset:4096
    ds_read_b128 v[84:87], v18 offset:5120
    ds_read_b128 v[88:91], v18 offset:6144
    ds_read_b128 v[92:95], v18 offset:7168
    buffer_load_dwordx4 v[240:243], v9, s[4:7], s30 offen offset:0 sc1
    buffer_load_dwordx4 v[244:247], v9, s[4:7], s31 offen offset:0 sc1
    buffer_load_dwordx4 v[248:251], v9, s[4:7], s30 offen offset:1024 sc1
    buffer_load_dwordx4 v[252:255], v9, s[4:7], s31 offen offset:1024 sc1
    s_waitcnt lgkmcnt(8)
    v_add_f32 v192, v192, v14
    v_add_f32 v196, v196, v15
    s_waitcnt lgkmcnt(7)
    v_pk_add_f32 v[128:129], v[128:129], v[64:65]
    v_pk_add_f32 v[130:131], v[130:131], v[66:67]
    s_waitcnt lgkmcnt(6)
    v_pk_add_f32 v[132:133], v[132:133], v[68:69]
    v_pk_add_f32 v[134:135], v[134:135], v[70:71]
    s_waitcnt lgkmcnt(5)
    v_pk_add_f32 v[136:137], v[136:137], v[72:73]
    v_pk_add_f32 v[138:139], v[138:139], v[74:75]
    s_waitcnt lgkmcnt(4)
    v_pk_add_f32 v[140:141], v[140:141], v[76:77]
    v_pk_add_f32 v[142:143], v[142:143], v[78:79]
    s_waitcnt lgkmcnt(3)
    v_pk_add_f32 v[144:145], v[144:145], v[80:81]
    v_pk_add_f32 v[146:147], v[146:147], v[82:83]
    s_waitcnt lgkmcnt(2)
    v_pk_add_f32 v[148:149], v[148:149], v[84:85]
    v_pk_add_f32 v[150:151], v[150:151], v[86:87]
    s_waitcnt lgkmcnt(1)
    v_pk_add_f32 v[152:153], v[152:153], v[88:89]
    v_pk_add_f32 v[154:155], v[154:155], v[90:91]
    s_waitcnt lgkmcnt(0)
    v_pk_add_f32 v[156:157], v[156:157], v[92:93]
    v_pk_add_f32 v[158:159], v[158:159], v[94:95]
    s_barrier
    v_min_f32 v8, v192, v196
    v_max_f32 v5, v192, v196
    v_pk_mul_f32 v[6:7], v[128:129], 0 op_sel_hi:[1,0]
    v_pk_fma_f32 v[6:7], v[130:131], 0, v[6:7] op_sel_hi:[1,0,1]
    v_pk_fma_f32 v[6:7], v[132:133], 0, v[6:7] op_sel_hi:[1,0,1]
    v_pk_fma_f32 v[6:7], v[134:135], 0, v[6:7] op_sel_hi:[1,0,1]
    v_pk_fma_f32 v[6:7], v[136:137], 0, v[6:7] op_sel_hi:[1,0,1]
    v_pk_fma_f32 v[6:7], v[138:139], 0, v[6:7] op_sel_hi:[1,0,1]
    v_pk_fma_f32 v[6:7], v[140:141], 0, v[6:7] op_sel_hi:[1,0,1]
    v_pk_fma_f32 v[6:7], v[142:143], 0, v[6:7] op_sel_hi:[1,0,1]
    v_pk_fma_f32 v[6:7], v[144:145], 0, v[6:7] op_sel_hi:[1,0,1]
    v_pk_fma_f32 v[6:7], v[146:147], 0, v[6:7] op_sel_hi:[1,0,1]
    v_pk_fma_f32 v[6:7], v[148:149], 0, v[6:7] op_sel_hi:[1,0,1]
    v_pk_fma_f32 v[6:7], v[150:151], 0, v[6:7] op_sel_hi:[1,0,1]
    v_pk_fma_f32 v[6:7], v[152:153], 0, v[6:7] op_sel_hi:[1,0,1]
    v_pk_fma_f32 v[6:7], v[154:155], 0, v[6:7] op_sel_hi:[1,0,1]
    v_pk_fma_f32 v[6:7], v[156:157], 0, v[6:7] op_sel_hi:[1,0,1]
    v_pk_fma_f32 v[6:7], v[158:159], 0, v[6:7] op_sel_hi:[1,0,1]
    v_add_f32 v7, v6, v7
    v_fmac_f32 v7, 0, v192
    v_fmac_f32 v7, 0, v196
    v_cmp_le_f32 vcc, 0x35800000, v8
    s_mov_b64 s[44:45], vcc
    v_cmp_ge_f32 vcc, 0x5d800000, v5
    s_and_b64 s[44:45], s[44:45], vcc
    v_cmp_eq_f32 vcc, 0, v7
    s_and_b64 s[44:45], s[44:45], vcc
    s_cmp_eq_u64 s[44:45], -1
    s_cbranch_scc0 L_slow_72
L_fin_73:
    v_add_u32 v52, 65536, v56
    v_add_u32 v53, 65536, v57
    v_add_u32 v54, 65536, v58
    v_add_u32 v55, 65536, v59
    ds_read_b64_tr_b16 v[96:97], v53 offset:0
    ds_read_b64_tr_b16 v[98:99], v53 offset:7168
    ds_read_b128 v[64:67], v52 offset:0
    ds_read_b128 v[68:71], v52 offset:1024
    ds_read_b128 v[72:75], v52 offset:2048
    ds_read_b128 v[76:79], v52 offset:3072
    ds_read_b64_tr_b16 v[100:101], v54 offset:0
    ds_read_b64_tr_b16 v[102:103], v54 offset:7168
    ds_read_b64_tr_b16 v[104:105], v53 offset:64
    ds_read_b64_tr_b16 v[106:107], v53 offset:7232
    ds_read_b64_tr_b16 v[108:109], v54 offset:64
    ds_read_b64_tr_b16 v[110:111], v54 offset:7232
    ds_read_b64_tr_b16 v[112:113], v53 offset:128
    ds_read_b64_tr_b16 v[114:115], v53 offset:7296
    ds_read_b64_tr_b16 v[116:117], v54 offset:128
    ds_read_b64_tr_b16 v[118:119], v54 offset:7296
    ds_read_b64_tr_b16 v[120:121], v55 offset:0
    ds_read_b64_tr_b16 v[122:123], v55 offset:7168
    v_add_u32 v48, 20480, v56
    v_add_u32 v49, 20480, v57
    v_add_u32 v50, 20480, v58
    v_add_u32 v51, 20480, v59
    v_add_u32 v56, 110592, v56
    v_add_u32 v57, 110592, v57
    v_add_u32 v58, 110592, v58
    v_add_u32 v59, 110592, v59
    v_rcp_f32 v6, v192
    v_rcp_f32 v7, v196
    s_nop 0
    v_mul_f32 v6, v6, v12
    v_mul_f32 v7, v7, v13
    v_pk_mul_f32 v[128:129], v[128:129], v[6:7] op_sel:[0,0] op_sel_hi:[1,0]
    v_pk_mul_f32 v[130:131], v[130:131], v[6:7] op_sel:[0,0] op_sel_hi:[1,0]
    v_pk_mul_f32 v[132:133], v[132:133], v[6:7] op_sel:[0,0] op_sel_hi:[1,0]
    v_pk_mul_f32 v[134:135], v[134:135], v[6:7] op_sel:[0,0] op_sel_hi:[1,0]
    v_pk_mul_f32 v[136:137], v[136:137], v[6:7] op_sel:[0,0] op_sel_hi:[1,0]
    v_pk_mul_f32 v[138:139], v[138:139], v[6:7] op_sel:[0,0] op_sel_hi:[1,0]
    v_pk_mul_f32 v[140:141], v[140:141], v[6:7] op_sel:[0,0] op_sel_hi:[1,0]
    v_pk_mul_f32 v[142:143], v[142:143], v[6:7] op_sel:[0,0] op_sel_hi:[1,0]
    v_cvt_pk_bf16_f32 v32, v128, v129
    v_cvt_pk_bf16_f32 v33, v130, v131
    v_cvt_pk_bf16_f32 v34, v132, v133
    v_cvt_pk_bf16_f32 v35, v134, v135
    buffer_store_dwordx4 v[32:35], v16, s[4:7], s29 offen offset:0 sc1
    v_cvt_pk_bf16_f32 v36, v136, v137
    v_cvt_pk_bf16_f32 v37, v138, v139
    v_cvt_pk_bf16_f32 v38, v140, v141
    v_cvt_pk_bf16_f32 v39, v142, v143
    buffer_store_dwordx4 v[36:39], v16, s[4:7], s29 offen offset:1024 sc1
    v_pk_mul_f32 v[144:145], v[144:145], v[6:7] op_sel:[0,1] op_sel_hi:[1,1]
    v_pk_mul_f32 v[146:147], v[146:147], v[6:7] op_sel:[0,1] op_sel_hi:[1,1]
    v_pk_mul_f32 v[148:149], v[148:149], v[6:7] op_sel:[0,1] op_sel_hi:[1,1]
    v_pk_mul_f32 v[150:151], v[150:151], v[6:7] op_sel:[0,1] op_sel_hi:[1,1]
    v_pk_mul_f32 v[152:153], v[152:153], v[6:7] op_sel:[0,1] op_sel_hi:[1,1]
    v_pk_mul_f32 v[154:155], v[154:155], v[6:7] op_sel:[0,1] op_sel_hi:[1,1]
    v_pk_mul_f32 v[156:157], v[156:157], v[6:7] op_sel:[0,1] op_sel_hi:[1,1]
    v_pk_mul_f32 v[158:159], v[158:159], v[6:7] op_sel:[0,1] op_sel_hi:[1,1]
    v_cvt_pk_bf16_f32 v40, v144, v145
    v_cvt_pk_bf16_f32 v41, v146, v147
    v_cvt_pk_bf16_f32 v42, v148, v149
    v_cvt_pk_bf16_f32 v43, v150, v151
    buffer_store_dwordx4 v[40:43], v16, s[4:7], s35 offen offset:0 sc1
    v_cvt_pk_bf16_f32 v44, v152, v153
    v_cvt_pk_bf16_f32 v45, v154, v155
    v_cvt_pk_bf16_f32 v46, v156, v157
    v_cvt_pk_bf16_f32 v47, v158, v159
    buffer_store_dwordx4 v[44:47], v16, s[4:7], s35 offen offset:1024 sc1
    s_waitcnt lgkmcnt(0)
    s_waitcnt lgkmcnt(5)
    v_mfma_f32_16x16x32_bf16 v[128:131], v[96:99], v[64:67], 0
    ds_read_b64_tr_b16 v[122:123], v55 offset:7168
    s_lshl_b32 s3, s19, 10
    v_mfma_f32_16x16x32_bf16 v[156:159], v[96:99], v[68:71], 0
    ds_read_b128 v[80:83], v52 offset:8192
    v_lshl_add_u32 v10, v3, 4, s3
    v_mfma_f32_16x16x32_bf16 v[184:187], v[96:99], v[72:75], 0
    ds_read_b128 v[84:87], v52 offset:9216
    v_add_u32 v10, 155648, v10
    v_mfma_f32_16x16x32_bf16 v[212:215], v[96:99], v[76:79], 0
    ds_read_b64_tr_b16 v[96:97], v53 offset:14336
    s_lshl_b32 s3, s20, 9
    v_mfma_f32_16x16x32_bf16 v[216:219], v[100:103], v[76:79], 0
    ds_read_b64_tr_b16 v[98:99], v53 offset:21504
    v_lshl_add_u32 v11, v4, 4, s3
    v_mfma_f32_16x16x32_bf16 v[188:191], v[100:103], v[72:75], 0
    ds_read_b128 v[88:91], v52 offset:10240
    v_add_u32 v11, 157696, v11
    v_mfma_f32_16x16x32_bf16 v[160:163], v[100:103], v[68:71], 0
    ds_read_b128 v[92:95], v52 offset:11264
    ds_read_b128 v[16:19], v10
    v_mfma_f32_16x16x32_bf16 v[132:135], v[100:103], v[64:67], 0
    ds_read_b64_tr_b16 v[100:101], v54 offset:14336
    ds_read_b128 v[20:23], v10 offset:256
    v_mfma_f32_16x16x32_bf16 v[136:139], v[104:107], v[64:67], 0
    ds_read_b64_tr_b16 v[102:103], v54 offset:21504
    ds_read_b128 v[24:27], v10 offset:512
    v_mfma_f32_16x16x32_bf16 v[164:167], v[104:107], v[68:71], 0
    ds_read_b128 v[28:31], v10 offset:768
    v_and_b32 v5, 1, v4
    v_mfma_f32_16x16x32_bf16 v[192:195], v[104:107], v[72:75], 0
    v_lshlrev_b32 v7, 6, v5
    v_lshrrev_b32 v8, 1, v4
    v_mfma_f32_16x16x32_bf16 v[220:223], v[104:107], v[76:79], 0
    ds_read_b64_tr_b16 v[104:105], v53 offset:14400
    v_lshl_add_u32 v7, v8, 4, v7
    v_mfma_f32_16x16x32_bf16 v[224:227], v[108:111], v[76:79], 0
    ds_read_b64_tr_b16 v[106:107], v53 offset:21568
    s_lshl_b32 s3, s20, 5
    v_mfma_f32_16x16x32_bf16 v[196:199], v[108:111], v[72:75], 0
    s_add_u32 s3, s3, 158080
    v_add_u32 v12, s3, v7
    v_mfma_f32_16x16x32_bf16 v[168:171], v[108:111], v[68:71], 0
    s_lshl_b32 s3, s42, 2
    s_add_u32 s3, s3, 158720
    v_mfma_f32_16x16x32_bf16 v[140:143], v[108:111], v[64:67], 0
    ds_read_b64_tr_b16 v[108:109], v54 offset:14400
    s_waitcnt lgkmcnt(5)
    v_mfma_f32_16x16x32_bf16 v[144:147], v[112:115], v[64:67], 0
    ds_read_b64_tr_b16 v[110:111], v54 offset:21568
    v_lshl_add_u32 v13, v3, 2, s3
    v_mfma_f32_16x16x32_bf16 v[172:175], v[112:115], v[68:71], 0
    ds_read_b32 v60, v13
    ds_read_b32 v61, v13 offset:64
    v_mfma_f32_16x16x32_bf16 v[200:203], v[112:115], v[72:75], 0
    s_mul_i32 s29, s17, 114688
    s_add_u32 s29, s29, s28
    v_mfma_f32_16x16x32_bf16 v[228:231], v[112:115], v[76:79], 0
    ds_read_b64_tr_b16 v[112:113], v53 offset:14464
    s_lshl_b32 s3, s19, 13
    v_mfma_f32_16x16x32_bf16 v[232:235], v[116:119], v[76:79], 0
    ds_read_b64_tr_b16 v[114:115], v53 offset:21632
    s_add_u32 s29, s29, s3
    v_mfma_f32_16x16x32_bf16 v[204:207], v[116:119], v[72:75], 0
    s_add_u32 s33, s29, 49152
    s_lshl_b32 s3, s20, 10
    v_mfma_f32_16x16x32_bf16 v[176:179], v[116:119], v[68:71], 0
    s_add_u32 s33, s33, s3
    s_add_u32 s34, s33, 4096
    v_mfma_f32_16x16x32_bf16 v[148:151], v[116:119], v[64:67], 0
    ds_read_b64_tr_b16 v[116:117], v54 offset:14464
    s_lshl_b32 s3, s20, 16
    v_mfma_f32_16x16x32_bf16 v[152:155], v[120:123], v[64:67], 0
    ds_read_b64_tr_b16 v[118:119], v54 offset:21632
    s_add_u32 s29, s29, s3
    v_mfma_f32_16x16x32_bf16 v[180:183], v[120:123], v[68:71], 0
    s_add_u32 s30, s29, 16384
    s_add_u32 s31, s29, 32768
    v_mfma_f32_16x16x32_bf16 v[208:211], v[120:123], v[72:75], 0
    v_lshlrev_b32 v5, 10, v5
    v_lshl_add_u32 v5, v8, 8, v5
    v_mfma_f32_16x16x32_bf16 v[236:239], v[120:123], v[76:79], 0
    ds_read_b64_tr_b16 v[120:121], v55 offset:14336
    v_lshl_add_u32 v8, v3, 4, v5
    v_mfma_f32_16x16x32_bf16 v[128:131], v[96:99], v[80:83], v[128:131]
    ds_read_b64_tr_b16 v[122:123], v55 offset:21504
    v_and_b32 v5, 0xffffff80, v8
    v_mfma_f32_16x16x32_bf16 v[156:159], v[96:99], v[84:87], v[156:159]
    v_add_u32 v8, v5, v8
    v_and_b32 v5, 0xffffff80, v9
    v_mfma_f32_16x16x32_bf16 v[184:187], v[96:99], v[88:91], v[184:187]
    v_add_u32 v10, v5, v9
    v_add_u32 v13, 4096, v10
    v_mfma_f32_16x16x32_bf16 v[212:215], v[96:99], v[92:95], v[212:215]
    s_waitcnt lgkmcnt(5)
    s_lshl_b32 s3, s19, 12
    v_mfma_f32_16x16x32_bf16 v[216:219], v[100:103], v[92:95], v[216:219]
    s_lshl_b32 s43, s22, 11
    s_add_u32 s3, s3, s43
    v_mfma_f32_16x16x32_bf16 v[188:191], v[100:103], v[88:91], v[188:191]
    v_add_u32 v14, s3, v9
    v_lshrrev_b32 v5, 2, v3
    v_mfma_f32_16x16x32_bf16 v[160:163], v[100:103], v[84:87], v[160:163]
    v_and_b32 v6, 3, v3
    v_lshl_add_u32 v7, v4, 2, v5
    v_mfma_f32_16x16x32_bf16 v[132:135], v[100:103], v[80:83], v[132:135]
    s_waitcnt lgkmcnt(0)
    v_bfe_u32 v5, v7, 1, 2
    v_mfma_f32_16x16x32_bf16 v[136:139], v[104:107], v[80:83], v[136:139]
    s_barrier
    v_mfma_f32_16x16x32_bf16 v[164:167], v[104:107], v[84:87], v[164:167]
    ds_read_b64_tr_b16 v[96:97], v57 offset:0
    v_lshlrev_b32 v7, 7, v7
    v_mfma_f32_16x16x32_bf16 v[192:195], v[104:107], v[88:91], v[192:195]
    ds_read_b64_tr_b16 v[98:99], v57 offset:7168
    v_lshl_add_u32 v7, v6, 3, v7
    v_mfma_f32_16x16x32_bf16 v[220:223], v[104:107], v[92:95], v[220:223]
    ds_read_b128 v[64:67], v56 offset:0
    s_lshl_b32 s3, s20, 13
    v_mfma_f32_16x16x32_bf16 v[224:227], v[108:111], v[92:95], v[224:227]
    ds_read_b128 v[68:71], v56 offset:1024
    v_add_u32 v7, s3, v7
    v_mfma_f32_16x16x32_bf16 v[196:199], v[108:111], v[88:91], v[196:199]
    ds_read_b128 v[72:75], v56 offset:2048
    v_lshl_add_u32 v15, v5, 5, v7
    v_mfma_f32_16x16x32_bf16 v[168:171], v[108:111], v[84:87], v[168:171]
    ds_read_b128 v[76:79], v56 offset:3072
    v_mfma_f32_16x16x32_bf16 v[140:143], v[108:111], v[80:83], v[140:143]
    ds_read_b64_tr_b16 v[100:101], v58 offset:0
    v_mfma_f32_16x16x32_bf16 v[144:147], v[112:115], v[80:83], v[144:147]
    ds_read_b64_tr_b16 v[102:103], v58 offset:7168
    v_mfma_f32_16x16x32_bf16 v[172:175], v[112:115], v[84:87], v[172:175]
    ds_read_b64_tr_b16 v[104:105], v57 offset:64
    v_mfma_f32_16x16x32_bf16 v[200:203], v[112:115], v[88:91], v[200:203]
    ds_read_b64_tr_b16 v[106:107], v57 offset:7232
    v_mfma_f32_16x16x32_bf16 v[228:231], v[112:115], v[92:95], v[228:231]
    ds_read_b64_tr_b16 v[108:109], v58 offset:64
    v_mfma_f32_16x16x32_bf16 v[232:235], v[116:119], v[92:95], v[232:235]
    ds_read_b64_tr_b16 v[110:111], v58 offset:7232
    v_mfma_f32_16x16x32_bf16 v[204:207], v[116:119], v[88:91], v[204:207]
    ds_read_b64_tr_b16 v[112:113], v57 offset:128
    v_mfma_f32_16x16x32_bf16 v[176:179], v[116:119], v[84:87], v[176:179]
    ds_read_b64_tr_b16 v[114:115], v57 offset:7296
    v_mfma_f32_16x16x32_bf16 v[148:151], v[116:119], v[80:83], v[148:151]
    ds_read_b64_tr_b16 v[116:117], v58 offset:128
    v_mfma_f32_16x16x32_bf16 v[152:155], v[120:123], v[80:83], v[152:155]
    ds_read_b64_tr_b16 v[118:119], v58 offset:7296
    v_mfma_f32_16x16x32_bf16 v[180:183], v[120:123], v[84:87], v[180:183]
    v_mfma_f32_16x16x32_bf16 v[208:211], v[120:123], v[88:91], v[208:211]
    v_mfma_f32_16x16x32_bf16 v[236:239], v[120:123], v[92:95], v[236:239]
    ds_read_b64_tr_b16 v[120:121], v59 offset:0
    s_mov_b32 s40, 1
    s_mov_b32 s41, 4
L_p3cloop_74:
    s_waitcnt lgkmcnt(5)
    v_mfma_f32_16x16x32_bf16 v[128:131], v[96:99], v[64:67], v[128:131]
    ds_read_b64_tr_b16 v[122:123], v59 offset:7168
    v_mfma_f32_16x16x32_bf16 v[156:159], v[96:99], v[68:71], v[156:159]
    ds_read_b128 v[80:83], v56 offset:8192
    v_mfma_f32_16x16x32_bf16 v[184:187], v[96:99], v[72:75], v[184:187]
    ds_read_b128 v[84:87], v56 offset:9216
    v_mfma_f32_16x16x32_bf16 v[212:215], v[96:99], v[76:79], v[212:215]
    ds_read_b64_tr_b16 v[96:97], v57 offset:14336
    v_mfma_f32_16x16x32_bf16 v[216:219], v[100:103], v[76:79], v[216:219]
    ds_read_b64_tr_b16 v[98:99], v57 offset:21504
    v_mfma_f32_16x16x32_bf16 v[188:191], v[100:103], v[72:75], v[188:191]
    ds_read_b128 v[88:91], v56 offset:10240
    v_mfma_f32_16x16x32_bf16 v[160:163], v[100:103], v[68:71], v[160:163]
    ds_read_b128 v[92:95], v56 offset:11264
    v_mfma_f32_16x16x32_bf16 v[132:135], v[100:103], v[64:67], v[132:135]
    ds_read_b64_tr_b16 v[100:101], v58 offset:14336
    v_mfma_f32_16x16x32_bf16 v[136:139], v[104:107], v[64:67], v[136:139]
    ds_read_b64_tr_b16 v[102:103], v58 offset:21504
    v_mfma_f32_16x16x32_bf16 v[164:167], v[104:107], v[68:71], v[164:167]
    v_mfma_f32_16x16x32_bf16 v[192:195], v[104:107], v[72:75], v[192:195]
    v_mfma_f32_16x16x32_bf16 v[220:223], v[104:107], v[76:79], v[220:223]
    ds_read_b64_tr_b16 v[104:105], v57 offset:14400
    v_mfma_f32_16x16x32_bf16 v[224:227], v[108:111], v[76:79], v[224:227]
    ds_read_b64_tr_b16 v[106:107], v57 offset:21568
    v_mfma_f32_16x16x32_bf16 v[196:199], v[108:111], v[72:75], v[196:199]
    v_mfma_f32_16x16x32_bf16 v[168:171], v[108:111], v[68:71], v[168:171]
    v_mfma_f32_16x16x32_bf16 v[140:143], v[108:111], v[64:67], v[140:143]
    ds_read_b64_tr_b16 v[108:109], v58 offset:14400
    s_waitcnt lgkmcnt(5)
    v_mfma_f32_16x16x32_bf16 v[144:147], v[112:115], v[64:67], v[144:147]
    ds_read_b64_tr_b16 v[110:111], v58 offset:21568
    v_mfma_f32_16x16x32_bf16 v[172:175], v[112:115], v[68:71], v[172:175]
    v_mfma_f32_16x16x32_bf16 v[200:203], v[112:115], v[72:75], v[200:203]
    v_mfma_f32_16x16x32_bf16 v[228:231], v[112:115], v[76:79], v[228:231]
    ds_read_b64_tr_b16 v[112:113], v57 offset:14464
    v_mfma_f32_16x16x32_bf16 v[232:235], v[116:119], v[76:79], v[232:235]
    ds_read_b64_tr_b16 v[114:115], v57 offset:21632
    v_mfma_f32_16x16x32_bf16 v[204:207], v[116:119], v[72:75], v[204:207]
    v_mfma_f32_16x16x32_bf16 v[176:179], v[116:119], v[68:71], v[176:179]
    v_mfma_f32_16x16x32_bf16 v[148:151], v[116:119], v[64:67], v[148:151]
    ds_read_b64_tr_b16 v[116:117], v58 offset:14464
    v_mfma_f32_16x16x32_bf16 v[152:155], v[120:123], v[64:67], v[152:155]
    ds_read_b64_tr_b16 v[118:119], v58 offset:21632
    v_mfma_f32_16x16x32_bf16 v[180:183], v[120:123], v[68:71], v[180:183]
    v_mfma_f32_16x16x32_bf16 v[208:211], v[120:123], v[72:75], v[208:211]
    v_mfma_f32_16x16x32_bf16 v[236:239], v[120:123], v[76:79], v[236:239]
    ds_read_b64_tr_b16 v[120:121], v59 offset:14336
    v_mfma_f32_16x16x32_bf16 v[128:131], v[96:99], v[80:83], v[128:131]
    ds_read_b64_tr_b16 v[122:123], v59 offset:21504
    v_mfma_f32_16x16x32_bf16 v[156:159], v[96:99], v[84:87], v[156:159]
    v_mfma_f32_16x16x32_bf16 v[184:187], v[96:99], v[88:91], v[184:187]
    v_mfma_f32_16x16x32_bf16 v[212:215], v[96:99], v[92:95], v[212:215]
    s_waitcnt lgkmcnt(5)
    v_mfma_f32_16x16x32_bf16 v[216:219], v[100:103], v[92:95], v[216:219]
    v_mfma_f32_16x16x32_bf16 v[188:191], v[100:103], v[88:91], v[188:191]
    v_mfma_f32_16x16x32_bf16 v[160:163], v[100:103], v[84:87], v[160:163]
    v_mfma_f32_16x16x32_bf16 v[132:135], v[100:103], v[80:83], v[132:135]
    s_waitcnt lgkmcnt(0)
    v_mfma_f32_16x16x32_bf16 v[136:139], v[104:107], v[80:83], v[136:139]
    s_barrier
    v_mfma_f32_16x16x32_bf16 v[164:167], v[104:107], v[84:87], v[164:167]
    ds_read_b64_tr_b16 v[96:97], v49 offset:0
    v_mfma_f32_16x16x32_bf16 v[192:195], v[104:107], v[88:91], v[192:195]
    ds_read_b64_tr_b16 v[98:99], v49 offset:7168
    v_mfma_f32_16x16x32_bf16 v[220:223], v[104:107], v[92:95], v[220:223]
    ds_read_b128 v[64:67], v48 offset:0
    v_mfma_f32_16x16x32_bf16 v[224:227], v[108:111], v[92:95], v[224:227]
    ds_read_b128 v[68:71], v48 offset:1024
    v_mfma_f32_16x16x32_bf16 v[196:199], v[108:111], v[88:91], v[196:199]
    ds_read_b128 v[72:75], v48 offset:2048
    v_mfma_f32_16x16x32_bf16 v[168:171], v[108:111], v[84:87], v[168:171]
    ds_read_b128 v[76:79], v48 offset:3072
    v_mfma_f32_16x16x32_bf16 v[140:143], v[108:111], v[80:83], v[140:143]
    ds_read_b64_tr_b16 v[100:101], v50 offset:0
    v_mfma_f32_16x16x32_bf16 v[144:147], v[112:115], v[80:83], v[144:147]
    ds_read_b64_tr_b16 v[102:103], v50 offset:7168
    v_mfma_f32_16x16x32_bf16 v[172:175], v[112:115], v[84:87], v[172:175]
    ds_read_b64_tr_b16 v[104:105], v49 offset:64
    v_mfma_f32_16x16x32_bf16 v[200:203], v[112:115], v[88:91], v[200:203]
    ds_read_b64_tr_b16 v[106:107], v49 offset:7232
    v_mfma_f32_16x16x32_bf16 v[228:231], v[112:115], v[92:95], v[228:231]
    ds_read_b64_tr_b16 v[108:109], v50 offset:64
    v_mfma_f32_16x16x32_bf16 v[232:235], v[116:119], v[92:95], v[232:235]
    ds_read_b64_tr_b16 v[110:111], v50 offset:7232
    v_mfma_f32_16x16x32_bf16 v[204:207], v[116:119], v[88:91], v[204:207]
    ds_read_b64_tr_b16 v[112:113], v49 offset:128
    v_mfma_f32_16x16x32_bf16 v[176:179], v[116:119], v[84:87], v[176:179]
    ds_read_b64_tr_b16 v[114:115], v49 offset:7296
    v_mfma_f32_16x16x32_bf16 v[148:151], v[116:119], v[80:83], v[148:151]
    ds_read_b64_tr_b16 v[116:117], v50 offset:128
    v_mfma_f32_16x16x32_bf16 v[152:155], v[120:123], v[80:83], v[152:155]
    ds_read_b64_tr_b16 v[118:119], v50 offset:7296
    v_mfma_f32_16x16x32_bf16 v[180:183], v[120:123], v[84:87], v[180:183]
    v_mfma_f32_16x16x32_bf16 v[208:211], v[120:123], v[88:91], v[208:211]
    v_mfma_f32_16x16x32_bf16 v[236:239], v[120:123], v[92:95], v[236:239]
    ds_read_b64_tr_b16 v[120:121], v51 offset:0
    s_waitcnt lgkmcnt(5)
    v_mfma_f32_16x16x32_bf16 v[128:131], v[96:99], v[64:67], v[128:131]
    ds_read_b64_tr_b16 v[122:123], v51 offset:7168
    v_mfma_f32_16x16x32_bf16 v[156:159], v[96:99], v[68:71], v[156:159]
    ds_read_b128 v[80:83], v48 offset:8192
    v_mfma_f32_16x16x32_bf16 v[184:187], v[96:99], v[72:75], v[184:187]
    ds_read_b128 v[84:87], v48 offset:9216
    v_mfma_f32_16x16x32_bf16 v[212:215], v[96:99], v[76:79], v[212:215]
    ds_read_b64_tr_b16 v[96:97], v49 offset:14336
    v_mfma_f32_16x16x32_bf16 v[216:219], v[100:103], v[76:79], v[216:219]
    ds_read_b64_tr_b16 v[98:99], v49 offset:21504
    v_mfma_f32_16x16x32_bf16 v[188:191], v[100:103], v[72:75], v[188:191]
    ds_read_b128 v[88:91], v48 offset:10240
    v_mfma_f32_16x16x32_bf16 v[160:163], v[100:103], v[68:71], v[160:163]
    ds_read_b128 v[92:95], v48 offset:11264
    v_mfma_f32_16x16x32_bf16 v[132:135], v[100:103], v[64:67], v[132:135]
    ds_read_b64_tr_b16 v[100:101], v50 offset:14336
    v_mfma_f32_16x16x32_bf16 v[136:139], v[104:107], v[64:67], v[136:139]
    ds_read_b64_tr_b16 v[102:103], v50 offset:21504
    v_mfma_f32_16x16x32_bf16 v[164:167], v[104:107], v[68:71], v[164:167]
    v_mfma_f32_16x16x32_bf16 v[192:195], v[104:107], v[72:75], v[192:195]
    v_mfma_f32_16x16x32_bf16 v[220:223], v[104:107], v[76:79], v[220:223]
    ds_read_b64_tr_b16 v[104:105], v49 offset:14400
    v_mfma_f32_16x16x32_bf16 v[224:227], v[108:111], v[76:79], v[224:227]
    ds_read_b64_tr_b16 v[106:107], v49 offset:21568
    v_mfma_f32_16x16x32_bf16 v[196:199], v[108:111], v[72:75], v[196:199]
    v_mfma_f32_16x16x32_bf16 v[168:171], v[108:111], v[68:71], v[168:171]
    v_mfma_f32_16x16x32_bf16 v[140:143], v[108:111], v[64:67], v[140:143]
    ds_read_b64_tr_b16 v[108:109], v50 offset:14400
    s_waitcnt lgkmcnt(5)
    v_mfma_f32_16x16x32_bf16 v[144:147], v[112:115], v[64:67], v[144:147]
    ds_read_b64_tr_b16 v[110:111], v50 offset:21568
    v_mfma_f32_16x16x32_bf16 v[172:175], v[112:115], v[68:71], v[172:175]
    v_mfma_f32_16x16x32_bf16 v[200:203], v[112:115], v[72:75], v[200:203]
    v_mfma_f32_16x16x32_bf16 v[228:231], v[112:115], v[76:79], v[228:231]
    ds_read_b64_tr_b16 v[112:113], v49 offset:14464
    v_mfma_f32_16x16x32_bf16 v[232:235], v[116:119], v[76:79], v[232:235]
    ds_read_b64_tr_b16 v[114:115], v49 offset:21632
    v_mfma_f32_16x16x32_bf16 v[204:207], v[116:119], v[72:75], v[204:207]
    v_mfma_f32_16x16x32_bf16 v[176:179], v[116:119], v[68:71], v[176:179]
    v_mfma_f32_16x16x32_bf16 v[148:151], v[116:119], v[64:67], v[148:151]
    ds_read_b64_tr_b16 v[116:117], v50 offset:14464
    v_mfma_f32_16x16x32_bf16 v[152:155], v[120:123], v[64:67], v[152:155]
    ds_read_b64_tr_b16 v[118:119], v50 offset:21632
    v_mfma_f32_16x16x32_bf16 v[180:183], v[120:123], v[68:71], v[180:183]
    v_mfma_f32_16x16x32_bf16 v[208:211], v[120:123], v[72:75], v[208:211]
    v_mfma_f32_16x16x32_bf16 v[236:239], v[120:123], v[76:79], v[236:239]
    ds_read_b64_tr_b16 v[120:121], v51 offset:14336
    v_mfma_f32_16x16x32_bf16 v[128:131], v[96:99], v[80:83], v[128:131]
    ds_read_b64_tr_b16 v[122:123], v51 offset:21504
    v_mfma_f32_16x16x32_bf16 v[156:159], v[96:99], v[84:87], v[156:159]
    v_mfma_f32_16x16x32_bf16 v[184:187], v[96:99], v[88:91], v[184:187]
    v_mfma_f32_16x16x32_bf16 v[212:215], v[96:99], v[92:95], v[212:215]
    s_waitcnt lgkmcnt(5)
    v_mfma_f32_16x16x32_bf16 v[216:219], v[100:103], v[92:95], v[216:219]
    v_mfma_f32_16x16x32_bf16 v[188:191], v[100:103], v[88:91], v[188:191]
    v_mfma_f32_16x16x32_bf16 v[160:163], v[100:103], v[84:87], v[160:163]
    v_mfma_f32_16x16x32_bf16 v[132:135], v[100:103], v[80:83], v[132:135]
    s_waitcnt lgkmcnt(0)
    v_mfma_f32_16x16x32_bf16 v[136:139], v[104:107], v[80:83], v[136:139]
    s_barrier
    v_mfma_f32_16x16x32_bf16 v[164:167], v[104:107], v[84:87], v[164:167]
    ds_read_b64_tr_b16 v[96:97], v53 offset:0
    v_mfma_f32_16x16x32_bf16 v[192:195], v[104:107], v[88:91], v[192:195]
    ds_read_b64_tr_b16 v[98:99], v53 offset:7168
    v_mfma_f32_16x16x32_bf16 v[220:223], v[104:107], v[92:95], v[220:223]
    ds_read_b128 v[64:67], v52 offset:0
    v_mfma_f32_16x16x32_bf16 v[224:227], v[108:111], v[92:95], v[224:227]
    ds_read_b128 v[68:71], v52 offset:1024
    v_mfma_f32_16x16x32_bf16 v[196:199], v[108:111], v[88:91], v[196:199]
    ds_read_b128 v[72:75], v52 offset:2048
    v_mfma_f32_16x16x32_bf16 v[168:171], v[108:111], v[84:87], v[168:171]
    ds_read_b128 v[76:79], v52 offset:3072
    v_mfma_f32_16x16x32_bf16 v[140:143], v[108:111], v[80:83], v[140:143]
    ds_read_b64_tr_b16 v[100:101], v54 offset:0
    v_mfma_f32_16x16x32_bf16 v[144:147], v[112:115], v[80:83], v[144:147]
    ds_read_b64_tr_b16 v[102:103], v54 offset:7168
    v_mfma_f32_16x16x32_bf16 v[172:175], v[112:115], v[84:87], v[172:175]
    ds_read_b64_tr_b16 v[104:105], v53 offset:64
    v_mfma_f32_16x16x32_bf16 v[200:203], v[112:115], v[88:91], v[200:203]
    ds_read_b64_tr_b16 v[106:107], v53 offset:7232
    v_mfma_f32_16x16x32_bf16 v[228:231], v[112:115], v[92:95], v[228:231]
    ds_read_b64_tr_b16 v[108:109], v54 offset:64
    v_mfma_f32_16x16x32_bf16 v[232:235], v[116:119], v[92:95], v[232:235]
    ds_read_b64_tr_b16 v[110:111], v54 offset:7232
    v_mfma_f32_16x16x32_bf16 v[204:207], v[116:119], v[88:91], v[204:207]
    ds_read_b64_tr_b16 v[112:113], v53 offset:128
    v_mfma_f32_16x16x32_bf16 v[176:179], v[116:119], v[84:87], v[176:179]
    ds_read_b64_tr_b16 v[114:115], v53 offset:7296
    v_mfma_f32_16x16x32_bf16 v[148:151], v[116:119], v[80:83], v[148:151]
    ds_read_b64_tr_b16 v[116:117], v54 offset:128
    v_mfma_f32_16x16x32_bf16 v[152:155], v[120:123], v[80:83], v[152:155]
    ds_read_b64_tr_b16 v[118:119], v54 offset:7296
    v_mfma_f32_16x16x32_bf16 v[180:183], v[120:123], v[84:87], v[180:183]
    v_mfma_f32_16x16x32_bf16 v[208:211], v[120:123], v[88:91], v[208:211]
    v_mfma_f32_16x16x32_bf16 v[236:239], v[120:123], v[92:95], v[236:239]
    ds_read_b64_tr_b16 v[120:121], v55 offset:0
    s_waitcnt lgkmcnt(5)
    v_mfma_f32_16x16x32_bf16 v[128:131], v[96:99], v[64:67], v[128:131]
    ds_read_b64_tr_b16 v[122:123], v55 offset:7168
    v_mfma_f32_16x16x32_bf16 v[156:159], v[96:99], v[68:71], v[156:159]
    ds_read_b128 v[80:83], v52 offset:8192
    v_mfma_f32_16x16x32_bf16 v[184:187], v[96:99], v[72:75], v[184:187]
    ds_read_b128 v[84:87], v52 offset:9216
    v_mfma_f32_16x16x32_bf16 v[212:215], v[96:99], v[76:79], v[212:215]
    ds_read_b64_tr_b16 v[96:97], v53 offset:14336
    v_mfma_f32_16x16x32_bf16 v[216:219], v[100:103], v[76:79], v[216:219]
    ds_read_b64_tr_b16 v[98:99], v53 offset:21504
    v_mfma_f32_16x16x32_bf16 v[188:191], v[100:103], v[72:75], v[188:191]
    ds_read_b128 v[88:91], v52 offset:10240
    v_mfma_f32_16x16x32_bf16 v[160:163], v[100:103], v[68:71], v[160:163]
    ds_read_b128 v[92:95], v52 offset:11264
    v_mfma_f32_16x16x32_bf16 v[132:135], v[100:103], v[64:67], v[132:135]
    ds_read_b64_tr_b16 v[100:101], v54 offset:14336
    v_mfma_f32_16x16x32_bf16 v[136:139], v[104:107], v[64:67], v[136:139]
    ds_read_b64_tr_b16 v[102:103], v54 offset:21504
    v_mfma_f32_16x16x32_bf16 v[164:167], v[104:107], v[68:71], v[164:167]
    v_mfma_f32_16x16x32_bf16 v[192:195], v[104:107], v[72:75], v[192:195]
    v_mfma_f32_16x16x32_bf16 v[220:223], v[104:107], v[76:79], v[220:223]
    ds_read_b64_tr_b16 v[104:105], v53 offset:14400
    v_mfma_f32_16x16x32_bf16 v[224:227], v[108:111], v[76:79], v[224:227]
    ds_read_b64_tr_b16 v[106:107], v53 offset:21568
    v_mfma_f32_16x16x32_bf16 v[196:199], v[108:111], v[72:75], v[196:199]
    v_mfma_f32_16x16x32_bf16 v[168:171], v[108:111], v[68:71], v[168:171]
    v_mfma_f32_16x16x32_bf16 v[140:143], v[108:111], v[64:67], v[140:143]
    ds_read_b64_tr_b16 v[108:109], v54 offset:14400
    s_waitcnt lgkmcnt(5)
    v_mfma_f32_16x16x32_bf16 v[144:147], v[112:115], v[64:67], v[144:147]
    ds_read_b64_tr_b16 v[110:111], v54 offset:21568
    v_mfma_f32_16x16x32_bf16 v[172:175], v[112:115], v[68:71], v[172:175]
    v_mfma_f32_16x16x32_bf16 v[200:203], v[112:115], v[72:75], v[200:203]
    v_mfma_f32_16x16x32_bf16 v[228:231], v[112:115], v[76:79], v[228:231]
    ds_read_b64_tr_b16 v[112:113], v53 offset:14464
    v_mfma_f32_16x16x32_bf16 v[232:235], v[116:119], v[76:79], v[232:235]
    ds_read_b64_tr_b16 v[114:115], v53 offset:21632
    v_mfma_f32_16x16x32_bf16 v[204:207], v[116:119], v[72:75], v[204:207]
    v_mfma_f32_16x16x32_bf16 v[176:179], v[116:119], v[68:71], v[176:179]
    v_mfma_f32_16x16x32_bf16 v[148:151], v[116:119], v[64:67], v[148:151]
    ds_read_b64_tr_b16 v[116:117], v54 offset:14464
    v_mfma_f32_16x16x32_bf16 v[152:155], v[120:123], v[64:67], v[152:155]
    ds_read_b64_tr_b16 v[118:119], v54 offset:21632
    v_mfma_f32_16x16x32_bf16 v[180:183], v[120:123], v[68:71], v[180:183]
    v_mfma_f32_16x16x32_bf16 v[208:211], v[120:123], v[72:75], v[208:211]
    v_mfma_f32_16x16x32_bf16 v[236:239], v[120:123], v[76:79], v[236:239]
    ds_read_b64_tr_b16 v[120:121], v55 offset:14336
    v_mfma_f32_16x16x32_bf16 v[128:131], v[96:99], v[80:83], v[128:131]
    ds_read_b64_tr_b16 v[122:123], v55 offset:21504
    v_mfma_f32_16x16x32_bf16 v[156:159], v[96:99], v[84:87], v[156:159]
    v_mfma_f32_16x16x32_bf16 v[184:187], v[96:99], v[88:91], v[184:187]
    v_mfma_f32_16x16x32_bf16 v[212:215], v[96:99], v[92:95], v[212:215]
    s_waitcnt lgkmcnt(5)
    v_mfma_f32_16x16x32_bf16 v[216:219], v[100:103], v[92:95], v[216:219]
    v_mfma_f32_16x16x32_bf16 v[188:191], v[100:103], v[88:91], v[188:191]
    v_mfma_f32_16x16x32_bf16 v[160:163], v[100:103], v[84:87], v[160:163]
    v_mfma_f32_16x16x32_bf16 v[132:135], v[100:103], v[80:83], v[132:135]
    s_waitcnt lgkmcnt(0)
    v_mfma_f32_16x16x32_bf16 v[136:139], v[104:107], v[80:83], v[136:139]
    s_barrier
    v_mfma_f32_16x16x32_bf16 v[164:167], v[104:107], v[84:87], v[164:167]
    ds_read_b64_tr_b16 v[96:97], v57 offset:0
    v_mfma_f32_16x16x32_bf16 v[192:195], v[104:107], v[88:91], v[192:195]
    ds_read_b64_tr_b16 v[98:99], v57 offset:7168
    v_mfma_f32_16x16x32_bf16 v[220:223], v[104:107], v[92:95], v[220:223]
    ds_read_b128 v[64:67], v56 offset:0
    v_mfma_f32_16x16x32_bf16 v[224:227], v[108:111], v[92:95], v[224:227]
    ds_read_b128 v[68:71], v56 offset:1024
    v_mfma_f32_16x16x32_bf16 v[196:199], v[108:111], v[88:91], v[196:199]
    ds_read_b128 v[72:75], v56 offset:2048
    v_mfma_f32_16x16x32_bf16 v[168:171], v[108:111], v[84:87], v[168:171]
    ds_read_b128 v[76:79], v56 offset:3072
    v_mfma_f32_16x16x32_bf16 v[140:143], v[108:111], v[80:83], v[140:143]
    ds_read_b64_tr_b16 v[100:101], v58 offset:0
    v_mfma_f32_16x16x32_bf16 v[144:147], v[112:115], v[80:83], v[144:147]
    ds_read_b64_tr_b16 v[102:103], v58 offset:7168
    v_mfma_f32_16x16x32_bf16 v[172:175], v[112:115], v[84:87], v[172:175]
    ds_read_b64_tr_b16 v[104:105], v57 offset:64
    v_mfma_f32_16x16x32_bf16 v[200:203], v[112:115], v[88:91], v[200:203]
    ds_read_b64_tr_b16 v[106:107], v57 offset:7232
    v_mfma_f32_16x16x32_bf16 v[228:231], v[112:115], v[92:95], v[228:231]
    ds_read_b64_tr_b16 v[108:109], v58 offset:64
    v_mfma_f32_16x16x32_bf16 v[232:235], v[116:119], v[92:95], v[232:235]
    ds_read_b64_tr_b16 v[110:111], v58 offset:7232
    v_mfma_f32_16x16x32_bf16 v[204:207], v[116:119], v[88:91], v[204:207]
    ds_read_b64_tr_b16 v[112:113], v57 offset:128
    v_mfma_f32_16x16x32_bf16 v[176:179], v[116:119], v[84:87], v[176:179]
    ds_read_b64_tr_b16 v[114:115], v57 offset:7296
    v_mfma_f32_16x16x32_bf16 v[148:151], v[116:119], v[80:83], v[148:151]
    ds_read_b64_tr_b16 v[116:117], v58 offset:128
    v_mfma_f32_16x16x32_bf16 v[152:155], v[120:123], v[80:83], v[152:155]
    ds_read_b64_tr_b16 v[118:119], v58 offset:7296
    v_mfma_f32_16x16x32_bf16 v[180:183], v[120:123], v[84:87], v[180:183]
    s_sub_u32 s40, s40, 1
    v_mfma_f32_16x16x32_bf16 v[208:211], v[120:123], v[88:91], v[208:211]
    s_cmp_lg_u32 s40, 0
    v_mfma_f32_16x16x32_bf16 v[236:239], v[120:123], v[92:95], v[236:239]
    ds_read_b64_tr_b16 v[120:121], v59 offset:0
    s_cbranch_scc1 L_p3cloop_74
    s_cmp_eq_u32 s41, 0
    s_cbranch_scc1 L_p3cexit_75
    s_add_u32 s3, s23, 46792704
    s_waitcnt vmcnt(0)
    v_mov_b32 v1, s12
    s_mov_b64 exec, 1
    buffer_store_dword v1, off, s[4:7], s3 sc1
    s_mov_b64 exec, -1
    s_mov_b32 s40, s41
    s_mov_b32 s41, 0
    s_branch L_p3cloop_74
L_p3cexit_75:
C_p3end:
    ds_read_b128 v[32:35], v11 offset:0
    ds_read_b128 v[36:39], v11 offset:64
    ds_read_b128 v[40:43], v11 offset:128
    ds_read_b128 v[44:47], v11 offset:192
    ds_read_b128 v[48:51], v11 offset:256
    ds_read_b128 v[52:55], v11 offset:320
    ds_read_b128 v[56:59], v12
    s_waitcnt lgkmcnt(0)
    v_pk_fma_f32 v[212:213], v[32:33], v[28:29], v[212:213] op_sel_hi:[1,0,1] neg_lo:[0,1,0] neg_hi:[0,1,0]
    v_pk_fma_f32 v[214:215], v[34:35], v[28:29], v[214:215] op_sel_hi:[1,0,1] neg_lo:[0,1,0] neg_hi:[0,1,0]
    v_pk_fma_f32 v[216:217], v[36:37], v[28:29], v[216:217] op_sel_hi:[1,0,1] neg_lo:[0,1,0] neg_hi:[0,1,0]
    v_pk_fma_f32 v[218:219], v[38:39], v[28:29], v[218:219] op_sel_hi:[1,0,1] neg_lo:[0,1,0] neg_hi:[0,1,0]
    v_pk_mul_f32 v[64:65], v[212:213], v[212:213]
    v_pk_mul_f32 v[66:67], v[214:215], v[214:215]
    v_pk_mul_f32 v[68:69], v[216:217], v[216:217]
    v_pk_mul_f32 v[70:71], v[218:219], v[218:219]
    v_pk_fma_f32 v[64:65], v[64:65], v[30:31], v[28:29] op_sel:[0,0,1] op_sel_hi:[1,0,1]
    v_pk_fma_f32 v[66:67], v[66:67], v[30:31], v[28:29] op_sel:[0,0,1] op_sel_hi:[1,0,1]
    v_pk_fma_f32 v[68:69], v[68:69], v[30:31], v[28:29] op_sel:[0,0,1] op_sel_hi:[1,0,1]
    v_pk_fma_f32 v[70:71], v[70:71], v[30:31], v[28:29] op_sel:[0,0,1] op_sel_hi:[1,0,1]
    v_pk_mul_f32 v[64:65], v[64:65], v[212:213]
    v_pk_mul_f32 v[66:67], v[66:67], v[214:215]
    v_pk_mul_f32 v[68:69], v[68:69], v[216:217]
    v_pk_mul_f32 v[70:71], v[70:71], v[218:219]
    v_exp_f32 v64, v64
    v_pk_fma_f32 v[220:221], v[40:41], v[28:29], v[220:221] op_sel_hi:[1,0,1] neg_lo:[0,1,0] neg_hi:[0,1,0]
    v_exp_f32 v65, v65
    v_pk_fma_f32 v[222:223], v[42:43], v[28:29], v[222:223] op_sel_hi:[1,0,1] neg_lo:[0,1,0] neg_hi:[0,1,0]
    v_pk_fma_f32 v[224:225], v[44:45], v[28:29], v[224:225] op_sel_hi:[1,0,1] neg_lo:[0,1,0] neg_hi:[0,1,0]
    v_exp_f32 v66, v66
    v_pk_fma_f32 v[64:65], v[64:65], v[30:31], v[30:31] op_sel:[0,1,1] op_sel_hi:[1,1,1]
    v_pk_fma_f32 v[226:227], v[46:47], v[28:29], v[226:227] op_sel_hi:[1,0,1] neg_lo:[0,1,0] neg_hi:[0,1,0]
    v_exp_f32 v67, v67
    v_pk_mul_f32 v[116:117], v[220:221], v[220:221]
    v_pk_mul_f32 v[118:119], v[222:223], v[222:223]
    v_exp_f32 v68, v68
    v_pk_fma_f32 v[66:67], v[66:67], v[30:31], v[30:31] op_sel:[0,1,1] op_sel_hi:[1,1,1]
    v_pk_mul_f32 v[120:121], v[224:225], v[224:225]
    v_exp_f32 v69, v69
    v_pk_mul_f32 v[122:123], v[226:227], v[226:227]
    v_exp_f32 v70, v70
    v_pk_fma_f32 v[116:117], v[116:117], v[30:31], v[28:29] op_sel:[0,0,1] op_sel_hi:[1,0,1]
    v_pk_fma_f32 v[68:69], v[68:69], v[30:31], v[30:31] op_sel:[0,1,1] op_sel_hi:[1,1,1]
    v_exp_f32 v71, v71
    v_pk_fma_f32 v[118:119], v[118:119], v[30:31], v[28:29] op_sel:[0,0,1] op_sel_hi:[1,0,1]
    v_pk_fma_f32 v[120:121], v[120:121], v[30:31], v[28:29] op_sel:[0,0,1] op_sel_hi:[1,0,1]
    v_rcp_f32 v64, v64
    v_pk_fma_f32 v[70:71], v[70:71], v[30:31], v[30:31] op_sel:[0,1,1] op_sel_hi:[1,1,1]
    v_pk_fma_f32 v[122:123], v[122:123], v[30:31], v[28:29] op_sel:[0,0,1] op_sel_hi:[1,0,1]
    v_rcp_f32 v65, v65
    v_pk_mul_f32 v[116:117], v[116:117], v[220:221]
    v_pk_mul_f32 v[118:119], v[118:119], v[222:223]
    v_rcp_f32 v66, v66
    v_pk_mul_f32 v[212:213], v[212:213], v[64:65]
    v_pk_mul_f32 v[120:121], v[120:121], v[224:225]
    v_rcp_f32 v67, v67
    v_pk_mul_f32 v[122:123], v[122:123], v[226:227]
    v_rcp_f32 v68, v68
    v_cvt_pk_bf16_f32 v72, v212, v213
    v_pk_mul_f32 v[214:215], v[214:215], v[66:67]
    v_rcp_f32 v69, v69
    v_pk_fma_f32 v[228:229], v[48:49], v[28:29], v[228:229] op_sel_hi:[1,0,1] neg_lo:[0,1,0] neg_hi:[0,1,0]
    v_pk_fma_f32 v[230:231], v[50:51], v[28:29], v[230:231] op_sel_hi:[1,0,1] neg_lo:[0,1,0] neg_hi:[0,1,0]
    v_rcp_f32 v70, v70
    v_pk_mul_f32 v[216:217], v[216:217], v[68:69]
    v_cvt_pk_bf16_f32 v73, v214, v215
    v_rcp_f32 v71, v71
    v_pk_fma_f32 v[232:233], v[52:53], v[28:29], v[232:233] op_sel_hi:[1,0,1] neg_lo:[0,1,0] neg_hi:[0,1,0]
    v_cvt_pk_bf16_f32 v74, v216, v217
    v_exp_f32 v116, v116
    v_pk_mul_f32 v[218:219], v[218:219], v[70:71]
    v_pk_fma_f32 v[234:235], v[54:55], v[28:29], v[234:235] op_sel_hi:[1,0,1] neg_lo:[0,1,0] neg_hi:[0,1,0]
    v_exp_f32 v117, v117
    v_pk_mul_f32 v[64:65], v[228:229], v[228:229]
    v_exp_f32 v118, v118
    v_cvt_pk_bf16_f32 v75, v218, v219
    v_pk_fma_f32 v[116:117], v[116:117], v[30:31], v[30:31] op_sel:[0,1,1] op_sel_hi:[1,1,1]
    v_exp_f32 v119, v119
    v_pk_mul_f32 v[66:67], v[230:231], v[230:231]
    buffer_store_dwordx4 v[72:75], v13, s[4:7], s29 offen offset:2048 sc1
    v_exp_f32 v120, v120
    v_pk_fma_f32 v[118:119], v[118:119], v[30:31], v[30:31] op_sel:[0,1,1] op_sel_hi:[1,1,1]
    v_pk_mul_f32 v[68:69], v[232:233], v[232:233]
    v_exp_f32 v121, v121
    v_pk_mul_f32 v[70:71], v[234:235], v[234:235]
    v_pk_fma_f32 v[64:65], v[64:65], v[30:31], v[28:29] op_sel:[0,0,1] op_sel_hi:[1,0,1]
    v_exp_f32 v122, v122
    v_pk_fma_f32 v[120:121], v[120:121], v[30:31], v[30:31] op_sel:[0,1,1] op_sel_hi:[1,1,1]
    v_pk_fma_f32 v[66:67], v[66:67], v[30:31], v[28:29] op_sel:[0,0,1] op_sel_hi:[1,0,1]
    v_exp_f32 v123, v123
    v_pk_fma_f32 v[68:69], v[68:69], v[30:31], v[28:29] op_sel:[0,0,1] op_sel_hi:[1,0,1]
    v_rcp_f32 v116, v116
    v_pk_fma_f32 v[70:71], v[70:71], v[30:31], v[28:29] op_sel:[0,0,1] op_sel_hi:[1,0,1]
    v_pk_fma_f32 v[122:123], v[122:123], v[30:31], v[30:31] op_sel:[0,1,1] op_sel_hi:[1,1,1]
    v_rcp_f32 v117, v117
    v_pk_mul_f32 v[64:65], v[64:65], v[228:229]
    v_pk_mul_f32 v[66:67], v[66:67], v[230:231]
    v_rcp_f32 v118, v118
    v_pk_mul_f32 v[220:221], v[220:221], v[116:117]
    v_pk_mul_f32 v[68:69], v[68:69], v[232:233]
    v_rcp_f32 v119, v119
    v_pk_mul_f32 v[70:71], v[70:71], v[234:235]
    v_cvt_pk_bf16_f32 v76, v220, v221
    v_rcp_f32 v120, v120
    v_pk_mul_f32 v[222:223], v[222:223], v[118:119]
    v_pk_fma_f32 v[236:237], v[56:57], v[28:29], v[236:237] op_sel_hi:[1,0,1] neg_lo:[0,1,0] neg_hi:[0,1,0]
    v_rcp_f32 v121, v121
    v_pk_fma_f32 v[238:239], v[58:59], v[28:29], v[238:239] op_sel_hi:[1,0,1] neg_lo:[0,1,0] neg_hi:[0,1,0]
    v_rcp_f32 v122, v122
    v_cvt_pk_bf16_f32 v77, v222, v223
    v_pk_mul_f32 v[224:225], v[224:225], v[120:121]
    v_rcp_f32 v123, v123
    v_pk_mul_f32 v[124:125], v[236:237], v[236:237]
    v_pk_mul_f32 v[126:127], v[238:239], v[238:239]
    v_exp_f32 v64, v64
    v_pk_mul_f32 v[226:227], v[226:227], v[122:123]
    v_cvt_pk_bf16_f32 v78, v224, v225
    v_exp_f32 v65, v65
    v_pk_fma_f32 v[124:125], v[124:125], v[30:31], v[28:29] op_sel:[0,0,1] op_sel_hi:[1,0,1]
    v_cvt_pk_bf16_f32 v79, v226, v227
    v_exp_f32 v66, v66
    v_pk_fma_f32 v[64:65], v[64:65], v[30:31], v[30:31] op_sel:[0,1,1] op_sel_hi:[1,1,1]
    v_pk_fma_f32 v[126:127], v[126:127], v[30:31], v[28:29] op_sel:[0,0,1] op_sel_hi:[1,0,1]
    v_exp_f32 v67, v67
    buffer_store_dwordx4 v[76:79], v13, s[4:7], s30 offen offset:2048 sc1
    v_exp_f32 v68, v68
    v_pk_mul_f32 v[124:125], v[124:125], v[236:237]
    v_pk_fma_f32 v[66:67], v[66:67], v[30:31], v[30:31] op_sel:[0,1,1] op_sel_hi:[1,1,1]
    v_exp_f32 v69, v69
    v_pk_mul_f32 v[126:127], v[126:127], v[238:239]
    v_pk_fma_f32 v[184:185], v[32:33], v[24:25], v[184:185] op_sel_hi:[1,0,1] neg_lo:[0,1,0] neg_hi:[0,1,0]
    v_exp_f32 v70, v70
    v_pk_fma_f32 v[68:69], v[68:69], v[30:31], v[30:31] op_sel:[0,1,1] op_sel_hi:[1,1,1]
    v_pk_fma_f32 v[186:187], v[34:35], v[24:25], v[186:187] op_sel_hi:[1,0,1] neg_lo:[0,1,0] neg_hi:[0,1,0]
    v_exp_f32 v71, v71
    v_pk_fma_f32 v[188:189], v[36:37], v[24:25], v[188:189] op_sel_hi:[1,0,1] neg_lo:[0,1,0] neg_hi:[0,1,0]
    v_pk_fma_f32 v[190:191], v[38:39], v[24:25], v[190:191] op_sel_hi:[1,0,1] neg_lo:[0,1,0] neg_hi:[0,1,0]
    v_rcp_f32 v64, v64
    v_pk_fma_f32 v[70:71], v[70:71], v[30:31], v[30:31] op_sel:[0,1,1] op_sel_hi:[1,1,1]
    v_pk_mul_f32 v[116:117], v[184:185], v[184:185]
    v_rcp_f32 v65, v65
    v_pk_mul_f32 v[118:119], v[186:187], v[186:187]
    v_rcp_f32 v66, v66
    v_pk_mul_f32 v[120:121], v[188:189], v[188:189]
    v_pk_mul_f32 v[228:229], v[228:229], v[64:65]
    v_rcp_f32 v67, v67
    v_pk_mul_f32 v[122:123], v[190:191], v[190:191]
    v_pk_fma_f32 v[116:117], v[116:117], v[26:27], v[24:25] op_sel:[0,0,1] op_sel_hi:[1,0,1]
    v_rcp_f32 v68, v68
    v_pk_mul_f32 v[230:231], v[230:231], v[66:67]
    v_cvt_pk_bf16_f32 v80, v228, v229
    v_rcp_f32 v69, v69
    v_pk_fma_f32 v[118:119], v[118:119], v[26:27], v[24:25] op_sel:[0,0,1] op_sel_hi:[1,0,1]
    v_cvt_pk_bf16_f32 v81, v230, v231
    v_rcp_f32 v70, v70
    v_pk_mul_f32 v[232:233], v[232:233], v[68:69]
    v_pk_fma_f32 v[120:121], v[120:121], v[26:27], v[24:25] op_sel:[0,0,1] op_sel_hi:[1,0,1]
    v_rcp_f32 v71, v71
    v_pk_fma_f32 v[122:123], v[122:123], v[26:27], v[24:25] op_sel:[0,0,1] op_sel_hi:[1,0,1]
    v_exp_f32 v124, v124
    v_cvt_pk_bf16_f32 v82, v232, v233
    v_pk_mul_f32 v[234:235], v[234:235], v[70:71]
    v_exp_f32 v125, v125
    v_pk_mul_f32 v[116:117], v[116:117], v[184:185]
    v_pk_mul_f32 v[118:119], v[118:119], v[186:187]
    v_exp_f32 v126, v126
    v_cvt_pk_bf16_f32 v83, v234, v235
    v_pk_fma_f32 v[124:125], v[124:125], v[30:31], v[30:31] op_sel:[0,1,1] op_sel_hi:[1,1,1]
    v_exp_f32 v127, v127
    v_pk_mul_f32 v[120:121], v[120:121], v[188:189]
    buffer_store_dwordx4 v[80:83], v13, s[4:7], s31 offen offset:2048 sc1
    v_rcp_f32 v124, v124
    v_pk_fma_f32 v[126:127], v[126:127], v[30:31], v[30:31] op_sel:[0,1,1] op_sel_hi:[1,1,1]
    v_pk_mul_f32 v[122:123], v[122:123], v[190:191]
    v_rcp_f32 v125, v125
    v_pk_fma_f32 v[192:193], v[40:41], v[24:25], v[192:193] op_sel_hi:[1,0,1] neg_lo:[0,1,0] neg_hi:[0,1,0]
    v_rcp_f32 v126, v126
    v_pk_fma_f32 v[194:195], v[42:43], v[24:25], v[194:195] op_sel_hi:[1,0,1] neg_lo:[0,1,0] neg_hi:[0,1,0]
    v_pk_mul_f32 v[236:237], v[236:237], v[124:125]
    v_rcp_f32 v127, v127
    v_pk_fma_f32 v[196:197], v[44:45], v[24:25], v[196:197] op_sel_hi:[1,0,1] neg_lo:[0,1,0] neg_hi:[0,1,0]
    v_pk_fma_f32 v[198:199], v[46:47], v[24:25], v[198:199] op_sel_hi:[1,0,1] neg_lo:[0,1,0] neg_hi:[0,1,0]
    v_exp_f32 v116, v116
    v_pk_mul_f32 v[238:239], v[238:239], v[126:127]
    v_cvt_pk_bf16_f32 v102, v236, v237
    v_exp_f32 v117, v117
    v_pk_mul_f32 v[64:65], v[192:193], v[192:193]
    v_cvt_pk_bf16_f32 v103, v238, v239
    v_exp_f32 v118, v118
    v_pk_fma_f32 v[116:117], v[116:117], v[26:27], v[26:27] op_sel:[0,1,1] op_sel_hi:[1,1,1]
    v_exp_f32 v119, v119
    v_pk_mul_f32 v[66:67], v[194:195], v[194:195]
    v_pk_mul_f32 v[68:69], v[196:197], v[196:197]
    v_exp_f32 v120, v120
    v_pk_fma_f32 v[118:119], v[118:119], v[26:27], v[26:27] op_sel:[0,1,1] op_sel_hi:[1,1,1]
    v_pk_mul_f32 v[70:71], v[198:199], v[198:199]
    v_exp_f32 v121, v121
    v_pk_fma_f32 v[64:65], v[64:65], v[26:27], v[24:25] op_sel:[0,0,1] op_sel_hi:[1,0,1]
    v_pk_fma_f32 v[66:67], v[66:67], v[26:27], v[24:25] op_sel:[0,0,1] op_sel_hi:[1,0,1]
    v_exp_f32 v122, v122
    v_pk_fma_f32 v[120:121], v[120:121], v[26:27], v[26:27] op_sel:[0,1,1] op_sel_hi:[1,1,1]
    v_pk_fma_f32 v[68:69], v[68:69], v[26:27], v[24:25] op_sel:[0,0,1] op_sel_hi:[1,0,1]
    v_exp_f32 v123, v123
    v_pk_fma_f32 v[70:71], v[70:71], v[26:27], v[24:25] op_sel:[0,0,1] op_sel_hi:[1,0,1]
    v_pk_mul_f32 v[64:65], v[64:65], v[192:193]
    v_rcp_f32 v116, v116
    v_pk_fma_f32 v[122:123], v[122:123], v[26:27], v[26:27] op_sel:[0,1,1] op_sel_hi:[1,1,1]
    v_rcp_f32 v117, v117
    v_pk_mul_f32 v[66:67], v[66:67], v[194:195]
    v_pk_mul_f32 v[68:69], v[68:69], v[196:197]
    v_rcp_f32 v118, v118
    v_pk_mul_f32 v[184:185], v[184:185], v[116:117]
    v_pk_mul_f32 v[70:71], v[70:71], v[198:199]
    v_rcp_f32 v119, v119
    v_pk_fma_f32 v[200:201], v[48:49], v[24:25], v[200:201] op_sel_hi:[1,0,1] neg_lo:[0,1,0] neg_hi:[0,1,0]
    v_cvt_pk_bf16_f32 v84, v184, v185
    v_rcp_f32 v120, v120
    v_pk_mul_f32 v[186:187], v[186:187], v[118:119]
    v_pk_fma_f32 v[202:203], v[50:51], v[24:25], v[202:203] op_sel_hi:[1,0,1] neg_lo:[0,1,0] neg_hi:[0,1,0]
    v_rcp_f32 v121, v121
    v_pk_fma_f32 v[204:205], v[52:53], v[24:25], v[204:205] op_sel_hi:[1,0,1] neg_lo:[0,1,0] neg_hi:[0,1,0]
    v_cvt_pk_bf16_f32 v85, v186, v187
    v_rcp_f32 v122, v122
    v_pk_mul_f32 v[188:189], v[188:189], v[120:121]
    v_rcp_f32 v123, v123
    v_pk_fma_f32 v[206:207], v[54:55], v[24:25], v[206:207] op_sel_hi:[1,0,1] neg_lo:[0,1,0] neg_hi:[0,1,0]
    v_pk_mul_f32 v[116:117], v[200:201], v[200:201]
    v_exp_f32 v64, v64
    v_pk_mul_f32 v[190:191], v[190:191], v[122:123]
    v_cvt_pk_bf16_f32 v86, v188, v189
    v_exp_f32 v65, v65
    v_pk_mul_f32 v[118:119], v[202:203], v[202:203]
    v_cvt_pk_bf16_f32 v87, v190, v191
    v_exp_f32 v66, v66
    v_pk_fma_f32 v[64:65], v[64:65], v[26:27], v[26:27] op_sel:[0,1,1] op_sel_hi:[1,1,1]
    v_pk_mul_f32 v[120:121], v[204:205], v[204:205]
    v_exp_f32 v67, v67
    buffer_store_dwordx4 v[84:87], v13, s[4:7], s29 offen offset:0 sc1
    v_pk_mul_f32 v[122:123], v[206:207], v[206:207]
    v_exp_f32 v68, v68
    v_pk_fma_f32 v[66:67], v[66:67], v[26:27], v[26:27] op_sel:[0,1,1] op_sel_hi:[1,1,1]
    v_exp_f32 v69, v69
    v_pk_fma_f32 v[116:117], v[116:117], v[26:27], v[24:25] op_sel:[0,0,1] op_sel_hi:[1,0,1]
    v_pk_fma_f32 v[118:119], v[118:119], v[26:27], v[24:25] op_sel:[0,0,1] op_sel_hi:[1,0,1]
    v_exp_f32 v70, v70
    v_pk_fma_f32 v[68:69], v[68:69], v[26:27], v[26:27] op_sel:[0,1,1] op_sel_hi:[1,1,1]
    v_pk_fma_f32 v[120:121], v[120:121], v[26:27], v[24:25] op_sel:[0,0,1] op_sel_hi:[1,0,1]
    v_exp_f32 v71, v71
    v_pk_fma_f32 v[122:123], v[122:123], v[26:27], v[24:25] op_sel:[0,0,1] op_sel_hi:[1,0,1]
    v_pk_mul_f32 v[116:117], v[116:117], v[200:201]
    v_rcp_f32 v64, v64
    v_pk_fma_f32 v[70:71], v[70:71], v[26:27], v[26:27] op_sel:[0,1,1] op_sel_hi:[1,1,1]
    v_pk_mul_f32 v[118:119], v[118:119], v[202:203]
    v_rcp_f32 v65, v65
    v_pk_mul_f32 v[120:121], v[120:121], v[204:205]
    v_pk_mul_f32 v[122:123], v[122:123], v[206:207]
    v_rcp_f32 v66, v66
    v_pk_mul_f32 v[192:193], v[192:193], v[64:65]
    v_rcp_f32 v67, v67
    v_pk_fma_f32 v[208:209], v[56:57], v[24:25], v[208:209] op_sel_hi:[1,0,1] neg_lo:[0,1,0] neg_hi:[0,1,0]
    v_pk_fma_f32 v[210:211], v[58:59], v[24:25], v[210:211] op_sel_hi:[1,0,1] neg_lo:[0,1,0] neg_hi:[0,1,0]
    v_rcp_f32 v68, v68
    v_pk_mul_f32 v[194:195], v[194:195], v[66:67]
    v_cvt_pk_bf16_f32 v88, v192, v193
    v_rcp_f32 v69, v69
    v_pk_mul_f32 v[124:125], v[208:209], v[208:209]
    v_cvt_pk_bf16_f32 v89, v194, v195
    v_rcp_f32 v70, v70
    v_pk_mul_f32 v[196:197], v[196:197], v[68:69]
    v_pk_mul_f32 v[126:127], v[210:211], v[210:211]
    v_rcp_f32 v71, v71
    v_pk_fma_f32 v[124:125], v[124:125], v[26:27], v[24:25] op_sel:[0,0,1] op_sel_hi:[1,0,1]
    v_cvt_pk_bf16_f32 v90, v196, v197
    v_exp_f32 v116, v116
    v_pk_mul_f32 v[198:199], v[198:199], v[70:71]
    v_exp_f32 v117, v117
    v_pk_fma_f32 v[126:127], v[126:127], v[26:27], v[24:25] op_sel:[0,0,1] op_sel_hi:[1,0,1]
    v_pk_mul_f32 v[124:125], v[124:125], v[208:209]
    v_exp_f32 v118, v118
    v_cvt_pk_bf16_f32 v91, v198, v199
    v_pk_fma_f32 v[116:117], v[116:117], v[26:27], v[26:27] op_sel:[0,1,1] op_sel_hi:[1,1,1]
    v_exp_f32 v119, v119
    v_pk_mul_f32 v[126:127], v[126:127], v[210:211]
    buffer_store_dwordx4 v[88:91], v13, s[4:7], s30 offen offset:0 sc1
    v_exp_f32 v120, v120
    v_pk_fma_f32 v[118:119], v[118:119], v[26:27], v[26:27] op_sel:[0,1,1] op_sel_hi:[1,1,1]
    v_pk_fma_f32 v[156:157], v[32:33], v[20:21], v[156:157] op_sel_hi:[1,0,1] neg_lo:[0,1,0] neg_hi:[0,1,0]
    v_exp_f32 v121, v121
    v_pk_fma_f32 v[158:159], v[34:35], v[20:21], v[158:159] op_sel_hi:[1,0,1] neg_lo:[0,1,0] neg_hi:[0,1,0]
    v_pk_fma_f32 v[160:161], v[36:37], v[20:21], v[160:161] op_sel_hi:[1,0,1] neg_lo:[0,1,0] neg_hi:[0,1,0]
    v_exp_f32 v122, v122
    v_pk_fma_f32 v[120:121], v[120:121], v[26:27], v[26:27] op_sel:[0,1,1] op_sel_hi:[1,1,1]
    v_exp_f32 v123, v123
    v_pk_fma_f32 v[162:163], v[38:39], v[20:21], v[162:163] op_sel_hi:[1,0,1] neg_lo:[0,1,0] neg_hi:[0,1,0]
    v_pk_mul_f32 v[64:65], v[156:157], v[156:157]
    v_rcp_f32 v116, v116
    v_pk_fma_f32 v[122:123], v[122:123], v[26:27], v[26:27] op_sel:[0,1,1] op_sel_hi:[1,1,1]
    v_pk_mul_f32 v[66:67], v[158:159], v[158:159]
    v_rcp_f32 v117, v117
    v_pk_mul_f32 v[68:69], v[160:161], v[160:161]
    v_pk_mul_f32 v[70:71], v[162:163], v[162:163]
    v_rcp_f32 v118, v118
    v_pk_mul_f32 v[200:201], v[200:201], v[116:117]
    v_pk_fma_f32 v[64:65], v[64:65], v[22:23], v[20:21] op_sel:[0,0,1] op_sel_hi:[1,0,1]
    v_rcp_f32 v119, v119
    v_pk_fma_f32 v[66:67], v[66:67], v[22:23], v[20:21] op_sel:[0,0,1] op_sel_hi:[1,0,1]
    v_cvt_pk_bf16_f32 v92, v200, v201
    v_rcp_f32 v120, v120
    v_pk_mul_f32 v[202:203], v[202:203], v[118:119]
    v_rcp_f32 v121, v121
    v_pk_fma_f32 v[68:69], v[68:69], v[22:23], v[20:21] op_sel:[0,0,1] op_sel_hi:[1,0,1]
    v_pk_fma_f32 v[70:71], v[70:71], v[22:23], v[20:21] op_sel:[0,0,1] op_sel_hi:[1,0,1]
    v_rcp_f32 v122, v122
    v_pk_mul_f32 v[204:205], v[204:205], v[120:121]
    v_cvt_pk_bf16_f32 v93, v202, v203
    v_rcp_f32 v123, v123
    v_pk_mul_f32 v[64:65], v[64:65], v[156:157]
    v_cvt_pk_bf16_f32 v94, v204, v205
    v_exp_f32 v124, v124
    v_pk_mul_f32 v[206:207], v[206:207], v[122:123]
    v_pk_mul_f32 v[66:67], v[66:67], v[158:159]
    v_exp_f32 v125, v125
    v_pk_mul_f32 v[68:69], v[68:69], v[160:161]
    v_cvt_pk_bf16_f32 v95, v206, v207
    v_exp_f32 v126, v126
    v_pk_fma_f32 v[124:125], v[124:125], v[26:27], v[26:27] op_sel:[0,1,1] op_sel_hi:[1,1,1]
    v_exp_f32 v127, v127
    buffer_store_dwordx4 v[92:95], v13, s[4:7], s31 offen offset:0 sc1
    v_pk_mul_f32 v[70:71], v[70:71], v[162:163]
    v_rcp_f32 v124, v124
    v_pk_fma_f32 v[126:127], v[126:127], v[26:27], v[26:27] op_sel:[0,1,1] op_sel_hi:[1,1,1]
    v_pk_fma_f32 v[164:165], v[40:41], v[20:21], v[164:165] op_sel_hi:[1,0,1] neg_lo:[0,1,0] neg_hi:[0,1,0]
    v_rcp_f32 v125, v125
    v_pk_fma_f32 v[166:167], v[42:43], v[20:21], v[166:167] op_sel_hi:[1,0,1] neg_lo:[0,1,0] neg_hi:[0,1,0]
    v_pk_fma_f32 v[168:169], v[44:45], v[20:21], v[168:169] op_sel_hi:[1,0,1] neg_lo:[0,1,0] neg_hi:[0,1,0]
    v_rcp_f32 v126, v126
    v_pk_mul_f32 v[208:209], v[208:209], v[124:125]
    v_pk_fma_f32 v[170:171], v[46:47], v[20:21], v[170:171] op_sel_hi:[1,0,1] neg_lo:[0,1,0] neg_hi:[0,1,0]
    v_rcp_f32 v127, v127
    v_pk_mul_f32 v[116:117], v[164:165], v[164:165]
    v_exp_f32 v64, v64
    v_cvt_pk_bf16_f32 v100, v208, v209
    v_pk_mul_f32 v[210:211], v[210:211], v[126:127]
    v_exp_f32 v65, v65
    v_pk_mul_f32 v[118:119], v[166:167], v[166:167]
    v_permlane16_swap_b32 v100, v102
    v_exp_f32 v66, v66
    v_cvt_pk_bf16_f32 v101, v210, v211
    v_pk_fma_f32 v[64:65], v[64:65], v[22:23], v[22:23] op_sel:[0,1,1] op_sel_hi:[1,1,1]
    v_exp_f32 v67, v67
    v_pk_mul_f32 v[120:121], v[168:169], v[168:169]
    v_permlane16_swap_b32 v101, v103
    v_exp_f32 v68, v68
    v_pk_fma_f32 v[66:67], v[66:67], v[22:23], v[22:23] op_sel:[0,1,1] op_sel_hi:[1,1,1]
    v_pk_mul_f32 v[122:123], v[170:171], v[170:171]
    v_exp_f32 v69, v69
    buffer_store_dwordx4 v[100:103], v8, s[4:7], s34 offen sc1
    v_exp_f32 v70, v70
    v_pk_fma_f32 v[116:117], v[116:117], v[22:23], v[20:21] op_sel:[0,0,1] op_sel_hi:[1,0,1]
    v_pk_fma_f32 v[68:69], v[68:69], v[22:23], v[22:23] op_sel:[0,1,1] op_sel_hi:[1,1,1]
    v_exp_f32 v71, v71
    v_pk_fma_f32 v[118:119], v[118:119], v[22:23], v[20:21] op_sel:[0,0,1] op_sel_hi:[1,0,1]
    v_pk_fma_f32 v[120:121], v[120:121], v[22:23], v[20:21] op_sel:[0,0,1] op_sel_hi:[1,0,1]
    v_rcp_f32 v64, v64
    v_pk_fma_f32 v[70:71], v[70:71], v[22:23], v[22:23] op_sel:[0,1,1] op_sel_hi:[1,1,1]
    v_pk_fma_f32 v[122:123], v[122:123], v[22:23], v[20:21] op_sel:[0,0,1] op_sel_hi:[1,0,1]
    v_rcp_f32 v65, v65
    v_pk_mul_f32 v[116:117], v[116:117], v[164:165]
    v_pk_mul_f32 v[118:119], v[118:119], v[166:167]
    v_rcp_f32 v66, v66
    v_pk_mul_f32 v[156:157], v[156:157], v[64:65]
    v_pk_mul_f32 v[120:121], v[120:121], v[168:169]
    v_rcp_f32 v67, v67
    v_pk_mul_f32 v[122:123], v[122:123], v[170:171]
    v_rcp_f32 v68, v68
    v_cvt_pk_bf16_f32 v72, v156, v157
    v_pk_mul_f32 v[158:159], v[158:159], v[66:67]
    v_rcp_f32 v69, v69
    v_pk_fma_f32 v[172:173], v[48:49], v[20:21], v[172:173] op_sel_hi:[1,0,1] neg_lo:[0,1,0] neg_hi:[0,1,0]
    v_pk_fma_f32 v[174:175], v[50:51], v[20:21], v[174:175] op_sel_hi:[1,0,1] neg_lo:[0,1,0] neg_hi:[0,1,0]
    v_rcp_f32 v70, v70
    v_pk_mul_f32 v[160:161], v[160:161], v[68:69]
    v_cvt_pk_bf16_f32 v73, v158, v159
    v_rcp_f32 v71, v71
    v_pk_fma_f32 v[176:177], v[52:53], v[20:21], v[176:177] op_sel_hi:[1,0,1] neg_lo:[0,1,0] neg_hi:[0,1,0]
    v_cvt_pk_bf16_f32 v74, v160, v161
    v_exp_f32 v116, v116
    v_pk_mul_f32 v[162:163], v[162:163], v[70:71]
    v_pk_fma_f32 v[178:179], v[54:55], v[20:21], v[178:179] op_sel_hi:[1,0,1] neg_lo:[0,1,0] neg_hi:[0,1,0]
    v_exp_f32 v117, v117
    v_pk_mul_f32 v[64:65], v[172:173], v[172:173]
    v_exp_f32 v118, v118
    v_cvt_pk_bf16_f32 v75, v162, v163
    v_pk_fma_f32 v[116:117], v[116:117], v[22:23], v[22:23] op_sel:[0,1,1] op_sel_hi:[1,1,1]
    v_exp_f32 v119, v119
    v_pk_mul_f32 v[66:67], v[174:175], v[174:175]
    buffer_store_dwordx4 v[72:75], v10, s[4:7], s29 offen offset:2048 sc1
    v_exp_f32 v120, v120
    v_pk_fma_f32 v[118:119], v[118:119], v[22:23], v[22:23] op_sel:[0,1,1] op_sel_hi:[1,1,1]
    v_pk_mul_f32 v[68:69], v[176:177], v[176:177]
    v_exp_f32 v121, v121
    v_pk_mul_f32 v[70:71], v[178:179], v[178:179]
    v_pk_fma_f32 v[64:65], v[64:65], v[22:23], v[20:21] op_sel:[0,0,1] op_sel_hi:[1,0,1]
    v_exp_f32 v122, v122
    v_pk_fma_f32 v[120:121], v[120:121], v[22:23], v[22:23] op_sel:[0,1,1] op_sel_hi:[1,1,1]
    v_pk_fma_f32 v[66:67], v[66:67], v[22:23], v[20:21] op_sel:[0,0,1] op_sel_hi:[1,0,1]
    v_exp_f32 v123, v123
    v_pk_fma_f32 v[68:69], v[68:69], v[22:23], v[20:21] op_sel:[0,0,1] op_sel_hi:[1,0,1]
    v_rcp_f32 v116, v116
    v_pk_fma_f32 v[70:71], v[70:71], v[22:23], v[20:21] op_sel:[0,0,1] op_sel_hi:[1,0,1]
    v_pk_fma_f32 v[122:123], v[122:123], v[22:23], v[22:23] op_sel:[0,1,1] op_sel_hi:[1,1,1]
    v_rcp_f32 v117, v117
    v_pk_mul_f32 v[64:65], v[64:65], v[172:173]
    v_pk_mul_f32 v[66:67], v[66:67], v[174:175]
    v_rcp_f32 v118, v118
    v_pk_mul_f32 v[164:165], v[164:165], v[116:117]
    v_pk_mul_f32 v[68:69], v[68:69], v[176:177]
    v_rcp_f32 v119, v119
    v_pk_mul_f32 v[70:71], v[70:71], v[178:179]
    v_cvt_pk_bf16_f32 v76, v164, v165
    v_rcp_f32 v120, v120
    v_pk_mul_f32 v[166:167], v[166:167], v[118:119]
    v_pk_fma_f32 v[180:181], v[56:57], v[20:21], v[180:181] op_sel_hi:[1,0,1] neg_lo:[0,1,0] neg_hi:[0,1,0]
    v_rcp_f32 v121, v121
    v_pk_fma_f32 v[182:183], v[58:59], v[20:21], v[182:183] op_sel_hi:[1,0,1] neg_lo:[0,1,0] neg_hi:[0,1,0]
    v_rcp_f32 v122, v122
    v_cvt_pk_bf16_f32 v77, v166, v167
    v_pk_mul_f32 v[168:169], v[168:169], v[120:121]
    v_rcp_f32 v123, v123
    v_pk_mul_f32 v[124:125], v[180:181], v[180:181]
    v_pk_mul_f32 v[126:127], v[182:183], v[182:183]
    v_exp_f32 v64, v64
    v_pk_mul_f32 v[170:171], v[170:171], v[122:123]
    v_cvt_pk_bf16_f32 v78, v168, v169
    v_exp_f32 v65, v65
    v_pk_fma_f32 v[124:125], v[124:125], v[22:23], v[20:21] op_sel:[0,0,1] op_sel_hi:[1,0,1]
    v_cvt_pk_bf16_f32 v79, v170, v171
    v_exp_f32 v66, v66
    v_pk_fma_f32 v[64:65], v[64:65], v[22:23], v[22:23] op_sel:[0,1,1] op_sel_hi:[1,1,1]
    v_pk_fma_f32 v[126:127], v[126:127], v[22:23], v[20:21] op_sel:[0,0,1] op_sel_hi:[1,0,1]
    v_exp_f32 v67, v67
    buffer_store_dwordx4 v[76:79], v10, s[4:7], s30 offen offset:2048 sc1
    v_exp_f32 v68, v68
    v_pk_mul_f32 v[124:125], v[124:125], v[180:181]
    v_pk_fma_f32 v[66:67], v[66:67], v[22:23], v[22:23] op_sel:[0,1,1] op_sel_hi:[1,1,1]
    v_exp_f32 v69, v69
    v_pk_mul_f32 v[126:127], v[126:127], v[182:183]
    v_pk_fma_f32 v[128:129], v[32:33], v[16:17], v[128:129] op_sel_hi:[1,0,1] neg_lo:[0,1,0] neg_hi:[0,1,0]
    v_exp_f32 v70, v70
    v_pk_fma_f32 v[68:69], v[68:69], v[22:23], v[22:23] op_sel:[0,1,1] op_sel_hi:[1,1,1]
    v_pk_fma_f32 v[130:131], v[34:35], v[16:17], v[130:131] op_sel_hi:[1,0,1] neg_lo:[0,1,0] neg_hi:[0,1,0]
    v_exp_f32 v71, v71
    v_pk_fma_f32 v[132:133], v[36:37], v[16:17], v[132:133] op_sel_hi:[1,0,1] neg_lo:[0,1,0] neg_hi:[0,1,0]
    v_pk_fma_f32 v[134:135], v[38:39], v[16:17], v[134:135] op_sel_hi:[1,0,1] neg_lo:[0,1,0] neg_hi:[0,1,0]
    v_rcp_f32 v64, v64
    v_pk_fma_f32 v[70:71], v[70:71], v[22:23], v[22:23] op_sel:[0,1,1] op_sel_hi:[1,1,1]
    v_pk_mul_f32 v[116:117], v[128:129], v[128:129]
    v_rcp_f32 v65, v65
    v_pk_mul_f32 v[118:119], v[130:131], v[130:131]
    v_rcp_f32 v66, v66
    v_pk_mul_f32 v[120:121], v[132:133], v[132:133]
    v_pk_mul_f32 v[172:173], v[172:173], v[64:65]
    v_rcp_f32 v67, v67
    v_pk_mul_f32 v[122:123], v[134:135], v[134:135]
    v_pk_fma_f32 v[116:117], v[116:117], v[18:19], v[16:17] op_sel:[0,0,1] op_sel_hi:[1,0,1]
    v_rcp_f32 v68, v68
    v_pk_mul_f32 v[174:175], v[174:175], v[66:67]
    v_cvt_pk_bf16_f32 v80, v172, v173
    v_rcp_f32 v69, v69
    v_pk_fma_f32 v[118:119], v[118:119], v[18:19], v[16:17] op_sel:[0,0,1] op_sel_hi:[1,0,1]
    v_cvt_pk_bf16_f32 v81, v174, v175
    v_rcp_f32 v70, v70
    v_pk_mul_f32 v[176:177], v[176:177], v[68:69]
    v_pk_fma_f32 v[120:121], v[120:121], v[18:19], v[16:17] op_sel:[0,0,1] op_sel_hi:[1,0,1]
    v_rcp_f32 v71, v71
    v_pk_fma_f32 v[122:123], v[122:123], v[18:19], v[16:17] op_sel:[0,0,1] op_sel_hi:[1,0,1]
    v_exp_f32 v124, v124
    v_cvt_pk_bf16_f32 v82, v176, v177
    v_pk_mul_f32 v[178:179], v[178:179], v[70:71]
    v_exp_f32 v125, v125
    v_pk_mul_f32 v[116:117], v[116:117], v[128:129]
    v_pk_mul_f32 v[118:119], v[118:119], v[130:131]
    v_exp_f32 v126, v126
    v_cvt_pk_bf16_f32 v83, v178, v179
    v_pk_fma_f32 v[124:125], v[124:125], v[22:23], v[22:23] op_sel:[0,1,1] op_sel_hi:[1,1,1]
    v_mov_b32 v104, v14
    v_xor_b32 v105, 2048, v14
    v_mov_b32 v106, v15
    v_xor_b32 v107, 32, v15
    v_xor_b32 v108, 64, v15
    v_xor_b32 v109, 96, v15
    s_barrier
    s_add_u32 s48, s23, 46923776
    s_mov_b32 s49, 1
    ds_read_b64_tr_b16 v[224:225], v106 offset:16384
    ds_read_b64_tr_b16 v[226:227], v106 offset:18432
    ds_read_b128 v[192:195], v104 offset:0
    ds_read_b128 v[196:199], v104 offset:1024
    ds_read_b128 v[200:203], v105 offset:0
    ds_read_b128 v[204:207], v105 offset:1024
    ds_read_b64_tr_b16 v[228:229], v107 offset:16384
    ds_read_b64_tr_b16 v[230:231], v107 offset:18432
    ds_read_b64_tr_b16 v[232:233], v108 offset:16384
    ds_read_b64_tr_b16 v[234:235], v108 offset:18432
    ds_read_b64_tr_b16 v[236:237], v109 offset:16384
    ds_read_b64_tr_b16 v[238:239], v109 offset:18432
    v_exp_f32 v127, v127
    v_pk_mul_f32 v[120:121], v[120:121], v[132:133]
    buffer_store_dwordx4 v[80:83], v10, s[4:7], s31 offen offset:2048 sc1
    v_rcp_f32 v124, v124
    v_pk_fma_f32 v[126:127], v[126:127], v[22:23], v[22:23] op_sel:[0,1,1] op_sel_hi:[1,1,1]
    v_pk_mul_f32 v[122:123], v[122:123], v[134:135]
    v_rcp_f32 v125, v125
    v_pk_fma_f32 v[136:137], v[40:41], v[16:17], v[136:137] op_sel_hi:[1,0,1] neg_lo:[0,1,0] neg_hi:[0,1,0]
    v_rcp_f32 v126, v126
    v_pk_fma_f32 v[138:139], v[42:43], v[16:17], v[138:139] op_sel_hi:[1,0,1] neg_lo:[0,1,0] neg_hi:[0,1,0]
    v_pk_mul_f32 v[180:181], v[180:181], v[124:125]
    v_rcp_f32 v127, v127
    v_pk_fma_f32 v[140:141], v[44:45], v[16:17], v[140:141] op_sel_hi:[1,0,1] neg_lo:[0,1,0] neg_hi:[0,1,0]
    v_pk_fma_f32 v[142:143], v[46:47], v[16:17], v[142:143] op_sel_hi:[1,0,1] neg_lo:[0,1,0] neg_hi:[0,1,0]
    v_exp_f32 v116, v116
    v_pk_mul_f32 v[182:183], v[182:183], v[126:127]
    v_cvt_pk_bf16_f32 v98, v180, v181
    v_exp_f32 v117, v117
    v_pk_mul_f32 v[64:65], v[136:137], v[136:137]
    v_cvt_pk_bf16_f32 v99, v182, v183
    v_exp_f32 v118, v118
    v_pk_fma_f32 v[116:117], v[116:117], v[18:19], v[18:19] op_sel:[0,1,1] op_sel_hi:[1,1,1]
    v_exp_f32 v119, v119
    v_pk_mul_f32 v[66:67], v[138:139], v[138:139]
    v_pk_mul_f32 v[68:69], v[140:141], v[140:141]
    v_exp_f32 v120, v120
    v_pk_fma_f32 v[118:119], v[118:119], v[18:19], v[18:19] op_sel:[0,1,1] op_sel_hi:[1,1,1]
    v_pk_mul_f32 v[70:71], v[142:143], v[142:143]
    v_exp_f32 v121, v121
    v_pk_fma_f32 v[64:65], v[64:65], v[18:19], v[16:17] op_sel:[0,0,1] op_sel_hi:[1,0,1]
    v_pk_fma_f32 v[66:67], v[66:67], v[18:19], v[16:17] op_sel:[0,0,1] op_sel_hi:[1,0,1]
    v_exp_f32 v122, v122
    v_pk_fma_f32 v[120:121], v[120:121], v[18:19], v[18:19] op_sel:[0,1,1] op_sel_hi:[1,1,1]
    v_pk_fma_f32 v[68:69], v[68:69], v[18:19], v[16:17] op_sel:[0,0,1] op_sel_hi:[1,0,1]
    v_exp_f32 v123, v123
    v_pk_fma_f32 v[70:71], v[70:71], v[18:19], v[16:17] op_sel:[0,0,1] op_sel_hi:[1,0,1]
    v_pk_mul_f32 v[64:65], v[64:65], v[136:137]
    v_rcp_f32 v116, v116
    v_pk_fma_f32 v[122:123], v[122:123], v[18:19], v[18:19] op_sel:[0,1,1] op_sel_hi:[1,1,1]
    v_rcp_f32 v117, v117
    v_pk_mul_f32 v[66:67], v[66:67], v[138:139]
    v_pk_mul_f32 v[68:69], v[68:69], v[140:141]
    v_rcp_f32 v118, v118
    v_pk_mul_f32 v[128:129], v[128:129], v[116:117]
    v_pk_mul_f32 v[70:71], v[70:71], v[142:143]
    v_rcp_f32 v119, v119
    v_pk_fma_f32 v[144:145], v[48:49], v[16:17], v[144:145] op_sel_hi:[1,0,1] neg_lo:[0,1,0] neg_hi:[0,1,0]
    v_cvt_pk_bf16_f32 v84, v128, v129
    v_rcp_f32 v120, v120
    v_pk_mul_f32 v[130:131], v[130:131], v[118:119]
    v_pk_fma_f32 v[146:147], v[50:51], v[16:17], v[146:147] op_sel_hi:[1,0,1] neg_lo:[0,1,0] neg_hi:[0,1,0]
    v_rcp_f32 v121, v121
    v_pk_fma_f32 v[148:149], v[52:53], v[16:17], v[148:149] op_sel_hi:[1,0,1] neg_lo:[0,1,0] neg_hi:[0,1,0]
    v_cvt_pk_bf16_f32 v85, v130, v131
    v_rcp_f32 v122, v122
    v_pk_mul_f32 v[132:133], v[132:133], v[120:121]
    v_rcp_f32 v123, v123
    v_pk_fma_f32 v[150:151], v[54:55], v[16:17], v[150:151] op_sel_hi:[1,0,1] neg_lo:[0,1,0] neg_hi:[0,1,0]
    v_pk_mul_f32 v[116:117], v[144:145], v[144:145]
    v_exp_f32 v64, v64
    v_pk_mul_f32 v[134:135], v[134:135], v[122:123]
    v_cvt_pk_bf16_f32 v86, v132, v133
    v_exp_f32 v65, v65
    v_pk_mul_f32 v[118:119], v[146:147], v[146:147]
    v_cvt_pk_bf16_f32 v87, v134, v135
    v_exp_f32 v66, v66
    v_pk_fma_f32 v[64:65], v[64:65], v[18:19], v[18:19] op_sel:[0,1,1] op_sel_hi:[1,1,1]
    v_pk_mul_f32 v[120:121], v[148:149], v[148:149]
    v_exp_f32 v67, v67
    buffer_store_dwordx4 v[84:87], v10, s[4:7], s29 offen offset:0 sc1
    v_pk_mul_f32 v[122:123], v[150:151], v[150:151]
    v_exp_f32 v68, v68
    v_pk_fma_f32 v[66:67], v[66:67], v[18:19], v[18:19] op_sel:[0,1,1] op_sel_hi:[1,1,1]
    v_exp_f32 v69, v69
    v_pk_fma_f32 v[116:117], v[116:117], v[18:19], v[16:17] op_sel:[0,0,1] op_sel_hi:[1,0,1]
    v_pk_fma_f32 v[118:119], v[118:119], v[18:19], v[16:17] op_sel:[0,0,1] op_sel_hi:[1,0,1]
    v_exp_f32 v70, v70
    v_pk_fma_f32 v[68:69], v[68:69], v[18:19], v[18:19] op_sel:[0,1,1] op_sel_hi:[1,1,1]
    v_pk_fma_f32 v[120:121], v[120:121], v[18:19], v[16:17] op_sel:[0,0,1] op_sel_hi:[1,0,1]
    v_exp_f32 v71, v71
    v_pk_fma_f32 v[122:123], v[122:123], v[18:19], v[16:17] op_sel:[0,0,1] op_sel_hi:[1,0,1]
    v_pk_mul_f32 v[116:117], v[116:117], v[144:145]
    v_rcp_f32 v64, v64
    v_pk_fma_f32 v[70:71], v[70:71], v[18:19], v[18:19] op_sel:[0,1,1] op_sel_hi:[1,1,1]
    v_pk_mul_f32 v[118:119], v[118:119], v[146:147]
    v_rcp_f32 v65, v65
    v_pk_mul_f32 v[120:121], v[120:121], v[148:149]
    v_pk_mul_f32 v[122:123], v[122:123], v[150:151]
    v_rcp_f32 v66, v66
    v_pk_mul_f32 v[136:137], v[136:137], v[64:65]
    v_rcp_f32 v67, v67
    v_pk_fma_f32 v[152:153], v[56:57], v[16:17], v[152:153] op_sel_hi:[1,0,1] neg_lo:[0,1,0] neg_hi:[0,1,0]
    v_pk_fma_f32 v[154:155], v[58:59], v[16:17], v[154:155] op_sel_hi:[1,0,1] neg_lo:[0,1,0] neg_hi:[0,1,0]
    v_rcp_f32 v68, v68
    v_pk_mul_f32 v[138:139], v[138:139], v[66:67]
    v_cvt_pk_bf16_f32 v88, v136, v137
    v_rcp_f32 v69, v69
    v_pk_mul_f32 v[124:125], v[152:153], v[152:153]
    v_cvt_pk_bf16_f32 v89, v138, v139
    v_rcp_f32 v70, v70
    v_pk_mul_f32 v[140:141], v[140:141], v[68:69]
    v_pk_mul_f32 v[126:127], v[154:155], v[154:155]
    v_rcp_f32 v71, v71
    v_pk_fma_f32 v[124:125], v[124:125], v[18:19], v[16:17] op_sel:[0,0,1] op_sel_hi:[1,0,1]
    v_cvt_pk_bf16_f32 v90, v140, v141
    v_exp_f32 v116, v116
    v_pk_mul_f32 v[142:143], v[142:143], v[70:71]
    v_exp_f32 v117, v117
    v_pk_fma_f32 v[126:127], v[126:127], v[18:19], v[16:17] op_sel:[0,0,1] op_sel_hi:[1,0,1]
    v_pk_mul_f32 v[124:125], v[124:125], v[152:153]
    v_exp_f32 v118, v118
    v_cvt_pk_bf16_f32 v91, v142, v143
    v_pk_fma_f32 v[116:117], v[116:117], v[18:19], v[18:19] op_sel:[0,1,1] op_sel_hi:[1,1,1]
    v_exp_f32 v119, v119
    v_pk_mul_f32 v[126:127], v[126:127], v[154:155]
    buffer_store_dwordx4 v[88:91], v10, s[4:7], s30 offen offset:0 sc1
    v_exp_f32 v120, v120
    v_exp_f32 v121, v121
    v_pk_fma_f32 v[118:119], v[118:119], v[18:19], v[18:19] op_sel:[0,1,1] op_sel_hi:[1,1,1]
    v_exp_f32 v122, v122
    v_exp_f32 v123, v123
    v_pk_fma_f32 v[120:121], v[120:121], v[18:19], v[18:19] op_sel:[0,1,1] op_sel_hi:[1,1,1]
    v_rcp_f32 v116, v116
    v_rcp_f32 v117, v117
    v_rcp_f32 v118, v118
    v_pk_fma_f32 v[122:123], v[122:123], v[18:19], v[18:19] op_sel:[0,1,1] op_sel_hi:[1,1,1]
    v_rcp_f32 v119, v119
    v_pk_mul_f32 v[144:145], v[144:145], v[116:117]
    v_rcp_f32 v120, v120
    v_rcp_f32 v121, v121
    v_rcp_f32 v122, v122
    v_pk_mul_f32 v[146:147], v[146:147], v[118:119]
    v_rcp_f32 v123, v123
    v_pk_mul_f32 v[148:149], v[148:149], v[120:121]
    v_cvt_pk_bf16_f32 v92, v144, v145
    v_exp_f32 v124, v124
    v_pk_mul_f32 v[150:151], v[150:151], v[122:123]
    v_cvt_pk_bf16_f32 v93, v146, v147
    v_exp_f32 v125, v125
    v_cvt_pk_bf16_f32 v94, v148, v149
    v_cvt_pk_bf16_f32 v95, v150, v151
    v_exp_f32 v126, v126
    v_exp_f32 v127, v127
    v_pk_fma_f32 v[124:125], v[124:125], v[18:19], v[18:19] op_sel:[0,1,1] op_sel_hi:[1,1,1]
    buffer_store_dwordx4 v[92:95], v10, s[4:7], s31 offen offset:0 sc1
    v_rcp_f32 v124, v124
    v_pk_fma_f32 v[126:127], v[126:127], v[18:19], v[18:19] op_sel:[0,1,1] op_sel_hi:[1,1,1]
    v_rcp_f32 v125, v125
    v_rcp_f32 v126, v126
    v_pk_mul_f32 v[152:153], v[152:153], v[124:125]
    v_rcp_f32 v127, v127
    v_cvt_pk_bf16_f32 v96, v152, v153
    v_pk_mul_f32 v[154:155], v[154:155], v[126:127]
    s_nop 0
    v_cvt_pk_bf16_f32 v97, v154, v155
    v_permlane16_swap_b32 v96, v98
    s_nop 0
    v_permlane16_swap_b32 v97, v99
    s_nop 0
    buffer_store_dwordx4 v[96:99], v8, s[4:7], s33 offen sc1
    s_waitcnt vmcnt(14)
    s_waitcnt lgkmcnt(5)
    v_mfma_f32_16x16x32_bf16 v[128:131], v[224:227], v[192:195], 0
    ds_read_b64_tr_b16 v[32:33], v106 offset:20480
    v_add_u32 v110, 0x10000, v104
    v_mfma_f32_16x16x32_bf16 v[144:147], v[224:227], v[196:199], 0
    ds_read_b64_tr_b16 v[34:35], v106 offset:22528
    v_add_u32 v111, 0x10000, v105
    v_mfma_f32_16x16x32_bf16 v[160:163], v[224:227], v[200:203], 0
    ds_read_b128 v[208:211], v104 offset:8192
    v_add_u32 v112, 0x10000, v106
    v_mfma_f32_16x16x32_bf16 v[176:179], v[224:227], v[204:207], 0
    ds_read_b128 v[212:215], v104 offset:9216
    s_waitcnt lgkmcnt(5)
    v_mfma_f32_16x16x32_bf16 v[180:183], v[228:231], v[204:207], 0
    ds_read_b128 v[216:219], v105 offset:8192
    v_add_u32 v113, 0x10000, v107
    v_mfma_f32_16x16x32_bf16 v[164:167], v[228:231], v[200:203], 0
    ds_read_b128 v[220:223], v105 offset:9216
    v_add_u32 v114, 0x10000, v108
    v_mfma_f32_16x16x32_bf16 v[148:151], v[228:231], v[196:199], 0
    ds_read_b64_tr_b16 v[36:37], v107 offset:20480
    v_add_u32 v115, 0x10000, v109
    v_mfma_f32_16x16x32_bf16 v[132:135], v[228:231], v[192:195], 0
    ds_read_b64_tr_b16 v[38:39], v107 offset:22528
    v_mov_b32 v8, 0xffff0000
    v_mfma_f32_16x16x32_bf16 v[136:139], v[232:235], v[192:195], 0
    ds_read_b64_tr_b16 v[40:41], v108 offset:20480
    v_sub_f32 v60, 1.0, v60
    v_mfma_f32_16x16x32_bf16 v[152:155], v[232:235], v[196:199], 0
    ds_read_b64_tr_b16 v[42:43], v108 offset:22528
    v_sub_f32 v61, 1.0, v61
    v_mfma_f32_16x16x32_bf16 v[168:171], v[232:235], v[200:203], 0
    ds_read_b64_tr_b16 v[44:45], v109 offset:20480
    v_mfma_f32_16x16x32_bf16 v[184:187], v[232:235], v[204:207], 0
    ds_read_b64_tr_b16 v[46:47], v109 offset:22528
    s_waitcnt lgkmcnt(5)
    v_mfma_f32_16x16x32_bf16 v[188:191], v[236:239], v[204:207], 0
    v_cvt_pk_bf16_f32 v60, v60, v60
    v_cvt_pk_bf16_f32 v61, v61, v61
    v_mfma_f32_16x16x32_bf16 v[172:175], v[236:239], v[200:203], 0
    v_and_b32 v60, v8, v60
    v_mfma_f32_16x16x32_bf16 v[156:159], v[236:239], v[196:199], 0
    v_and_b32 v61, v8, v61
    v_mfma_f32_16x16x32_bf16 v[140:143], v[236:239], v[192:195], 0
    v_lshlrev_b32 v64, 16, v240
    v_mfma_f32_16x16x32_bf16 v[128:131], v[32:35], v[208:211], v[128:131]
    v_and_b32 v65, v8, v240
    v_mfma_f32_16x16x32_bf16 v[144:147], v[32:35], v[212:215], v[144:147]
    s_waitcnt lgkmcnt(0)
    v_mfma_f32_16x16x32_bf16 v[160:163], v[32:35], v[216:219], v[160:163]
    s_barrier
    v_mfma_f32_16x16x32_bf16 v[176:179], v[32:35], v[220:223], v[176:179]
    ds_read_b64_tr_b16 v[224:225], v106 offset:49152
    v_mul_f32 v64, v64, v60
    v_mfma_f32_16x16x32_bf16 v[180:183], v[36:39], v[220:223], v[180:183]
    ds_read_b64_tr_b16 v[226:227], v106 offset:51200
    v_mul_f32 v65, v65, v60
    v_mfma_f32_16x16x32_bf16 v[164:167], v[36:39], v[216:219], v[164:167]
    ds_read_b128 v[192:195], v104 offset:32768
    v_mfma_f32_16x16x32_bf16 v[148:151], v[36:39], v[212:215], v[148:151]
    ds_read_b128 v[196:199], v104 offset:33792
    v_lshlrev_b32 v66, 16, v241
    v_mfma_f32_16x16x32_bf16 v[132:135], v[36:39], v[208:211], v[132:135]
    ds_read_b128 v[200:203], v105 offset:32768
    v_and_b32 v67, v8, v241
    v_mfma_f32_16x16x32_bf16 v[136:139], v[40:43], v[208:211], v[136:139]
    ds_read_b128 v[204:207], v105 offset:33792
    v_mfma_f32_16x16x32_bf16 v[152:155], v[40:43], v[212:215], v[152:155]
    ds_read_b64_tr_b16 v[228:229], v107 offset:49152
    v_mul_f32 v66, v66, v60
    v_mfma_f32_16x16x32_bf16 v[168:171], v[40:43], v[216:219], v[168:171]
    ds_read_b64_tr_b16 v[230:231], v107 offset:51200
    v_mul_f32 v67, v67, v60
    v_mfma_f32_16x16x32_bf16 v[184:187], v[40:43], v[220:223], v[184:187]
    ds_read_b64_tr_b16 v[232:233], v108 offset:49152
    v_lshlrev_b32 v68, 16, v242
    v_mfma_f32_16x16x32_bf16 v[188:191], v[44:47], v[220:223], v[188:191]
    ds_read_b64_tr_b16 v[234:235], v108 offset:51200
    v_mfma_f32_16x16x32_bf16 v[172:175], v[44:47], v[216:219], v[172:175]
    ds_read_b64_tr_b16 v[236:237], v109 offset:49152
    v_and_b32 v69, v8, v242
    v_mfma_f32_16x16x32_bf16 v[156:159], v[44:47], v[212:215], v[156:159]
    ds_read_b64_tr_b16 v[238:239], v109 offset:51200
    v_mul_f32 v68, v68, v60
    v_mfma_f32_16x16x32_bf16 v[140:143], v[44:47], v[208:211], v[140:143]
    s_getreg_b32 s3, hwreg(HW_REG_IB_STS, 0, 4)
    s_cmp_ge_u32 s3, s49
    s_cbranch_scc1 L_tf_76
    s_waitcnt vmcnt(0)
    s_mov_b32 s49, 0
    v_mov_b32 v1, s12
    s_mov_b64 exec, 1
    buffer_store_dword v1, off, s[4:7], s48 sc1
    s_mov_b64 exec, -1
L_tf_76:
    s_waitcnt lgkmcnt(5)
    v_mfma_f32_16x16x32_bf16 v[128:131], v[224:227], v[192:195], v[128:131]
    ds_read_b64_tr_b16 v[32:33], v106 offset:53248
    v_mul_f32 v69, v69, v60
    v_mfma_f32_16x16x32_bf16 v[144:147], v[224:227], v[196:199], v[144:147]
    ds_read_b64_tr_b16 v[34:35], v106 offset:55296
    v_lshlrev_b32 v70, 16, v243
    v_mfma_f32_16x16x32_bf16 v[160:163], v[224:227], v[200:203], v[160:163]
    ds_read_b128 v[208:211], v104 offset:40960
    v_and_b32 v71, v8, v243
    v_mfma_f32_16x16x32_bf16 v[176:179], v[224:227], v[204:207], v[176:179]
    ds_read_b128 v[212:215], v104 offset:41984
    s_waitcnt lgkmcnt(5)
    v_mfma_f32_16x16x32_bf16 v[180:183], v[228:231], v[204:207], v[180:183]
    ds_read_b128 v[216:219], v105 offset:40960
    v_mul_f32 v70, v70, v60
    v_mfma_f32_16x16x32_bf16 v[164:167], v[228:231], v[200:203], v[164:167]
    ds_read_b128 v[220:223], v105 offset:41984
    v_mul_f32 v71, v71, v60
    v_mfma_f32_16x16x32_bf16 v[148:151], v[228:231], v[196:199], v[148:151]
    ds_read_b64_tr_b16 v[36:37], v107 offset:53248
    v_lshlrev_b32 v72, 16, v244
    v_mfma_f32_16x16x32_bf16 v[132:135], v[228:231], v[192:195], v[132:135]
    ds_read_b64_tr_b16 v[38:39], v107 offset:55296
    v_mfma_f32_16x16x32_bf16 v[136:139], v[232:235], v[192:195], v[136:139]
    ds_read_b64_tr_b16 v[40:41], v108 offset:53248
    v_and_b32 v73, v8, v244
    v_mfma_f32_16x16x32_bf16 v[152:155], v[232:235], v[196:199], v[152:155]
    ds_read_b64_tr_b16 v[42:43], v108 offset:55296
    v_mul_f32 v72, v72, v60
    v_mfma_f32_16x16x32_bf16 v[168:171], v[232:235], v[200:203], v[168:171]
    ds_read_b64_tr_b16 v[44:45], v109 offset:53248
    v_mul_f32 v73, v73, v60
    v_mfma_f32_16x16x32_bf16 v[184:187], v[232:235], v[204:207], v[184:187]
    ds_read_b64_tr_b16 v[46:47], v109 offset:55296
    s_waitcnt lgkmcnt(5)
    v_mfma_f32_16x16x32_bf16 v[188:191], v[236:239], v[204:207], v[188:191]
    v_lshlrev_b32 v74, 16, v245
    v_mfma_f32_16x16x32_bf16 v[172:175], v[236:239], v[200:203], v[172:175]
    v_and_b32 v75, v8, v245
    v_mfma_f32_16x16x32_bf16 v[156:159], v[236:239], v[196:199], v[156:159]
    v_mul_f32 v74, v74, v60
    v_mfma_f32_16x16x32_bf16 v[140:143], v[236:239], v[192:195], v[140:143]
    v_mul_f32 v75, v75, v60
    v_mfma_f32_16x16x32_bf16 v[128:131], v[32:35], v[208:211], v[128:131]
    v_lshlrev_b32 v76, 16, v246
    v_mfma_f32_16x16x32_bf16 v[144:147], v[32:35], v[212:215], v[144:147]
    s_waitcnt lgkmcnt(0)
    v_mfma_f32_16x16x32_bf16 v[160:163], v[32:35], v[216:219], v[160:163]
    s_barrier
    v_mfma_f32_16x16x32_bf16 v[176:179], v[32:35], v[220:223], v[176:179]
    ds_read_b64_tr_b16 v[224:225], v112 offset:16384
    v_and_b32 v77, v8, v246
    v_mfma_f32_16x16x32_bf16 v[180:183], v[36:39], v[220:223], v[180:183]
    ds_read_b64_tr_b16 v[226:227], v112 offset:18432
    v_mul_f32 v76, v76, v60
    v_mfma_f32_16x16x32_bf16 v[164:167], v[36:39], v[216:219], v[164:167]
    ds_read_b128 v[192:195], v110 offset:0
    v_mul_f32 v77, v77, v60
    v_mfma_f32_16x16x32_bf16 v[148:151], v[36:39], v[212:215], v[148:151]
    ds_read_b128 v[196:199], v110 offset:1024
    v_mfma_f32_16x16x32_bf16 v[132:135], v[36:39], v[208:211], v[132:135]
    ds_read_b128 v[200:203], v111 offset:0
    v_lshlrev_b32 v78, 16, v247
    v_mfma_f32_16x16x32_bf16 v[136:139], v[40:43], v[208:211], v[136:139]
    ds_read_b128 v[204:207], v111 offset:1024
    v_and_b32 v79, v8, v247
    v_mfma_f32_16x16x32_bf16 v[152:155], v[40:43], v[212:215], v[152:155]
    ds_read_b64_tr_b16 v[228:229], v113 offset:16384
    v_mul_f32 v78, v78, v60
    v_mfma_f32_16x16x32_bf16 v[168:171], v[40:43], v[216:219], v[168:171]
    ds_read_b64_tr_b16 v[230:231], v113 offset:18432
    v_mfma_f32_16x16x32_bf16 v[184:187], v[40:43], v[220:223], v[184:187]
    ds_read_b64_tr_b16 v[232:233], v114 offset:16384
    v_mul_f32 v79, v79, v60
    v_mfma_f32_16x16x32_bf16 v[188:191], v[44:47], v[220:223], v[188:191]
    ds_read_b64_tr_b16 v[234:235], v114 offset:18432
    v_lshlrev_b32 v80, 16, v248
    v_mfma_f32_16x16x32_bf16 v[172:175], v[44:47], v[216:219], v[172:175]
    ds_read_b64_tr_b16 v[236:237], v115 offset:16384
    v_mfma_f32_16x16x32_bf16 v[156:159], v[44:47], v[212:215], v[156:159]
    ds_read_b64_tr_b16 v[238:239], v115 offset:18432
    v_and_b32 v81, v8, v248
    v_mfma_f32_16x16x32_bf16 v[140:143], v[44:47], v[208:211], v[140:143]
    s_getreg_b32 s3, hwreg(HW_REG_IB_STS, 0, 4)
    s_cmp_ge_u32 s3, s49
    s_cbranch_scc1 L_tf_77
    s_waitcnt vmcnt(0)
    s_mov_b32 s49, 0
    v_mov_b32 v1, s12
    s_mov_b64 exec, 1
    buffer_store_dword v1, off, s[4:7], s48 sc1
    s_mov_b64 exec, -1
L_tf_77:
    s_waitcnt lgkmcnt(5)
    v_mfma_f32_16x16x32_bf16 v[128:131], v[224:227], v[192:195], v[128:131]
    ds_read_b64_tr_b16 v[32:33], v112 offset:20480
    v_mul_f32 v80, v80, v61
    v_mfma_f32_16x16x32_bf16 v[144:147], v[224:227], v[196:199], v[144:147]
    ds_read_b64_tr_b16 v[34:35], v112 offset:22528
    v_mul_f32 v81, v81, v61
    v_mfma_f32_16x16x32_bf16 v[160:163], v[224:227], v[200:203], v[160:163]
    ds_read_b128 v[208:211], v110 offset:8192
    v_lshlrev_b32 v82, 16, v249
    v_mfma_f32_16x16x32_bf16 v[176:179], v[224:227], v[204:207], v[176:179]
    ds_read_b128 v[212:215], v110 offset:9216
    s_waitcnt lgkmcnt(5)
    v_mfma_f32_16x16x32_bf16 v[180:183], v[228:231], v[204:207], v[180:183]
    ds_read_b128 v[216:219], v111 offset:8192
    v_and_b32 v83, v8, v249
    v_mfma_f32_16x16x32_bf16 v[164:167], v[228:231], v[200:203], v[164:167]
    ds_read_b128 v[220:223], v111 offset:9216
    v_mul_f32 v82, v82, v61
    v_mfma_f32_16x16x32_bf16 v[148:151], v[228:231], v[196:199], v[148:151]
    ds_read_b64_tr_b16 v[36:37], v113 offset:20480
    v_mul_f32 v83, v83, v61
    v_mfma_f32_16x16x32_bf16 v[132:135], v[228:231], v[192:195], v[132:135]
    ds_read_b64_tr_b16 v[38:39], v113 offset:22528
    v_lshlrev_b32 v84, 16, v250
    v_mfma_f32_16x16x32_bf16 v[136:139], v[232:235], v[192:195], v[136:139]
    ds_read_b64_tr_b16 v[40:41], v114 offset:20480
    v_mfma_f32_16x16x32_bf16 v[152:155], v[232:235], v[196:199], v[152:155]
    ds_read_b64_tr_b16 v[42:43], v114 offset:22528
    v_and_b32 v85, v8, v250
    v_mfma_f32_16x16x32_bf16 v[168:171], v[232:235], v[200:203], v[168:171]
    ds_read_b64_tr_b16 v[44:45], v115 offset:20480
    v_mul_f32 v84, v84, v61
    v_mfma_f32_16x16x32_bf16 v[184:187], v[232:235], v[204:207], v[184:187]
    ds_read_b64_tr_b16 v[46:47], v115 offset:22528
    s_waitcnt lgkmcnt(5)
    v_mfma_f32_16x16x32_bf16 v[188:191], v[236:239], v[204:207], v[188:191]
    v_mul_f32 v85, v85, v61
    v_mfma_f32_16x16x32_bf16 v[172:175], v[236:239], v[200:203], v[172:175]
    v_lshlrev_b32 v86, 16, v251
    v_mfma_f32_16x16x32_bf16 v[156:159], v[236:239], v[196:199], v[156:159]
    v_and_b32 v87, v8, v251
    v_mfma_f32_16x16x32_bf16 v[140:143], v[236:239], v[192:195], v[140:143]
    v_mul_f32 v86, v86, v61
    v_mfma_f32_16x16x32_bf16 v[128:131], v[32:35], v[208:211], v[128:131]
    v_mul_f32 v87, v87, v61
    v_mfma_f32_16x16x32_bf16 v[144:147], v[32:35], v[212:215], v[144:147]
    s_waitcnt lgkmcnt(0)
    v_mfma_f32_16x16x32_bf16 v[160:163], v[32:35], v[216:219], v[160:163]
    s_barrier
    v_mfma_f32_16x16x32_bf16 v[176:179], v[32:35], v[220:223], v[176:179]
    ds_read_b64_tr_b16 v[224:225], v112 offset:49152
    v_lshlrev_b32 v88, 16, v252
    v_mfma_f32_16x16x32_bf16 v[180:183], v[36:39], v[220:223], v[180:183]
    ds_read_b64_tr_b16 v[226:227], v112 offset:51200
    v_and_b32 v89, v8, v252
    v_mfma_f32_16x16x32_bf16 v[164:167], v[36:39], v[216:219], v[164:167]
    ds_read_b128 v[192:195], v110 offset:32768
    v_mul_f32 v88, v88, v61
    v_mfma_f32_16x16x32_bf16 v[148:151], v[36:39], v[212:215], v[148:151]
    ds_read_b128 v[196:199], v110 offset:33792
    v_mul_f32 v89, v89, v61
    v_mfma_f32_16x16x32_bf16 v[132:135], v[36:39], v[208:211], v[132:135]
    ds_read_b128 v[200:203], v111 offset:32768
    v_mfma_f32_16x16x32_bf16 v[136:139], v[40:43], v[208:211], v[136:139]
    ds_read_b128 v[204:207], v111 offset:33792
    v_lshlrev_b32 v90, 16, v253
    v_mfma_f32_16x16x32_bf16 v[152:155], v[40:43], v[212:215], v[152:155]
    ds_read_b64_tr_b16 v[228:229], v113 offset:49152
    v_and_b32 v91, v8, v253
    v_mfma_f32_16x16x32_bf16 v[168:171], v[40:43], v[216:219], v[168:171]
    ds_read_b64_tr_b16 v[230:231], v113 offset:51200
    v_mul_f32 v90, v90, v61
    v_mfma_f32_16x16x32_bf16 v[184:187], v[40:43], v[220:223], v[184:187]
    ds_read_b64_tr_b16 v[232:233], v114 offset:49152
    v_mfma_f32_16x16x32_bf16 v[188:191], v[44:47], v[220:223], v[188:191]
    ds_read_b64_tr_b16 v[234:235], v114 offset:51200
    v_mul_f32 v91, v91, v61
    v_mfma_f32_16x16x32_bf16 v[172:175], v[44:47], v[216:219], v[172:175]
    ds_read_b64_tr_b16 v[236:237], v115 offset:49152
    v_lshlrev_b32 v92, 16, v254
    v_mfma_f32_16x16x32_bf16 v[156:159], v[44:47], v[212:215], v[156:159]
    ds_read_b64_tr_b16 v[238:239], v115 offset:51200
    v_and_b32 v93, v8, v254
    v_mfma_f32_16x16x32_bf16 v[140:143], v[44:47], v[208:211], v[140:143]
    s_getreg_b32 s3, hwreg(HW_REG_IB_STS, 0, 4)
    s_cmp_ge_u32 s3, s49
    s_cbranch_scc1 L_tf_78
    s_waitcnt vmcnt(0)
    s_mov_b32 s49, 0
    v_mov_b32 v1, s12
    s_mov_b64 exec, 1
    buffer_store_dword v1, off, s[4:7], s48 sc1
    s_mov_b64 exec, -1
L_tf_78:
    s_waitcnt lgkmcnt(5)
    v_mfma_f32_16x16x32_bf16 v[128:131], v[224:227], v[192:195], v[128:131]
    ds_read_b64_tr_b16 v[32:33], v112 offset:53248
    v_mul_f32 v92, v92, v61
    v_mfma_f32_16x16x32_bf16 v[144:147], v[224:227], v[196:199], v[144:147]
    ds_read_b64_tr_b16 v[34:35], v112 offset:55296
    v_mul_f32 v93, v93, v61
    v_mfma_f32_16x16x32_bf16 v[160:163], v[224:227], v[200:203], v[160:163]
    ds_read_b128 v[208:211], v110 offset:40960
    v_mfma_f32_16x16x32_bf16 v[176:179], v[224:227], v[204:207], v[176:179]
    ds_read_b128 v[212:215], v110 offset:41984
    s_waitcnt lgkmcnt(5)
    v_mfma_f32_16x16x32_bf16 v[180:183], v[228:231], v[204:207], v[180:183]
    ds_read_b128 v[216:219], v111 offset:40960
    v_lshlrev_b32 v94, 16, v255
    v_mfma_f32_16x16x32_bf16 v[164:167], v[228:231], v[200:203], v[164:167]
    ds_read_b128 v[220:223], v111 offset:41984
    v_and_b32 v95, v8, v255
    v_mfma_f32_16x16x32_bf16 v[148:151], v[228:231], v[196:199], v[148:151]
    ds_read_b64_tr_b16 v[36:37], v113 offset:53248
    v_mul_f32 v94, v94, v61
    v_mfma_f32_16x16x32_bf16 v[132:135], v[228:231], v[192:195], v[132:135]
    ds_read_b64_tr_b16 v[38:39], v113 offset:55296
    v_mul_f32 v95, v95, v61
    v_mfma_f32_16x16x32_bf16 v[136:139], v[232:235], v[192:195], v[136:139]
    ds_read_b64_tr_b16 v[40:41], v114 offset:53248
    s_mov_b32 s24, s82
    v_mfma_f32_16x16x32_bf16 v[152:155], v[232:235], v[196:199], v[152:155]
    ds_read_b64_tr_b16 v[42:43], v114 offset:55296
    s_and_b32 s25, s83, 0xffff
    v_mfma_f32_16x16x32_bf16 v[168:171], v[232:235], v[200:203], v[168:171]
    ds_read_b64_tr_b16 v[44:45], v115 offset:53248
    v_mfma_f32_16x16x32_bf16 v[184:187], v[232:235], v[204:207], v[184:187]
    ds_read_b64_tr_b16 v[46:47], v115 offset:55296
    s_waitcnt lgkmcnt(5)
    v_mfma_f32_16x16x32_bf16 v[188:191], v[236:239], v[204:207], v[188:191]
    s_mov_b32 s26, 4194304
    s_mov_b32 s27, 0x20000
    v_mfma_f32_16x16x32_bf16 v[172:175], v[236:239], v[200:203], v[172:175]
    s_lshl_b32 s44, s16, 7
    v_mfma_f32_16x16x32_bf16 v[156:159], v[236:239], v[196:199], v[156:159]
    s_add_u32 s44, s44, s42
    v_mfma_f32_16x16x32_bf16 v[140:143], v[236:239], v[192:195], v[140:143]
    s_lshl_b32 s44, s44, 11
    v_mfma_f32_16x16x32_bf16 v[128:131], v[32:35], v[208:211], v[128:131]
    s_and_b32 s45, s17, 7
    v_mfma_f32_16x16x32_bf16 v[144:147], v[32:35], v[212:215], v[144:147]
    s_waitcnt lgkmcnt(0)
    v_mfma_f32_16x16x32_bf16 v[160:163], v[32:35], v[216:219], v[160:163]
    s_barrier
    v_mfma_f32_16x16x32_bf16 v[176:179], v[32:35], v[220:223], v[176:179]
    ds_read_b64_tr_b16 v[224:225], v106 offset:16384
    s_lshl_b32 s45, s45, 8
    v_mfma_f32_16x16x32_bf16 v[180:183], v[36:39], v[220:223], v[180:183]
    ds_read_b64_tr_b16 v[226:227], v106 offset:18432
    s_add_u32 s44, s44, s45
    v_mfma_f32_16x16x32_bf16 v[164:167], v[36:39], v[216:219], v[164:167]
    ds_read_b128 v[192:195], v104 offset:0
    v_mfma_f32_16x16x32_bf16 v[148:151], v[36:39], v[212:215], v[148:151]
    ds_read_b128 v[196:199], v104 offset:1024
    s_lshl_b32 s45, s20, 7
    v_mfma_f32_16x16x32_bf16 v[132:135], v[36:39], v[208:211], v[132:135]
    ds_read_b128 v[200:203], v105 offset:0
    s_add_u32 s44, s44, s45
    v_mfma_f32_16x16x32_bf16 v[136:139], v[40:43], v[208:211], v[136:139]
    ds_read_b128 v[204:207], v105 offset:1024
    v_mfma_f32_16x16x32_bf16 v[152:155], v[40:43], v[212:215], v[152:155]
    ds_read_b64_tr_b16 v[228:229], v107 offset:16384
    v_mfma_f32_16x16x32_bf16 v[168:171], v[40:43], v[216:219], v[168:171]
    ds_read_b64_tr_b16 v[230:231], v107 offset:18432
    v_mfma_f32_16x16x32_bf16 v[184:187], v[40:43], v[220:223], v[184:187]
    ds_read_b64_tr_b16 v[232:233], v108 offset:16384
    v_mfma_f32_16x16x32_bf16 v[188:191], v[44:47], v[220:223], v[188:191]
    ds_read_b64_tr_b16 v[234:235], v108 offset:18432
    v_mfma_f32_16x16x32_bf16 v[172:175], v[44:47], v[216:219], v[172:175]
    ds_read_b64_tr_b16 v[236:237], v109 offset:16384
    v_mfma_f32_16x16x32_bf16 v[156:159], v[44:47], v[212:215], v[156:159]
    ds_read_b64_tr_b16 v[238:239], v109 offset:18432
    v_mfma_f32_16x16x32_bf16 v[140:143], v[44:47], v[208:211], v[140:143]
    s_cmp_eq_u32 s49, 0
    s_cbranch_scc1 L_tf_79
    s_waitcnt vmcnt(0)
    s_mov_b32 s49, 0
    v_mov_b32 v1, s12
    s_mov_b64 exec, 1
    buffer_store_dword v1, off, s[4:7], s48 sc1
    s_mov_b64 exec, -1
L_tf_79:
    s_mov_b32 s40, 7
L_p4cloop_80:
    s_waitcnt lgkmcnt(5)
    v_mfma_f32_16x16x32_bf16 v[128:131], v[224:227], v[192:195], v[128:131]
    ds_read_b64_tr_b16 v[32:33], v106 offset:20480
    v_mfma_f32_16x16x32_bf16 v[144:147], v[224:227], v[196:199], v[144:147]
    ds_read_b64_tr_b16 v[34:35], v106 offset:22528
    v_mfma_f32_16x16x32_bf16 v[160:163], v[224:227], v[200:203], v[160:163]
    ds_read_b128 v[208:211], v104 offset:8192
    v_mfma_f32_16x16x32_bf16 v[176:179], v[224:227], v[204:207], v[176:179]
    ds_read_b128 v[212:215], v104 offset:9216
    s_waitcnt lgkmcnt(5)
    v_mfma_f32_16x16x32_bf16 v[180:183], v[228:231], v[204:207], v[180:183]
    ds_read_b128 v[216:219], v105 offset:8192
    v_mfma_f32_16x16x32_bf16 v[164:167], v[228:231], v[200:203], v[164:167]
    ds_read_b128 v[220:223], v105 offset:9216
    v_mfma_f32_16x16x32_bf16 v[148:151], v[228:231], v[196:199], v[148:151]
    ds_read_b64_tr_b16 v[36:37], v107 offset:20480
    v_mfma_f32_16x16x32_bf16 v[132:135], v[228:231], v[192:195], v[132:135]
    ds_read_b64_tr_b16 v[38:39], v107 offset:22528
    v_mfma_f32_16x16x32_bf16 v[136:139], v[232:235], v[192:195], v[136:139]
    ds_read_b64_tr_b16 v[40:41], v108 offset:20480
    v_mfma_f32_16x16x32_bf16 v[152:155], v[232:235], v[196:199], v[152:155]
    ds_read_b64_tr_b16 v[42:43], v108 offset:22528
    v_mfma_f32_16x16x32_bf16 v[168:171], v[232:235], v[200:203], v[168:171]
    ds_read_b64_tr_b16 v[44:45], v109 offset:20480
    v_mfma_f32_16x16x32_bf16 v[184:187], v[232:235], v[204:207], v[184:187]
    ds_read_b64_tr_b16 v[46:47], v109 offset:22528
    s_waitcnt lgkmcnt(5)
    v_mfma_f32_16x16x32_bf16 v[188:191], v[236:239], v[204:207], v[188:191]
    v_mfma_f32_16x16x32_bf16 v[172:175], v[236:239], v[200:203], v[172:175]
    v_mfma_f32_16x16x32_bf16 v[156:159], v[236:239], v[196:199], v[156:159]
    v_mfma_f32_16x16x32_bf16 v[140:143], v[236:239], v[192:195], v[140:143]
    v_mfma_f32_16x16x32_bf16 v[128:131], v[32:35], v[208:211], v[128:131]
    v_mfma_f32_16x16x32_bf16 v[144:147], v[32:35], v[212:215], v[144:147]
    s_waitcnt lgkmcnt(0)
    v_mfma_f32_16x16x32_bf16 v[160:163], v[32:35], v[216:219], v[160:163]
    s_barrier
    v_mfma_f32_16x16x32_bf16 v[176:179], v[32:35], v[220:223], v[176:179]
    ds_read_b64_tr_b16 v[224:225], v106 offset:49152
    v_mfma_f32_16x16x32_bf16 v[180:183], v[36:39], v[220:223], v[180:183]
    ds_read_b64_tr_b16 v[226:227], v106 offset:51200
    v_mfma_f32_16x16x32_bf16 v[164:167], v[36:39], v[216:219], v[164:167]
    ds_read_b128 v[192:195], v104 offset:32768
    v_mfma_f32_16x16x32_bf16 v[148:151], v[36:39], v[212:215], v[148:151]
    ds_read_b128 v[196:199], v104 offset:33792
    v_mfma_f32_16x16x32_bf16 v[132:135], v[36:39], v[208:211], v[132:135]
    ds_read_b128 v[200:203], v105 offset:32768
    v_mfma_f32_16x16x32_bf16 v[136:139], v[40:43], v[208:211], v[136:139]
    ds_read_b128 v[204:207], v105 offset:33792
    v_mfma_f32_16x16x32_bf16 v[152:155], v[40:43], v[212:215], v[152:155]
    ds_read_b64_tr_b16 v[228:229], v107 offset:49152
    v_mfma_f32_16x16x32_bf16 v[168:171], v[40:43], v[216:219], v[168:171]
    ds_read_b64_tr_b16 v[230:231], v107 offset:51200
    v_mfma_f32_16x16x32_bf16 v[184:187], v[40:43], v[220:223], v[184:187]
    ds_read_b64_tr_b16 v[232:233], v108 offset:49152
    v_mfma_f32_16x16x32_bf16 v[188:191], v[44:47], v[220:223], v[188:191]
    ds_read_b64_tr_b16 v[234:235], v108 offset:51200
    v_mfma_f32_16x16x32_bf16 v[172:175], v[44:47], v[216:219], v[172:175]
    ds_read_b64_tr_b16 v[236:237], v109 offset:49152
    v_mfma_f32_16x16x32_bf16 v[156:159], v[44:47], v[212:215], v[156:159]
    ds_read_b64_tr_b16 v[238:239], v109 offset:51200
    v_mfma_f32_16x16x32_bf16 v[140:143], v[44:47], v[208:211], v[140:143]
    s_waitcnt lgkmcnt(5)
    v_mfma_f32_16x16x32_bf16 v[128:131], v[224:227], v[192:195], v[128:131]
    ds_read_b64_tr_b16 v[32:33], v106 offset:53248
    v_mfma_f32_16x16x32_bf16 v[144:147], v[224:227], v[196:199], v[144:147]
    ds_read_b64_tr_b16 v[34:35], v106 offset:55296
    v_mfma_f32_16x16x32_bf16 v[160:163], v[224:227], v[200:203], v[160:163]
    ds_read_b128 v[208:211], v104 offset:40960
    v_mfma_f32_16x16x32_bf16 v[176:179], v[224:227], v[204:207], v[176:179]
    ds_read_b128 v[212:215], v104 offset:41984
    s_waitcnt lgkmcnt(5)
    v_mfma_f32_16x16x32_bf16 v[180:183], v[228:231], v[204:207], v[180:183]
    ds_read_b128 v[216:219], v105 offset:40960
    v_mfma_f32_16x16x32_bf16 v[164:167], v[228:231], v[200:203], v[164:167]
    ds_read_b128 v[220:223], v105 offset:41984
    v_mfma_f32_16x16x32_bf16 v[148:151], v[228:231], v[196:199], v[148:151]
    ds_read_b64_tr_b16 v[36:37], v107 offset:53248
    v_mfma_f32_16x16x32_bf16 v[132:135], v[228:231], v[192:195], v[132:135]
    ds_read_b64_tr_b16 v[38:39], v107 offset:55296
    v_mfma_f32_16x16x32_bf16 v[136:139], v[232:235], v[192:195], v[136:139]
    ds_read_b64_tr_b16 v[40:41], v108 offset:53248
    v_mfma_f32_16x16x32_bf16 v[152:155], v[232:235], v[196:199], v[152:155]
    ds_read_b64_tr_b16 v[42:43], v108 offset:55296
    v_mfma_f32_16x16x32_bf16 v[168:171], v[232:235], v[200:203], v[168:171]
    ds_read_b64_tr_b16 v[44:45], v109 offset:53248
    v_mfma_f32_16x16x32_bf16 v[184:187], v[232:235], v[204:207], v[184:187]
    ds_read_b64_tr_b16 v[46:47], v109 offset:55296
    s_waitcnt lgkmcnt(5)
    v_mfma_f32_16x16x32_bf16 v[188:191], v[236:239], v[204:207], v[188:191]
    v_mfma_f32_16x16x32_bf16 v[172:175], v[236:239], v[200:203], v[172:175]
    v_mfma_f32_16x16x32_bf16 v[156:159], v[236:239], v[196:199], v[156:159]
    v_mfma_f32_16x16x32_bf16 v[140:143], v[236:239], v[192:195], v[140:143]
    v_mfma_f32_16x16x32_bf16 v[128:131], v[32:35], v[208:211], v[128:131]
    v_mfma_f32_16x16x32_bf16 v[144:147], v[32:35], v[212:215], v[144:147]
    s_waitcnt lgkmcnt(0)
    v_mfma_f32_16x16x32_bf16 v[160:163], v[32:35], v[216:219], v[160:163]
    s_barrier
    v_mfma_f32_16x16x32_bf16 v[176:179], v[32:35], v[220:223], v[176:179]
    ds_read_b64_tr_b16 v[224:225], v112 offset:16384
    v_mfma_f32_16x16x32_bf16 v[180:183], v[36:39], v[220:223], v[180:183]
    ds_read_b64_tr_b16 v[226:227], v112 offset:18432
    v_mfma_f32_16x16x32_bf16 v[164:167], v[36:39], v[216:219], v[164:167]
    ds_read_b128 v[192:195], v110 offset:0
    v_mfma_f32_16x16x32_bf16 v[148:151], v[36:39], v[212:215], v[148:151]
    ds_read_b128 v[196:199], v110 offset:1024
    v_mfma_f32_16x16x32_bf16 v[132:135], v[36:39], v[208:211], v[132:135]
    ds_read_b128 v[200:203], v111 offset:0
    v_mfma_f32_16x16x32_bf16 v[136:139], v[40:43], v[208:211], v[136:139]
    ds_read_b128 v[204:207], v111 offset:1024
    v_mfma_f32_16x16x32_bf16 v[152:155], v[40:43], v[212:215], v[152:155]
    ds_read_b64_tr_b16 v[228:229], v113 offset:16384
    v_mfma_f32_16x16x32_bf16 v[168:171], v[40:43], v[216:219], v[168:171]
    ds_read_b64_tr_b16 v[230:231], v113 offset:18432
    v_mfma_f32_16x16x32_bf16 v[184:187], v[40:43], v[220:223], v[184:187]
    ds_read_b64_tr_b16 v[232:233], v114 offset:16384
    v_mfma_f32_16x16x32_bf16 v[188:191], v[44:47], v[220:223], v[188:191]
    ds_read_b64_tr_b16 v[234:235], v114 offset:18432
    v_mfma_f32_16x16x32_bf16 v[172:175], v[44:47], v[216:219], v[172:175]
    ds_read_b64_tr_b16 v[236:237], v115 offset:16384
    v_mfma_f32_16x16x32_bf16 v[156:159], v[44:47], v[212:215], v[156:159]
    ds_read_b64_tr_b16 v[238:239], v115 offset:18432
    v_mfma_f32_16x16x32_bf16 v[140:143], v[44:47], v[208:211], v[140:143]
    s_waitcnt lgkmcnt(5)
    v_mfma_f32_16x16x32_bf16 v[128:131], v[224:227], v[192:195], v[128:131]
    ds_read_b64_tr_b16 v[32:33], v112 offset:20480
    v_mfma_f32_16x16x32_bf16 v[144:147], v[224:227], v[196:199], v[144:147]
    ds_read_b64_tr_b16 v[34:35], v112 offset:22528
    v_mfma_f32_16x16x32_bf16 v[160:163], v[224:227], v[200:203], v[160:163]
    ds_read_b128 v[208:211], v110 offset:8192
    v_mfma_f32_16x16x32_bf16 v[176:179], v[224:227], v[204:207], v[176:179]
    ds_read_b128 v[212:215], v110 offset:9216
    s_waitcnt lgkmcnt(5)
    v_mfma_f32_16x16x32_bf16 v[180:183], v[228:231], v[204:207], v[180:183]
    ds_read_b128 v[216:219], v111 offset:8192
    v_mfma_f32_16x16x32_bf16 v[164:167], v[228:231], v[200:203], v[164:167]
    ds_read_b128 v[220:223], v111 offset:9216
    v_mfma_f32_16x16x32_bf16 v[148:151], v[228:231], v[196:199], v[148:151]
    ds_read_b64_tr_b16 v[36:37], v113 offset:20480
    v_mfma_f32_16x16x32_bf16 v[132:135], v[228:231], v[192:195], v[132:135]
    ds_read_b64_tr_b16 v[38:39], v113 offset:22528
    v_mfma_f32_16x16x32_bf16 v[136:139], v[232:235], v[192:195], v[136:139]
    ds_read_b64_tr_b16 v[40:41], v114 offset:20480
    v_mfma_f32_16x16x32_bf16 v[152:155], v[232:235], v[196:199], v[152:155]
    ds_read_b64_tr_b16 v[42:43], v114 offset:22528
    v_mfma_f32_16x16x32_bf16 v[168:171], v[232:235], v[200:203], v[168:171]
    ds_read_b64_tr_b16 v[44:45], v115 offset:20480
    v_mfma_f32_16x16x32_bf16 v[184:187], v[232:235], v[204:207], v[184:187]
    ds_read_b64_tr_b16 v[46:47], v115 offset:22528
    s_waitcnt lgkmcnt(5)
    v_mfma_f32_16x16x32_bf16 v[188:191], v[236:239], v[204:207], v[188:191]
    v_mfma_f32_16x16x32_bf16 v[172:175], v[236:239], v[200:203], v[172:175]
    v_mfma_f32_16x16x32_bf16 v[156:159], v[236:239], v[196:199], v[156:159]
    v_mfma_f32_16x16x32_bf16 v[140:143], v[236:239], v[192:195], v[140:143]
    v_mfma_f32_16x16x32_bf16 v[128:131], v[32:35], v[208:211], v[128:131]
    v_mfma_f32_16x16x32_bf16 v[144:147], v[32:35], v[212:215], v[144:147]
    s_waitcnt lgkmcnt(0)
    v_mfma_f32_16x16x32_bf16 v[160:163], v[32:35], v[216:219], v[160:163]
    s_barrier
    v_mfma_f32_16x16x32_bf16 v[176:179], v[32:35], v[220:223], v[176:179]
    ds_read_b64_tr_b16 v[224:225], v112 offset:49152
    v_mfma_f32_16x16x32_bf16 v[180:183], v[36:39], v[220:223], v[180:183]
    ds_read_b64_tr_b16 v[226:227], v112 offset:51200
    v_mfma_f32_16x16x32_bf16 v[164:167], v[36:39], v[216:219], v[164:167]
    ds_read_b128 v[192:195], v110 offset:32768
    v_mfma_f32_16x16x32_bf16 v[148:151], v[36:39], v[212:215], v[148:151]
    ds_read_b128 v[196:199], v110 offset:33792
    v_mfma_f32_16x16x32_bf16 v[132:135], v[36:39], v[208:211], v[132:135]
    ds_read_b128 v[200:203], v111 offset:32768
    v_mfma_f32_16x16x32_bf16 v[136:139], v[40:43], v[208:211], v[136:139]
    ds_read_b128 v[204:207], v111 offset:33792
    v_mfma_f32_16x16x32_bf16 v[152:155], v[40:43], v[212:215], v[152:155]
    ds_read_b64_tr_b16 v[228:229], v113 offset:49152
    v_mfma_f32_16x16x32_bf16 v[168:171], v[40:43], v[216:219], v[168:171]
    ds_read_b64_tr_b16 v[230:231], v113 offset:51200
    v_mfma_f32_16x16x32_bf16 v[184:187], v[40:43], v[220:223], v[184:187]
    ds_read_b64_tr_b16 v[232:233], v114 offset:49152
    v_mfma_f32_16x16x32_bf16 v[188:191], v[44:47], v[220:223], v[188:191]
    ds_read_b64_tr_b16 v[234:235], v114 offset:51200
    v_mfma_f32_16x16x32_bf16 v[172:175], v[44:47], v[216:219], v[172:175]
    ds_read_b64_tr_b16 v[236:237], v115 offset:49152
    v_mfma_f32_16x16x32_bf16 v[156:159], v[44:47], v[212:215], v[156:159]
    ds_read_b64_tr_b16 v[238:239], v115 offset:51200
    v_mfma_f32_16x16x32_bf16 v[140:143], v[44:47], v[208:211], v[140:143]
    s_waitcnt lgkmcnt(5)
    v_mfma_f32_16x16x32_bf16 v[128:131], v[224:227], v[192:195], v[128:131]
    ds_read_b64_tr_b16 v[32:33], v112 offset:53248
    v_mfma_f32_16x16x32_bf16 v[144:147], v[224:227], v[196:199], v[144:147]
    ds_read_b64_tr_b16 v[34:35], v112 offset:55296
    v_mfma_f32_16x16x32_bf16 v[160:163], v[224:227], v[200:203], v[160:163]
    ds_read_b128 v[208:211], v110 offset:40960
    v_mfma_f32_16x16x32_bf16 v[176:179], v[224:227], v[204:207], v[176:179]
    ds_read_b128 v[212:215], v110 offset:41984
    s_waitcnt lgkmcnt(5)
    v_mfma_f32_16x16x32_bf16 v[180:183], v[228:231], v[204:207], v[180:183]
    ds_read_b128 v[216:219], v111 offset:40960
    v_mfma_f32_16x16x32_bf16 v[164:167], v[228:231], v[200:203], v[164:167]
    ds_read_b128 v[220:223], v111 offset:41984
    v_mfma_f32_16x16x32_bf16 v[148:151], v[228:231], v[196:199], v[148:151]
    ds_read_b64_tr_b16 v[36:37], v113 offset:53248
    v_mfma_f32_16x16x32_bf16 v[132:135], v[228:231], v[192:195], v[132:135]
    ds_read_b64_tr_b16 v[38:39], v113 offset:55296
    v_mfma_f32_16x16x32_bf16 v[136:139], v[232:235], v[192:195], v[136:139]
    ds_read_b64_tr_b16 v[40:41], v114 offset:53248
    v_mfma_f32_16x16x32_bf16 v[152:155], v[232:235], v[196:199], v[152:155]
    ds_read_b64_tr_b16 v[42:43], v114 offset:55296
    v_mfma_f32_16x16x32_bf16 v[168:171], v[232:235], v[200:203], v[168:171]
    ds_read_b64_tr_b16 v[44:45], v115 offset:53248
    v_mfma_f32_16x16x32_bf16 v[184:187], v[232:235], v[204:207], v[184:187]
    ds_read_b64_tr_b16 v[46:47], v115 offset:55296
    s_waitcnt lgkmcnt(5)
    v_mfma_f32_16x16x32_bf16 v[188:191], v[236:239], v[204:207], v[188:191]
    v_mfma_f32_16x16x32_bf16 v[172:175], v[236:239], v[200:203], v[172:175]
    v_mfma_f32_16x16x32_bf16 v[156:159], v[236:239], v[196:199], v[156:159]
    v_mfma_f32_16x16x32_bf16 v[140:143], v[236:239], v[192:195], v[140:143]
    v_mfma_f32_16x16x32_bf16 v[128:131], v[32:35], v[208:211], v[128:131]
    v_mfma_f32_16x16x32_bf16 v[144:147], v[32:35], v[212:215], v[144:147]
    s_waitcnt lgkmcnt(0)
    v_mfma_f32_16x16x32_bf16 v[160:163], v[32:35], v[216:219], v[160:163]
    s_barrier
    v_mfma_f32_16x16x32_bf16 v[176:179], v[32:35], v[220:223], v[176:179]
    ds_read_b64_tr_b16 v[224:225], v106 offset:16384
    v_mfma_f32_16x16x32_bf16 v[180:183], v[36:39], v[220:223], v[180:183]
    ds_read_b64_tr_b16 v[226:227], v106 offset:18432
    v_mfma_f32_16x16x32_bf16 v[164:167], v[36:39], v[216:219], v[164:167]
    ds_read_b128 v[192:195], v104 offset:0
    v_mfma_f32_16x16x32_bf16 v[148:151], v[36:39], v[212:215], v[148:151]
    ds_read_b128 v[196:199], v104 offset:1024
    v_mfma_f32_16x16x32_bf16 v[132:135], v[36:39], v[208:211], v[132:135]
    ds_read_b128 v[200:203], v105 offset:0
    v_mfma_f32_16x16x32_bf16 v[136:139], v[40:43], v[208:211], v[136:139]
    ds_read_b128 v[204:207], v105 offset:1024
    v_mfma_f32_16x16x32_bf16 v[152:155], v[40:43], v[212:215], v[152:155]
    ds_read_b64_tr_b16 v[228:229], v107 offset:16384
    v_mfma_f32_16x16x32_bf16 v[168:171], v[40:43], v[216:219], v[168:171]
    ds_read_b64_tr_b16 v[230:231], v107 offset:18432
    v_mfma_f32_16x16x32_bf16 v[184:187], v[40:43], v[220:223], v[184:187]
    ds_read_b64_tr_b16 v[232:233], v108 offset:16384
    v_mfma_f32_16x16x32_bf16 v[188:191], v[44:47], v[220:223], v[188:191]
    ds_read_b64_tr_b16 v[234:235], v108 offset:18432
    v_mfma_f32_16x16x32_bf16 v[172:175], v[44:47], v[216:219], v[172:175]
    ds_read_b64_tr_b16 v[236:237], v109 offset:16384
    v_mfma_f32_16x16x32_bf16 v[156:159], v[44:47], v[212:215], v[156:159]
    ds_read_b64_tr_b16 v[238:239], v109 offset:18432
    v_mfma_f32_16x16x32_bf16 v[140:143], v[44:47], v[208:211], v[140:143]
    s_sub_u32 s40, s40, 1
    s_cmp_lg_u32 s40, 0
    s_cbranch_scc1 L_p4cloop_80
    s_waitcnt lgkmcnt(5)
    v_mfma_f32_16x16x32_bf16 v[128:131], v[224:227], v[192:195], v[128:131]
    ds_read_b64_tr_b16 v[32:33], v106 offset:20480
    s_add_u32 s43, s44, 32768
    v_mfma_f32_16x16x32_bf16 v[144:147], v[224:227], v[196:199], v[144:147]
    ds_read_b64_tr_b16 v[34:35], v106 offset:22528
    s_lshl_b32 s45, s18, 12
    v_mfma_f32_16x16x32_bf16 v[160:163], v[224:227], v[200:203], v[160:163]
    ds_read_b128 v[208:211], v104 offset:8192
    s_add_u32 s46, s45, 131072
    v_mfma_f32_16x16x32_bf16 v[176:179], v[224:227], v[204:207], v[176:179]
    ds_read_b128 v[212:215], v104 offset:9216
    s_waitcnt lgkmcnt(5)
    v_mfma_f32_16x16x32_bf16 v[180:183], v[228:231], v[204:207], v[180:183]
    ds_read_b128 v[216:219], v105 offset:8192
    v_add_u32 v6, s46, v9
    v_mfma_f32_16x16x32_bf16 v[164:167], v[228:231], v[200:203], v[164:167]
    ds_read_b128 v[220:223], v105 offset:9216
    s_lshl_b32 s46, s16, 4
    v_mfma_f32_16x16x32_bf16 v[148:151], v[228:231], v[196:199], v[148:151]
    ds_read_b64_tr_b16 v[36:37], v107 offset:20480
    s_add_u32 s46, s46, s17
    v_mfma_f32_16x16x32_bf16 v[132:135], v[228:231], v[192:195], v[132:135]
    ds_read_b64_tr_b16 v[38:39], v107 offset:22528
    s_lshl_b32 s29, s46, 14
    v_mfma_f32_16x16x32_bf16 v[136:139], v[232:235], v[192:195], v[136:139]
    ds_read_b64_tr_b16 v[40:41], v108 offset:20480
    s_add_u32 s29, s29, s45
    v_mfma_f32_16x16x32_bf16 v[152:155], v[232:235], v[196:199], v[152:155]
    ds_read_b64_tr_b16 v[42:43], v108 offset:22528
    s_add_u32 s29, s29, 41943040
    v_mfma_f32_16x16x32_bf16 v[168:171], v[232:235], v[200:203], v[168:171]
    ds_read_b64_tr_b16 v[44:45], v109 offset:20480
    s_lshl_b32 s47, s46, 9
    v_mfma_f32_16x16x32_bf16 v[184:187], v[232:235], v[204:207], v[184:187]
    ds_read_b64_tr_b16 v[46:47], v109 offset:22528
    s_waitcnt lgkmcnt(5)
    v_mfma_f32_16x16x32_bf16 v[188:191], v[236:239], v[204:207], v[188:191]
    s_lshl_b32 s45, s18, 7
    s_add_u32 s47, s47, s45
    v_mfma_f32_16x16x32_bf16 v[172:175], v[236:239], v[200:203], v[172:175]
    s_add_u32 s47, s47, 46399488
    s_lshl_b32 s45, s18, 12
    v_mfma_f32_16x16x32_bf16 v[156:159], v[236:239], v[196:199], v[156:159]
    v_lshrrev_b32 v7, 1, v4
    v_and_b32 v10, 7, v3
    v_mfma_f32_16x16x32_bf16 v[140:143], v[236:239], v[192:195], v[140:143]
    v_xor_b32 v7, v7, v10
    v_lshlrev_b32 v7, 4, v7
    v_mfma_f32_16x16x32_bf16 v[128:131], v[32:35], v[208:211], v[128:131]
    v_lshl_add_u32 v7, v3, 7, v7
    v_and_b32 v10, 1, v4
    v_mfma_f32_16x16x32_bf16 v[144:147], v[32:35], v[212:215], v[144:147]
    s_waitcnt lgkmcnt(0)
    v_lshl_add_u32 v7, v10, 3, v7
    v_mfma_f32_16x16x32_bf16 v[160:163], v[32:35], v[216:219], v[160:163]
    s_barrier
    v_mfma_f32_16x16x32_bf16 v[176:179], v[32:35], v[220:223], v[176:179]
    ds_read_b64_tr_b16 v[224:225], v106 offset:49152
    v_add_u32 v48, s45, v7
    v_mfma_f32_16x16x32_bf16 v[180:183], v[36:39], v[220:223], v[180:183]
    ds_read_b64_tr_b16 v[226:227], v106 offset:51200
    v_xor_b32 v49, 32, v48
    v_mfma_f32_16x16x32_bf16 v[164:167], v[36:39], v[216:219], v[164:167]
    ds_read_b128 v[192:195], v104 offset:32768
    v_xor_b32 v50, 64, v48
    v_mfma_f32_16x16x32_bf16 v[148:151], v[36:39], v[212:215], v[148:151]
    ds_read_b128 v[196:199], v104 offset:33792
    v_xor_b32 v51, 96, v48
    v_mfma_f32_16x16x32_bf16 v[132:135], v[36:39], v[208:211], v[132:135]
    ds_read_b128 v[200:203], v105 offset:32768
    v_lshrrev_b32 v7, 3, v2
    v_mfma_f32_16x16x32_bf16 v[136:139], v[40:43], v[208:211], v[136:139]
    ds_read_b128 v[204:207], v105 offset:33792
    v_and_b32 v10, 7, v2
    v_mfma_f32_16x16x32_bf16 v[152:155], v[40:43], v[212:215], v[152:155]
    ds_read_b64_tr_b16 v[228:229], v107 offset:49152
    v_lshlrev_b32 v53, 11, v7
    v_mfma_f32_16x16x32_bf16 v[168:171], v[40:43], v[216:219], v[168:171]
    ds_read_b64_tr_b16 v[230:231], v107 offset:51200
    v_lshl_add_u32 v53, v10, 4, v53
    v_mfma_f32_16x16x32_bf16 v[184:187], v[40:43], v[220:223], v[184:187]
    ds_read_b64_tr_b16 v[232:233], v108 offset:49152
    v_add_u32 v54, 16384, v53
    v_mfma_f32_16x16x32_bf16 v[188:191], v[44:47], v[220:223], v[188:191]
    ds_read_b64_tr_b16 v[234:235], v108 offset:51200
    v_xor_b32 v10, v10, v7
    v_mfma_f32_16x16x32_bf16 v[172:175], v[44:47], v[216:219], v[172:175]
    ds_read_b64_tr_b16 v[236:237], v109 offset:49152
    v_lshlrev_b32 v10, 4, v10
    v_mfma_f32_16x16x32_bf16 v[156:159], v[44:47], v[212:215], v[156:159]
    ds_read_b64_tr_b16 v[238:239], v109 offset:51200
    v_lshl_add_u32 v10, v7, 7, v10
    v_mfma_f32_16x16x32_bf16 v[140:143], v[44:47], v[208:211], v[140:143]
    v_add_u32 v52, s45, v10
C_p4end:
    s_mov_b32 s49, 1
    s_nop 5
    v_cvt_pk_bf16_f32 v12, v160, v161
    v_cvt_pk_bf16_f32 v13, v162, v163
    v_cvt_pk_bf16_f32 v14, v164, v165
    v_cvt_pk_bf16_f32 v15, v166, v167
    buffer_store_dwordx4 v[12:15], v9, s[4:7], s29 offen offset:0 sc1
    v_cvt_pk_bf16_f32 v16, v168, v169
    v_cvt_pk_bf16_f32 v17, v170, v171
    v_cvt_pk_bf16_f32 v18, v172, v173
    v_cvt_pk_bf16_f32 v19, v174, v175
    buffer_store_dwordx4 v[16:19], v9, s[4:7], s29 offen offset:1024 sc1
    v_cvt_pk_bf16_f32 v20, v176, v177
    v_cvt_pk_bf16_f32 v21, v178, v179
    v_cvt_pk_bf16_f32 v22, v180, v181
    v_cvt_pk_bf16_f32 v23, v182, v183
    buffer_store_dwordx4 v[20:23], v9, s[4:7], s29 offen offset:2048 sc1
    v_cvt_pk_bf16_f32 v24, v184, v185
    v_cvt_pk_bf16_f32 v25, v186, v187
    v_cvt_pk_bf16_f32 v26, v188, v189
    v_cvt_pk_bf16_f32 v27, v190, v191
    buffer_store_dwordx4 v[24:27], v9, s[4:7], s29 offen offset:3072 sc1
    s_waitcnt lgkmcnt(0)
    s_waitcnt lgkmcnt(7)
    v_mfma_f32_16x16x32_bf16 v[128:131], v[224:227], v[192:195], v[128:131]
    ds_read_b64_tr_b16 v[32:33], v106 offset:53248
    ds_read_b64_tr_b16 v[34:35], v106 offset:55296
    s_waitcnt lgkmcnt(8)
    v_mfma_f32_16x16x32_bf16 v[144:147], v[224:227], v[196:199], v[144:147]
    ds_read_b128 v[208:211], v104 offset:40960
    ds_read_b128 v[212:215], v104 offset:41984
    s_waitcnt lgkmcnt(8)
    v_mfma_f32_16x16x32_bf16 v[148:151], v[228:231], v[196:199], v[148:151]
    ds_read_b64_tr_b16 v[36:37], v107 offset:53248
    ds_read_b64_tr_b16 v[38:39], v107 offset:55296
    v_mfma_f32_16x16x32_bf16 v[132:135], v[228:231], v[192:195], v[132:135]
    ds_read_b64_tr_b16 v[40:41], v108 offset:53248
    ds_read_b64_tr_b16 v[42:43], v108 offset:55296
    s_waitcnt lgkmcnt(8)
    v_mfma_f32_16x16x32_bf16 v[136:139], v[232:235], v[192:195], v[136:139]
    ds_read_b64_tr_b16 v[44:45], v109 offset:53248
    ds_read_b64_tr_b16 v[46:47], v109 offset:55296
    v_mfma_f32_16x16x32_bf16 v[152:155], v[232:235], v[196:199], v[152:155]
    v_mfma_f32_16x16x32_bf16 v[156:159], v[236:239], v[196:199], v[156:159]
    v_mfma_f32_16x16x32_bf16 v[140:143], v[236:239], v[192:195], v[140:143]
    s_waitcnt lgkmcnt(7)
    v_mfma_f32_16x16x32_bf16 v[128:131], v[32:35], v[208:211], v[128:131]
    s_waitcnt lgkmcnt(0)
    v_mfma_f32_16x16x32_bf16 v[144:147], v[32:35], v[212:215], v[144:147]
    s_barrier
    v_mfma_f32_16x16x32_bf16 v[148:151], v[36:39], v[212:215], v[148:151]
    ds_read_b64_tr_b16 v[224:225], v112 offset:16384
    ds_read_b64_tr_b16 v[226:227], v112 offset:18432
    v_mfma_f32_16x16x32_bf16 v[132:135], v[36:39], v[208:211], v[132:135]
    ds_read_b128 v[192:195], v110 offset:0
    ds_read_b128 v[196:199], v110 offset:1024
    v_mfma_f32_16x16x32_bf16 v[136:139], v[40:43], v[208:211], v[136:139]
    ds_read_b64_tr_b16 v[228:229], v113 offset:16384
    ds_read_b64_tr_b16 v[230:231], v113 offset:18432
    v_mfma_f32_16x16x32_bf16 v[152:155], v[40:43], v[212:215], v[152:155]
    ds_read_b64_tr_b16 v[232:233], v114 offset:16384
    ds_read_b64_tr_b16 v[234:235], v114 offset:18432
    v_mfma_f32_16x16x32_bf16 v[156:159], v[44:47], v[212:215], v[156:159]
    ds_read_b64_tr_b16 v[236:237], v115 offset:16384
    ds_read_b64_tr_b16 v[238:239], v115 offset:18432
    v_mfma_f32_16x16x32_bf16 v[140:143], v[44:47], v[208:211], v[140:143]
    s_getreg_b32 s3, hwreg(HW_REG_IB_STS, 0, 4)
    s_cmp_ge_u32 s3, s49
    s_cbranch_scc1 L_tf_81
    s_waitcnt vmcnt(0)
    s_mov_b32 s49, 0
    v_mov_b32 v1, s12
    s_mov_b64 exec, 1
    buffer_store_dword v1, off, s[4:7], s47 sc1
    s_mov_b64 exec, -1
L_tf_81:
    s_waitcnt lgkmcnt(7)
    v_mfma_f32_16x16x32_bf16 v[128:131], v[224:227], v[192:195], v[128:131]
    ds_read_b64_tr_b16 v[32:33], v112 offset:20480
    ds_read_b64_tr_b16 v[34:35], v112 offset:22528
    s_waitcnt lgkmcnt(8)
    v_mfma_f32_16x16x32_bf16 v[144:147], v[224:227], v[196:199], v[144:147]
    ds_read_b128 v[208:211], v110 offset:8192
    ds_read_b128 v[212:215], v110 offset:9216
    s_waitcnt lgkmcnt(8)
    v_mfma_f32_16x16x32_bf16 v[148:151], v[228:231], v[196:199], v[148:151]
    ds_read_b64_tr_b16 v[36:37], v113 offset:20480
    ds_read_b64_tr_b16 v[38:39], v113 offset:22528
    v_mfma_f32_16x16x32_bf16 v[132:135], v[228:231], v[192:195], v[132:135]
    ds_read_b64_tr_b16 v[40:41], v114 offset:20480
    ds_read_b64_tr_b16 v[42:43], v114 offset:22528
    s_waitcnt lgkmcnt(8)
    v_mfma_f32_16x16x32_bf16 v[136:139], v[232:235], v[192:195], v[136:139]
    ds_read_b64_tr_b16 v[44:45], v115 offset:20480
    ds_read_b64_tr_b16 v[46:47], v115 offset:22528
    v_mfma_f32_16x16x32_bf16 v[152:155], v[232:235], v[196:199], v[152:155]
    v_mfma_f32_16x16x32_bf16 v[156:159], v[236:239], v[196:199], v[156:159]
    v_mfma_f32_16x16x32_bf16 v[140:143], v[236:239], v[192:195], v[140:143]
    s_waitcnt lgkmcnt(7)
    v_mfma_f32_16x16x32_bf16 v[128:131], v[32:35], v[208:211], v[128:131]
    s_waitcnt lgkmcnt(0)
    v_mfma_f32_16x16x32_bf16 v[144:147], v[32:35], v[212:215], v[144:147]
    s_barrier
    v_mfma_f32_16x16x32_bf16 v[148:151], v[36:39], v[212:215], v[148:151]
    ds_read_b64_tr_b16 v[224:225], v112 offset:49152
    ds_read_b64_tr_b16 v[226:227], v112 offset:51200
    v_mfma_f32_16x16x32_bf16 v[132:135], v[36:39], v[208:211], v[132:135]
    ds_read_b128 v[192:195], v110 offset:32768
    ds_read_b128 v[196:199], v110 offset:33792
    v_mfma_f32_16x16x32_bf16 v[136:139], v[40:43], v[208:211], v[136:139]
    ds_read_b64_tr_b16 v[228:229], v113 offset:49152
    ds_read_b64_tr_b16 v[230:231], v113 offset:51200
    v_mfma_f32_16x16x32_bf16 v[152:155], v[40:43], v[212:215], v[152:155]
    ds_read_b64_tr_b16 v[232:233], v114 offset:49152
    ds_read_b64_tr_b16 v[234:235], v114 offset:51200
    v_mfma_f32_16x16x32_bf16 v[156:159], v[44:47], v[212:215], v[156:159]
    ds_read_b64_tr_b16 v[236:237], v115 offset:49152
    ds_read_b64_tr_b16 v[238:239], v115 offset:51200
    v_mfma_f32_16x16x32_bf16 v[140:143], v[44:47], v[208:211], v[140:143]
    s_getreg_b32 s3, hwreg(HW_REG_IB_STS, 0, 4)
    s_cmp_ge_u32 s3, s49
    s_cbranch_scc1 L_tf_82
    s_waitcnt vmcnt(0)
    s_mov_b32 s49, 0
    v_mov_b32 v1, s12
    s_mov_b64 exec, 1
    buffer_store_dword v1, off, s[4:7], s47 sc1
    s_mov_b64 exec, -1
L_tf_82:
    s_waitcnt lgkmcnt(7)
    v_mfma_f32_16x16x32_bf16 v[128:131], v[224:227], v[192:195], v[128:131]
    ds_read_b64_tr_b16 v[32:33], v112 offset:53248
    ds_read_b64_tr_b16 v[34:35], v112 offset:55296
    s_waitcnt lgkmcnt(8)
    v_mfma_f32_16x16x32_bf16 v[144:147], v[224:227], v[196:199], v[144:147]
    ds_read_b128 v[208:211], v110 offset:40960
    ds_read_b128 v[212:215], v110 offset:41984
    s_waitcnt lgkmcnt(8)
    v_mfma_f32_16x16x32_bf16 v[148:151], v[228:231], v[196:199], v[148:151]
    ds_read_b64_tr_b16 v[36:37], v113 offset:53248
    ds_read_b64_tr_b16 v[38:39], v113 offset:55296
    v_mfma_f32_16x16x32_bf16 v[132:135], v[228:231], v[192:195], v[132:135]
    ds_read_b64_tr_b16 v[40:41], v114 offset:53248
    ds_read_b64_tr_b16 v[42:43], v114 offset:55296
    s_waitcnt lgkmcnt(8)
    v_mfma_f32_16x16x32_bf16 v[136:139], v[232:235], v[192:195], v[136:139]
    ds_read_b64_tr_b16 v[44:45], v115 offset:53248
    ds_read_b64_tr_b16 v[46:47], v115 offset:55296
    v_mfma_f32_16x16x32_bf16 v[152:155], v[232:235], v[196:199], v[152:155]
    v_mfma_f32_16x16x32_bf16 v[156:159], v[236:239], v[196:199], v[156:159]
    v_mfma_f32_16x16x32_bf16 v[140:143], v[236:239], v[192:195], v[140:143]
    s_waitcnt lgkmcnt(7)
    v_mfma_f32_16x16x32_bf16 v[128:131], v[32:35], v[208:211], v[128:131]
    s_waitcnt lgkmcnt(0)
    v_mfma_f32_16x16x32_bf16 v[144:147], v[32:35], v[212:215], v[144:147]
    s_barrier
    v_mfma_f32_16x16x32_bf16 v[148:151], v[36:39], v[212:215], v[148:151]
    ds_read_b64_tr_b16 v[224:225], v106 offset:16384
    ds_read_b64_tr_b16 v[226:227], v106 offset:18432
    v_mfma_f32_16x16x32_bf16 v[132:135], v[36:39], v[208:211], v[132:135]
    ds_read_b128 v[192:195], v104 offset:0
    ds_read_b128 v[196:199], v104 offset:1024
    v_mfma_f32_16x16x32_bf16 v[136:139], v[40:43], v[208:211], v[136:139]
    ds_read_b64_tr_b16 v[228:229], v107 offset:16384
    ds_read_b64_tr_b16 v[230:231], v107 offset:18432
    v_mfma_f32_16x16x32_bf16 v[152:155], v[40:43], v[212:215], v[152:155]
    ds_read_b64_tr_b16 v[232:233], v108 offset:16384
    ds_read_b64_tr_b16 v[234:235], v108 offset:18432
    v_mfma_f32_16x16x32_bf16 v[156:159], v[44:47], v[212:215], v[156:159]
    ds_read_b64_tr_b16 v[236:237], v109 offset:16384
    ds_read_b64_tr_b16 v[238:239], v109 offset:18432
    v_mfma_f32_16x16x32_bf16 v[140:143], v[44:47], v[208:211], v[140:143]
    s_getreg_b32 s3, hwreg(HW_REG_IB_STS, 0, 4)
    s_cmp_ge_u32 s3, s49
    s_cbranch_scc1 L_tf_83
    s_waitcnt vmcnt(0)
    s_mov_b32 s49, 0
    v_mov_b32 v1, s12
    s_mov_b64 exec, 1
    buffer_store_dword v1, off, s[4:7], s47 sc1
    s_mov_b64 exec, -1
L_tf_83:
    s_waitcnt lgkmcnt(7)
    v_mfma_f32_16x16x32_bf16 v[128:131], v[224:227], v[192:195], v[128:131]
    ds_read_b64_tr_b16 v[32:33], v106 offset:20480
    ds_read_b64_tr_b16 v[34:35], v106 offset:22528
    s_waitcnt lgkmcnt(8)
    v_mfma_f32_16x16x32_bf16 v[144:147], v[224:227], v[196:199], v[144:147]
    ds_read_b128 v[208:211], v104 offset:8192
    ds_read_b128 v[212:215], v104 offset:9216
    s_waitcnt lgkmcnt(8)
    v_mfma_f32_16x16x32_bf16 v[148:151], v[228:231], v[196:199], v[148:151]
    ds_read_b64_tr_b16 v[36:37], v107 offset:20480
    ds_read_b64_tr_b16 v[38:39], v107 offset:22528
    v_mfma_f32_16x16x32_bf16 v[132:135], v[228:231], v[192:195], v[132:135]
    ds_read_b64_tr_b16 v[40:41], v108 offset:20480
    ds_read_b64_tr_b16 v[42:43], v108 offset:22528
    s_waitcnt lgkmcnt(8)
    v_mfma_f32_16x16x32_bf16 v[136:139], v[232:235], v[192:195], v[136:139]
    ds_read_b64_tr_b16 v[44:45], v109 offset:20480
    ds_read_b64_tr_b16 v[46:47], v109 offset:22528
    v_mfma_f32_16x16x32_bf16 v[152:155], v[232:235], v[196:199], v[152:155]
    v_mfma_f32_16x16x32_bf16 v[156:159], v[236:239], v[196:199], v[156:159]
    v_mfma_f32_16x16x32_bf16 v[140:143], v[236:239], v[192:195], v[140:143]
    s_waitcnt lgkmcnt(7)
    v_mfma_f32_16x16x32_bf16 v[128:131], v[32:35], v[208:211], v[128:131]
    s_waitcnt lgkmcnt(0)
    v_mfma_f32_16x16x32_bf16 v[144:147], v[32:35], v[212:215], v[144:147]
    s_barrier
    v_mfma_f32_16x16x32_bf16 v[148:151], v[36:39], v[212:215], v[148:151]
    ds_read_b64_tr_b16 v[224:225], v106 offset:49152
    ds_read_b64_tr_b16 v[226:227], v106 offset:51200
    v_mfma_f32_16x16x32_bf16 v[132:135], v[36:39], v[208:211], v[132:135]
    ds_read_b128 v[192:195], v104 offset:32768
    ds_read_b128 v[196:199], v104 offset:33792
    v_mfma_f32_16x16x32_bf16 v[136:139], v[40:43], v[208:211], v[136:139]
    ds_read_b64_tr_b16 v[228:229], v107 offset:49152
    ds_read_b64_tr_b16 v[230:231], v107 offset:51200
    v_mfma_f32_16x16x32_bf16 v[152:155], v[40:43], v[212:215], v[152:155]
    ds_read_b64_tr_b16 v[232:233], v108 offset:49152
    ds_read_b64_tr_b16 v[234:235], v108 offset:51200
    v_mfma_f32_16x16x32_bf16 v[156:159], v[44:47], v[212:215], v[156:159]
    ds_read_b64_tr_b16 v[236:237], v109 offset:49152
    ds_read_b64_tr_b16 v[238:239], v109 offset:51200
    v_mfma_f32_16x16x32_bf16 v[140:143], v[44:47], v[208:211], v[140:143]
    s_getreg_b32 s3, hwreg(HW_REG_IB_STS, 0, 4)
    s_cmp_ge_u32 s3, s49
    s_cbranch_scc1 L_tf_84
    s_waitcnt vmcnt(0)
    s_mov_b32 s49, 0
    v_mov_b32 v1, s12
    s_mov_b64 exec, 1
    buffer_store_dword v1, off, s[4:7], s47 sc1
    s_mov_b64 exec, -1
L_tf_84:
    s_waitcnt lgkmcnt(7)
    v_mfma_f32_16x16x32_bf16 v[128:131], v[224:227], v[192:195], v[128:131]
    ds_read_b64_tr_b16 v[32:33], v106 offset:53248
    ds_read_b64_tr_b16 v[34:35], v106 offset:55296
    s_waitcnt lgkmcnt(8)
    v_mfma_f32_16x16x32_bf16 v[144:147], v[224:227], v[196:199], v[144:147]
    ds_read_b128 v[208:211], v104 offset:40960
    ds_read_b128 v[212:215], v104 offset:41984
    s_waitcnt lgkmcnt(8)
    v_mfma_f32_16x16x32_bf16 v[148:151], v[228:231], v[196:199], v[148:151]
    ds_read_b64_tr_b16 v[36:37], v107 offset:53248
    ds_read_b64_tr_b16 v[38:39], v107 offset:55296
    v_mfma_f32_16x16x32_bf16 v[132:135], v[228:231], v[192:195], v[132:135]
    ds_read_b64_tr_b16 v[40:41], v108 offset:53248
    ds_read_b64_tr_b16 v[42:43], v108 offset:55296
    s_waitcnt lgkmcnt(8)
    v_mfma_f32_16x16x32_bf16 v[136:139], v[232:235], v[192:195], v[136:139]
    ds_read_b64_tr_b16 v[44:45], v109 offset:53248
    ds_read_b64_tr_b16 v[46:47], v109 offset:55296
    v_mfma_f32_16x16x32_bf16 v[152:155], v[232:235], v[196:199], v[152:155]
    v_mfma_f32_16x16x32_bf16 v[156:159], v[236:239], v[196:199], v[156:159]
    v_mfma_f32_16x16x32_bf16 v[140:143], v[236:239], v[192:195], v[140:143]
    s_waitcnt lgkmcnt(7)
    v_mfma_f32_16x16x32_bf16 v[128:131], v[32:35], v[208:211], v[128:131]
    s_waitcnt lgkmcnt(0)
    v_mfma_f32_16x16x32_bf16 v[144:147], v[32:35], v[212:215], v[144:147]
    s_barrier
    v_mfma_f32_16x16x32_bf16 v[148:151], v[36:39], v[212:215], v[148:151]
    ds_read_b64_tr_b16 v[224:225], v112 offset:16384
    ds_read_b64_tr_b16 v[226:227], v112 offset:18432
    v_mfma_f32_16x16x32_bf16 v[132:135], v[36:39], v[208:211], v[132:135]
    ds_read_b128 v[192:195], v110 offset:0
    ds_read_b128 v[196:199], v110 offset:1024
    v_mfma_f32_16x16x32_bf16 v[136:139], v[40:43], v[208:211], v[136:139]
    ds_read_b64_tr_b16 v[228:229], v113 offset:16384
    ds_read_b64_tr_b16 v[230:231], v113 offset:18432
    v_mfma_f32_16x16x32_bf16 v[152:155], v[40:43], v[212:215], v[152:155]
    ds_read_b64_tr_b16 v[232:233], v114 offset:16384
    ds_read_b64_tr_b16 v[234:235], v114 offset:18432
    v_mfma_f32_16x16x32_bf16 v[156:159], v[44:47], v[212:215], v[156:159]
    ds_read_b64_tr_b16 v[236:237], v115 offset:16384
    ds_read_b64_tr_b16 v[238:239], v115 offset:18432
    v_mfma_f32_16x16x32_bf16 v[140:143], v[44:47], v[208:211], v[140:143]
    s_getreg_b32 s3, hwreg(HW_REG_IB_STS, 0, 4)
    s_cmp_ge_u32 s3, s49
    s_cbranch_scc1 L_tf_85
    s_waitcnt vmcnt(0)
    s_mov_b32 s49, 0
    v_mov_b32 v1, s12
    s_mov_b64 exec, 1
    buffer_store_dword v1, off, s[4:7], s47 sc1
    s_mov_b64 exec, -1
L_tf_85:
    s_waitcnt lgkmcnt(7)
    v_mfma_f32_16x16x32_bf16 v[128:131], v[224:227], v[192:195], v[128:131]
    ds_read_b64_tr_b16 v[32:33], v112 offset:20480
    ds_read_b64_tr_b16 v[34:35], v112 offset:22528
    s_waitcnt lgkmcnt(8)
    v_mfma_f32_16x16x32_bf16 v[144:147], v[224:227], v[196:199], v[144:147]
    ds_read_b128 v[208:211], v110 offset:8192
    ds_read_b128 v[212:215], v110 offset:9216
    s_waitcnt lgkmcnt(8)
    v_mfma_f32_16x16x32_bf16 v[148:151], v[228:231], v[196:199], v[148:151]
    ds_read_b64_tr_b16 v[36:37], v113 offset:20480
    ds_read_b64_tr_b16 v[38:39], v113 offset:22528
    v_mfma_f32_16x16x32_bf16 v[132:135], v[228:231], v[192:195], v[132:135]
    ds_read_b64_tr_b16 v[40:41], v114 offset:20480
    ds_read_b64_tr_b16 v[42:43], v114 offset:22528
    s_waitcnt lgkmcnt(8)
    v_mfma_f32_16x16x32_bf16 v[136:139], v[232:235], v[192:195], v[136:139]
    ds_read_b64_tr_b16 v[44:45], v115 offset:20480
    ds_read_b64_tr_b16 v[46:47], v115 offset:22528
    v_mfma_f32_16x16x32_bf16 v[152:155], v[232:235], v[196:199], v[152:155]
    v_mfma_f32_16x16x32_bf16 v[156:159], v[236:239], v[196:199], v[156:159]
    v_mfma_f32_16x16x32_bf16 v[140:143], v[236:239], v[192:195], v[140:143]
    s_waitcnt lgkmcnt(7)
    v_mfma_f32_16x16x32_bf16 v[128:131], v[32:35], v[208:211], v[128:131]
    s_waitcnt lgkmcnt(0)
    v_mfma_f32_16x16x32_bf16 v[144:147], v[32:35], v[212:215], v[144:147]
    v_mfma_f32_16x16x32_bf16 v[148:151], v[36:39], v[212:215], v[148:151]
    v_mfma_f32_16x16x32_bf16 v[132:135], v[36:39], v[208:211], v[132:135]
    v_mfma_f32_16x16x32_bf16 v[136:139], v[40:43], v[208:211], v[136:139]
    v_mfma_f32_16x16x32_bf16 v[152:155], v[40:43], v[212:215], v[152:155]
    v_mfma_f32_16x16x32_bf16 v[156:159], v[44:47], v[212:215], v[156:159]
    v_mfma_f32_16x16x32_bf16 v[140:143], v[44:47], v[208:211], v[140:143]
    s_cmp_eq_u32 s49, 0
    s_cbranch_scc1 L_tf_86
    s_waitcnt vmcnt(0)
    s_mov_b32 s49, 0
    v_mov_b32 v1, s12
    s_mov_b64 exec, 1
    buffer_store_dword v1, off, s[4:7], s47 sc1
    s_mov_b64 exec, -1
L_tf_86:
    s_nop 4
    v_pk_add_f32 v[128:129], v[128:129], v[64:65]
    v_pk_add_f32 v[130:131], v[130:131], v[66:67]
    v_pk_add_f32 v[132:133], v[132:133], v[68:69]
    v_pk_add_f32 v[134:135], v[134:135], v[70:71]
    v_pk_add_f32 v[136:137], v[136:137], v[72:73]
    v_pk_add_f32 v[138:139], v[138:139], v[74:75]
    v_pk_add_f32 v[140:141], v[140:141], v[76:77]
    v_pk_add_f32 v[142:143], v[142:143], v[78:79]
    v_pk_add_f32 v[144:145], v[144:145], v[80:81]
    v_pk_add_f32 v[146:147], v[146:147], v[82:83]
    v_pk_add_f32 v[148:149], v[148:149], v[84:85]
    v_pk_add_f32 v[150:151], v[150:151], v[86:87]
    v_pk_add_f32 v[152:153], v[152:153], v[88:89]
    v_pk_add_f32 v[154:155], v[154:155], v[90:91]
    v_pk_add_f32 v[156:157], v[156:157], v[92:93]
    v_pk_add_f32 v[158:159], v[158:159], v[94:95]
    s_waitcnt lgkmcnt(0)
    s_barrier
    ds_read_b128 v[192:195], v6 offset:0
    ds_read_b128 v[196:199], v6 offset:1024
    ds_read_b128 v[200:203], v6 offset:2048
    ds_read_b128 v[204:207], v6 offset:3072
    s_waitcnt lgkmcnt(3)
    v_lshlrev_b32 v22, 16, v192
    v_and_b32 v23, v8, v192
    v_pk_add_f32 v[128:129], v[128:129], v[22:23]
    v_lshlrev_b32 v22, 16, v193
    v_and_b32 v23, v8, v193
    v_pk_add_f32 v[130:131], v[130:131], v[22:23]
    v_lshlrev_b32 v22, 16, v194
    v_and_b32 v23, v8, v194
    v_pk_add_f32 v[132:133], v[132:133], v[22:23]
    v_lshlrev_b32 v22, 16, v195
    v_and_b32 v23, v8, v195
    v_pk_add_f32 v[134:135], v[134:135], v[22:23]
    v_cvt_pk_bf16_f32 v96, v128, v129
    v_cvt_pk_bf16_f32 v97, v130, v131
    v_cvt_pk_bf16_f32 v98, v132, v133
    v_cvt_pk_bf16_f32 v99, v134, v135
    ds_write_b64 v48, v[96:97] offset:0
    ds_write_b64 v49, v[98:99] offset:0
    s_waitcnt lgkmcnt(2)
    v_lshlrev_b32 v22, 16, v196
    v_and_b32 v23, v8, v196
    v_pk_add_f32 v[136:137], v[136:137], v[22:23]
    v_lshlrev_b32 v22, 16, v197
    v_and_b32 v23, v8, v197
    v_pk_add_f32 v[138:139], v[138:139], v[22:23]
    v_lshlrev_b32 v22, 16, v198
    v_and_b32 v23, v8, v198
    v_pk_add_f32 v[140:141], v[140:141], v[22:23]
    v_lshlrev_b32 v22, 16, v199
    v_and_b32 v23, v8, v199
    v_pk_add_f32 v[142:143], v[142:143], v[22:23]
    v_cvt_pk_bf16_f32 v100, v136, v137
    v_cvt_pk_bf16_f32 v101, v138, v139
    v_cvt_pk_bf16_f32 v102, v140, v141
    v_cvt_pk_bf16_f32 v103, v142, v143
    ds_write_b64 v50, v[100:101] offset:0
    ds_write_b64 v51, v[102:103] offset:0
    ds_read_b128 v[208:211], v52 offset:0
    ds_read_b128 v[212:215], v52 offset:1024
    v_lshlrev_b32 v22, 16, v200
    v_and_b32 v23, v8, v200
    v_pk_add_f32 v[144:145], v[144:145], v[22:23]
    v_lshlrev_b32 v22, 16, v201
    v_and_b32 v23, v8, v201
    v_pk_add_f32 v[146:147], v[146:147], v[22:23]
    v_lshlrev_b32 v22, 16, v202
    v_and_b32 v23, v8, v202
    v_pk_add_f32 v[148:149], v[148:149], v[22:23]
    v_lshlrev_b32 v22, 16, v203
    v_and_b32 v23, v8, v203
    v_pk_add_f32 v[150:151], v[150:151], v[22:23]
    v_cvt_pk_bf16_f32 v104, v144, v145
    v_cvt_pk_bf16_f32 v105, v146, v147
    v_cvt_pk_bf16_f32 v106, v148, v149
    v_cvt_pk_bf16_f32 v107, v150, v151
    ds_write_b64 v48, v[104:105] offset:2048
    ds_write_b64 v49, v[106:107] offset:2048
    v_lshlrev_b32 v22, 16, v204
    v_and_b32 v23, v8, v204
    v_pk_add_f32 v[152:153], v[152:153], v[22:23]
    v_lshlrev_b32 v22, 16, v205
    v_and_b32 v23, v8, v205
    v_pk_add_f32 v[154:155], v[154:155], v[22:23]
    v_lshlrev_b32 v22, 16, v206
    v_and_b32 v23, v8, v206
    v_pk_add_f32 v[156:157], v[156:157], v[22:23]
    v_lshlrev_b32 v22, 16, v207
    v_and_b32 v23, v8, v207
    v_pk_add_f32 v[158:159], v[158:159], v[22:23]
    v_cvt_pk_bf16_f32 v108, v152, v153
    v_cvt_pk_bf16_f32 v109, v154, v155
    v_cvt_pk_bf16_f32 v110, v156, v157
    v_cvt_pk_bf16_f32 v111, v158, v159
    s_waitcnt lgkmcnt(2)
    buffer_store_dwordx4 v[208:211], v53, s[24:27], s44 offen sc1
    buffer_store_dwordx4 v[212:215], v54, s[24:27], s44 offen sc1
    ds_write_b64 v50, v[108:109] offset:2048
    ds_write_b64 v51, v[110:111] offset:2048
    ds_read_b128 v[216:219], v52 offset:2048
    ds_read_b128 v[220:223], v52 offset:3072
    s_waitcnt lgkmcnt(1)
    buffer_store_dwordx4 v[216:219], v53, s[24:27], s43 offen sc1
    s_waitcnt lgkmcnt(0)
    buffer_store_dwordx4 v[220:223], v54, s[24:27], s43 offen sc1
    s_endpgm
C_slow:
L_slow_72:
    s_waitcnt lgkmcnt(0)
    v_mov_b64 v[128:129], 0
    v_mov_b64 v[130:131], 0
    v_mov_b64 v[132:133], 0
    v_mov_b64 v[134:135], 0
    v_mov_b64 v[136:137], 0
    v_mov_b64 v[138:139], 0
    v_mov_b64 v[140:141], 0
    v_mov_b64 v[142:143], 0
    v_mov_b64 v[144:145], 0
    v_mov_b64 v[146:147], 0
    v_mov_b64 v[148:149], 0
    v_mov_b64 v[150:151], 0
    v_mov_b64 v[152:153], 0
    v_mov_b64 v[154:155], 0
    v_mov_b64 v[156:157], 0
    v_mov_b64 v[158:159], 0
    v_mov_b64 v[192:193], 0
    v_mov_b64 v[194:195], 0
    v_mov_b64 v[196:197], 0
    v_mov_b64 v[198:199], 0
    v_mov_b32 v14, 0xff7fffff
    v_mov_b32 v15, 0xff7fffff
    s_lshl_b32 s41, s17, 19
    s_lshl_b32 s3, s20, 14
    s_add_u32 s41, s41, s3
    s_add_u32 s41, s41, 4194304
    s_mov_b32 s40, 64
L_sloop_87:
    buffer_load_dwordx4 v[24:27], v11, s[4:7], s41 offen offset:0 sc1
    buffer_load_dwordx4 v[28:31], v11, s[4:7], s41 offen offset:1024 sc1
    buffer_load_dwordx4 v[40:43], v11, s[4:7], s41 offen offset:2048 sc1
    buffer_load_dwordx4 v[44:47], v11, s[4:7], s41 offen offset:3072 sc1
    s_waitcnt vmcnt(0)
    v_mfma_f32_32x32x16_bf16 v[64:79], v[24:27], v[200:203], 0
    v_mfma_f32_32x32x16_bf16 v[64:79], v[28:31], v[204:207], v[64:79]
    v_mfma_f32_32x32x16_bf16 v[80:95], v[24:27], v[208:211], 0
    v_mfma_f32_32x32x16_bf16 v[80:95], v[28:31], v[212:215], v[80:95]
    s_nop 15
    v_max3_f32 v6, v64, v65, v14
    v_max3_f32 v6, v66, v67, v6
    v_max3_f32 v6, v68, v69, v6
    v_max3_f32 v6, v70, v71, v6
    v_max3_f32 v6, v72, v73, v6
    v_max3_f32 v6, v74, v75, v6
    v_max3_f32 v6, v76, v77, v6
    v_max3_f32 v6, v78, v79, v6
    v_mov_b32 v5, v6
    s_nop 1
    v_permlane32_swap_b32 v5, v6
    s_nop 1
    v_max_f32 v6, v6, v5
    v_sub_f32 v5, v14, v6
    v_exp_f32 v5, v5
    v_mov_b32 v14, v6
    v_sub_f32 v64, v64, v6
    v_sub_f32 v65, v65, v6
    v_sub_f32 v66, v66, v6
    v_sub_f32 v67, v67, v6
    v_sub_f32 v68, v68, v6
    v_sub_f32 v69, v69, v6
    v_sub_f32 v70, v70, v6
    v_sub_f32 v71, v71, v6
    v_sub_f32 v72, v72, v6
    v_sub_f32 v73, v73, v6
    v_sub_f32 v74, v74, v6
    v_sub_f32 v75, v75, v6
    v_sub_f32 v76, v76, v6
    v_sub_f32 v77, v77, v6
    v_sub_f32 v78, v78, v6
    v_sub_f32 v79, v79, v6
    v_exp_f32 v64, v64
    v_exp_f32 v65, v65
    v_exp_f32 v66, v66
    v_exp_f32 v67, v67
    v_exp_f32 v68, v68
    v_exp_f32 v69, v69
    v_exp_f32 v70, v70
    v_exp_f32 v71, v71
    v_exp_f32 v72, v72
    v_exp_f32 v73, v73
    v_exp_f32 v74, v74
    v_exp_f32 v75, v75
    v_exp_f32 v76, v76
    v_exp_f32 v77, v77
    v_exp_f32 v78, v78
    v_exp_f32 v79, v79
    v_mul_f32 v128, v128, v5
    v_mul_f32 v129, v129, v5
    v_mul_f32 v130, v130, v5
    v_mul_f32 v131, v131, v5
    v_mul_f32 v132, v132, v5
    v_mul_f32 v133, v133, v5
    v_mul_f32 v134, v134, v5
    v_mul_f32 v135, v135, v5
    v_mul_f32 v136, v136, v5
    v_mul_f32 v137, v137, v5
    v_mul_f32 v138, v138, v5
    v_mul_f32 v139, v139, v5
    v_mul_f32 v140, v140, v5
    v_mul_f32 v141, v141, v5
    v_mul_f32 v142, v142, v5
    v_mul_f32 v143, v143, v5
    v_mul_f32 v192, v192, v5
    v_mul_f32 v193, v193, v5
    v_mul_f32 v194, v194, v5
    v_mul_f32 v195, v195, v5
    s_nop 1
    v_smfmac_f32_32x32x32_bf16 v[128:143], v[40:43], v[64:71], v19
    v_smfmac_f32_16x16x64_bf16 v[192:195], v[20:23], v[64:71], v19
    v_smfmac_f32_32x32x32_bf16 v[128:143], v[44:47], v[72:79], v19
    v_smfmac_f32_16x16x64_bf16 v[192:195], v[20:23], v[72:79], v19
    v_max3_f32 v6, v80, v81, v15
    v_max3_f32 v6, v82, v83, v6
    v_max3_f32 v6, v84, v85, v6
    v_max3_f32 v6, v86, v87, v6
    v_max3_f32 v6, v88, v89, v6
    v_max3_f32 v6, v90, v91, v6
    v_max3_f32 v6, v92, v93, v6
    v_max3_f32 v6, v94, v95, v6
    v_mov_b32 v5, v6
    s_nop 1
    v_permlane32_swap_b32 v5, v6
    s_nop 1
    v_max_f32 v6, v6, v5
    v_sub_f32 v5, v15, v6
    v_exp_f32 v5, v5
    v_mov_b32 v15, v6
    v_sub_f32 v80, v80, v6
    v_sub_f32 v81, v81, v6
    v_sub_f32 v82, v82, v6
    v_sub_f32 v83, v83, v6
    v_sub_f32 v84, v84, v6
    v_sub_f32 v85, v85, v6
    v_sub_f32 v86, v86, v6
    v_sub_f32 v87, v87, v6
    v_sub_f32 v88, v88, v6
    v_sub_f32 v89, v89, v6
    v_sub_f32 v90, v90, v6
    v_sub_f32 v91, v91, v6
    v_sub_f32 v92, v92, v6
    v_sub_f32 v93, v93, v6
    v_sub_f32 v94, v94, v6
    v_sub_f32 v95, v95, v6
    v_exp_f32 v80, v80
    v_exp_f32 v81, v81
    v_exp_f32 v82, v82
    v_exp_f32 v83, v83
    v_exp_f32 v84, v84
    v_exp_f32 v85, v85
    v_exp_f32 v86, v86
    v_exp_f32 v87, v87
    v_exp_f32 v88, v88
    v_exp_f32 v89, v89
    v_exp_f32 v90, v90
    v_exp_f32 v91, v91
    v_exp_f32 v92, v92
    v_exp_f32 v93, v93
    v_exp_f32 v94, v94
    v_exp_f32 v95, v95
    v_mul_f32 v144, v144, v5
    v_mul_f32 v145, v145, v5
    v_mul_f32 v146, v146, v5
    v_mul_f32 v147, v147, v5
    v_mul_f32 v148, v148, v5
    v_mul_f32 v149, v149, v5
    v_mul_f32 v150, v150, v5
    v_mul_f32 v151, v151, v5
    v_mul_f32 v152, v152, v5
    v_mul_f32 v153, v153, v5
    v_mul_f32 v154, v154, v5
    v_mul_f32 v155, v155, v5
    v_mul_f32 v156, v156, v5
    v_mul_f32 v157, v157, v5
    v_mul_f32 v158, v158, v5
    v_mul_f32 v159, v159, v5
    v_mul_f32 v196, v196, v5
    v_mul_f32 v197, v197, v5
    v_mul_f32 v198, v198, v5
    v_mul_f32 v199, v199, v5
    s_nop 1
    v_smfmac_f32_32x32x32_bf16 v[144:159], v[40:43], v[80:87], v19
    v_smfmac_f32_16x16x64_bf16 v[196:199], v[20:23], v[80:87], v19
    v_smfmac_f32_32x32x32_bf16 v[144:159], v[44:47], v[88:95], v19
    v_smfmac_f32_16x16x64_bf16 v[196:199], v[20:23], v[88:95], v19
    s_nop 15
    s_sub_u32 s40, s40, 1
    s_and_b32 s3, s40, 3
    s_cmp_eq_u32 s3, 0
    s_cselect_b32 s3, 16384, 0
    s_add_u32 s41, s41, s3
    s_add_u32 s41, s41, 4096
    s_cmp_lg_u32 s40, 0
    s_cbranch_scc1 L_sloop_87
    s_branch L_fin_73
.section .rodata,"a"
.p2align 6
.amdhsa_kernel gated_mix__softmax_full_mha__mixer_s_mlp__prompt_kernel
  .amdhsa_next_free_vgpr 256
  .amdhsa_next_free_sgpr 102
  .amdhsa_accum_offset 256
  .amdhsa_group_segment_fixed_size 0
  .amdhsa_kernarg_size 96
  .amdhsa_user_sgpr_count 2
  .amdhsa_user_sgpr_kernarg_segment_ptr 1
  .amdhsa_system_sgpr_workgroup_id_x 1
  .amdhsa_float_denorm_mode_32 3
.end_amdhsa_kernel
```
